```python
import torch

def _softmax(x, axis=-1):
    return torch.softmax(x, dim=axis)
def _gelu(x):
    return torch.nn.functional.gelu(x, approximate="tanh")
def _silu(x):
    return torch.nn.functional.silu(x)
def _sigmoid(x):
    return torch.sigmoid(x)
def _layernorm(x, axis=-1, eps=1e-5):
    m = x.mean(dim=axis, keepdim=True)
    v = x.var(dim=axis, keepdim=True, unbiased=False)
    return (x - m) / torch.sqrt(v + eps)
def _scatter_add(tgt, idx, src, axis=0):
    return tgt.clone().index_add_(axis, idx, src)
def _segment_sum(src, seg, n):
    out = torch.zeros((n,) + src.shape[1:], dtype=src.dtype)
    return out.index_add_(0, seg, src)
def _pad(x, pw):
    flat = tuple(v for pair in reversed(pw) for v in pair)
    return torch.nn.functional.pad(x, flat)

kernel_name = 'interleave_layers__softmax_full_mha__dense_activation_gelu__prompt'

def setup_inputs():

    _w = (lambda a: (lambda t: t.to(torch.bfloat16) if t.is_floating_point() else t)(torch.as_tensor(a)))
    def _A_setup():
        B, S, D = 1, 2048, 640
        return {
            "x": _w((lambda *s: torch.randn(*s, dtype=torch.bfloat16) * 0.05)(B, S, D)),
            "wqkv": _w((lambda *s: torch.randn(*s, dtype=torch.bfloat16) * 0.05)(D, 3 * D)),
            "wo": _w((lambda *s: torch.randn(*s, dtype=torch.bfloat16) * 0.05)(D, D)),
        }
    _A_in = _A_setup()

    def _B_setup():
        B, S, D, F = 1, 2048, 640, 1536
        return {
            "x": _w((lambda *s: torch.randn(*s, dtype=torch.bfloat16) * 0.05)(B, S, D)),
            "w1": _w((lambda *s: torch.randn(*s, dtype=torch.bfloat16) * 0.8)(D, F) * (D ** -0.5)),
            "b1": _w((lambda *s: torch.randn(*s, dtype=torch.bfloat16) * 0.8)(F) * 0.01),
            "w2": _w((lambda *s: torch.randn(*s, dtype=torch.bfloat16) * 0.8)(F, D) * (F ** -0.5)),
            "b2": _w((lambda *s: torch.randn(*s, dtype=torch.bfloat16) * 0.8)(D) * 0.01),
        }
    _B_in = _B_setup()

    return {
        "A_x": _A_in["x"],
        "A_wqkv": _A_in["wqkv"],
        "A_wo": _A_in["wo"],
        "B_x": _B_in["x"],
        "B_w1": _B_in["w1"],
        "B_b1": _B_in["b1"],
        "B_w2": _B_in["w2"],
        "B_b2": _B_in["b2"],
    }

def reference(A_x, A_wqkv, A_wo, B_x, B_w1, B_b1, B_w2, B_b2):
    def _A_ref(x, wqkv, wo):
        B, S, D = x.shape
        H = 32; Dh = D // H
        qkv = (lambda x, *d: x.permute(*d))((x @ wqkv).reshape(B, S, 3, H, Dh), 2, 0, 3, 1, 4)
        q, k, v = qkv[0], qkv[1], qkv[2]
        scale = Dh ** -0.5
        scores = torch.einsum("bhqd,bhkd->bhqk", q, k) * scale
        p = _softmax(scores, axis=-1)
        o = torch.einsum("bhqk,bhkd->bhqd", p, v)
        return (lambda x, *d: x.permute(*d))(o, 0, 2, 1, 3).reshape(B, S, D) @ wo

    def _B_ref(x, w1, b1, w2, b2):
        h = torch.einsum("bsd,df->bsf", x, w1) + b1
        h = _gelu(h)
        return torch.einsum("bsf,fd->bsd", h, w2) + b2

    x = A_x
    x = x + _A_ref(_layernorm(x, axis=-1), A_wqkv, A_wo)
    x = x + _B_ref(_layernorm(x, axis=-1), B_w1, B_b1, B_w2, B_b2)
    x = x + _A_ref(_layernorm(x, axis=-1), A_wqkv, A_wo)
    x = x + _B_ref(_layernorm(x, axis=-1), B_w1, B_b1, B_w2, B_b2)
    return x
```

```asm
; @launch grid=(256,1,1) block=(512,1,1) lds=163840
.amdgcn_target "amdgcn-amd-amdhsa--gfx950"
.text
.globl interleave_layers__softmax_full_mha__dense_activation_gelu__prompt_kernel
.p2align 8
.type interleave_layers__softmax_full_mha__dense_activation_gelu__prompt_kernel,@function
interleave_layers__softmax_full_mha__dense_activation_gelu__prompt_kernel:
    s_cmp_ge_u32 s2, 256
    s_cbranch_scc1 L_exit
    s_load_dwordx16 s[64:79], s[0:1], 0
    s_load_dwordx4 s[80:83], s[0:1], 64
    s_load_dwordx2 s[84:85], s[0:1], 80
    v_lshrrev_b32 v7, 6, v0
    v_and_b32 v1, 63, v0
    v_readfirstlane_b32 s26, v7
    s_and_b32 s24, s2, 7
    s_lshr_b32 s25, s2, 3
    s_getreg_b32 s30, hwreg(HW_REG_XCC_ID)
    s_and_b32 s30, s30, 7
    s_mov_b32 s27, 0
    s_mov_b32 s28, 0
    s_mov_b32 s97, 0
    s_mov_b32 s29, 400000
    s_mov_b32 s39, 0x3f803f80
    v_lshlrev_b32 v2, 4, v1
    v_lshrrev_b32 v5, 5, v1
    v_mov_b32 v6, 0
    s_lshl_b32 s37, s26, 10
    s_and_b32 s36, s37, 3072
    s_lshl_b32 s35, s24, 3
    s_add_u32 s35, s35, s26
    s_lshl_b32 s46, s25, 3
    s_add_u32 s46, s46, s26
    s_lshl_b32 s45, s24, 8
    s_add_u32 s45, s46, s45
    s_mul_i32 s44, s45, 1280
    s_mul_i32 s46, s46, 1664
    s_mul_i32 s45, s45, 1024
    s_add_u32 s45, s45, 424320
    v_mul_u32_u24 v49, 20, v1
    v_lshlrev_b32 v48, 7, v1
    v_add_u32 v50, s45, v48
    s_bfm_b64 exec, 13, 0
    v_add_u32 v50, s46, v48
    s_mov_b64 exec, -1
    s_mov_b32 s10, 2621440
    s_mov_b32 s11, 0x20000
    s_mov_b32 s14, 2457600
    s_mov_b32 s15, 0x20000
    s_mov_b32 s6, 25133056
    s_mov_b32 s7, 0x20000
    s_waitcnt lgkmcnt(0)
    s_mov_b64 s[8:9], s[64:65]
    s_mov_b64 s[12:13], s[66:67]
    buffer_load_dwordx4 v[20:23], v49, s[8:11], s44 offen
    s_bfm_b64 exec, 21, 0
    buffer_load_dword v8, v50, s[12:15], 0 offen
    s_mov_b64 exec, -1
    buffer_load_dword v24, v49, s[8:11], s44 offen offset:16
    s_mov_b64 s[4:5], s[84:85]
    s_cmp_ge_u32 s26, 6
    s_cbranch_scc1 Li_1
Li_3:
    v_mul_u32_u24 v48, 57, v1
    v_lshrrev_b32 v48, 9, v48
    v_mul_u32_u24 v49, 9, v48
    v_sub_u32 v49, v1, v49
    v_mul_u32_u24 v50, 11, v49
    v_lshrrev_b32 v50, 5, v50
    v_mul_u32_u24 v48, 3840, v48
    v_lshl_add_u32 v48, v49, 4, v48
    v_mul_u32_u24 v50, 1232, v50
    v_add_u32 v120, v48, v50
    v_lshrrev_b32 v48, 3, v1
    v_lshrrev_b32 v49, 4, v1
    v_and_b32 v50, 7, v1
    v_xor_b32 v49, v49, v50
    v_mul_u32_u24 v48, 1280, v48
    v_lshl_add_u32 v121, v49, 4, v48
    v_xor_b32 v122, 64, v121
    s_mul_i32 s44, s25, 40
    s_and_b32 s44, s44, 0xfffffff0
    s_mul_i32 s59, s26, 26880
    s_add_u32 s59, s59, s44
    s_mul_i32 s61, s26, 1008
    s_add_u32 s61, s61, 65536
    s_mul_i32 s60, s35, 40960
    s_lshl_b32 s62, s26, 13
    s_and_b32 s44, s25, 3
    s_mov_b32 s52, 0x68532410
    s_mov_b32 s53, 0xba97
    s_cmp_eq_u32 s44, 1
    s_cmov_b32 s52, 0x96435210
    s_cmov_b32 s53, 0xba87
    s_cmp_eq_u32 s44, 2
    s_cmov_b32 s52, 0x75463210
    s_cmov_b32 s53, 0xb98a
    s_cmp_eq_u32 s44, 3
    s_cmov_b32 s52, 0x65743210
    s_cmov_b32 s53, 0xa9b8
    s_mov_b32 s16, s80
    s_mov_b32 s17, s81
    s_mov_b32 s18, 2621440
    s_mov_b32 s19, 0x20000
    s_and_b32 s33, s25, 7
    s_and_b32 s34, s25, 15
    s_and_b32 s44, s26, 3
    s_lshr_b32 s45, s25, 3
    s_lshl_b32 s45, s45, 2
    s_lshl_b32 s31, s24, 4
    s_add_u32 s31, s31, s45
    s_add_u32 s31, s31, s44
    s_lshr_b32 s45, s25, 4
    s_lshl_b32 s45, s45, 2
    s_lshl_b32 s32, s24, 3
    s_add_u32 s32, s32, s45
    s_add_u32 s32, s32, s44
    s_mul_i32 s38, s25, 172032
    s_add_u32 s38, s38, 14123008
    v_add_u32 v3, 0x10000, v2
    v_add_u32 v4, 0x20000, v2
    s_mul_i32 s90, s26, 2624
    s_lshl_b32 s92, s25, 10
    s_add_u32 s92, s92, 32768
    s_lshl_b32 s91, s25, 12
    s_lshr_b32 s44, s36, 3
    s_add_u32 s91, s91, s44
    s_add_u32 s91, s91, 65536
    s_mul_i32 s41, s33, 102400
    s_add_u32 s41, s41, 9371648
    s_mul_i32 s42, s34, 122880
    s_add_u32 s42, s42, 10190848
    s_mul_i32 s43, s33, 245760
    s_add_u32 s43, s43, 12156928
    s_mov_b32 s54, 0xc0135761
    s_mov_b32 s55, 0xc0135761
    s_mov_b32 s56, 0xbdd2d3e8
    s_mov_b32 s57, 0xbdd2d3e8
    v_and_b32 v56, 31, v1
    v_lshlrev_b32 v46, 2, v56
    v_and_b32 v47, 60, v46
    v_bfe_u32 v57, v1, 1, 3
    v_xor_b32 v57, v57, v5
    v_lshlrev_b32 v57, 4, v57
    v_lshl_add_u32 v57, v56, 7, v57
    s_lshl_b32 s44, s26, 13
    v_add_u32 v124, s44, v57
    v_xor_b32 v125, 32, v124
    v_xor_b32 v126, 64, v124
    v_xor_b32 v127, 96, v124
    v_bfe_u32 v57, v1, 2, 2
    v_lshl_add_u32 v57, v5, 3, v57
    v_mul_u32_u24 v57, 144, v57
    s_and_b32 s44, s25, 1
    s_lshl_b32 s44, s44, 3
    s_add_u32 s44, s44, 65536
    v_add_u32 v57, s44, v57
    v_and_b32 v58, 3, v1
    v_lshlrev_b32 v58, 3, v58
    v_and_b32 v59, 16, v1
    v_cmp_ne_u32 vcc, 0, v59
    v_mov_b32 v59, 0x48384030
    v_mov_b32 v60, 0x78687060
    v_cndmask_b32 v59, v59, v60, vcc
    v_bfe_u32 v59, v59, v58, 8
    v_add_u32 v128, v57, v59
    v_mov_b32 v59, 0x20208050
    v_mov_b32 v60, 0x18081000
    v_cndmask_b32 v59, v59, v60, vcc
    v_bfe_u32 v59, v59, v58, 8
    v_add_u32 v129, v57, v59
    s_branch L_front_end
Li_1:
    s_cmp_eq_u32 s26, 7
    s_cbranch_scc1 Li_2
    s_cmp_ge_u32 s2, 24
    s_cbranch_scc1 Li_3
    v_mov_b32 v52, 0
    v_mov_b32 v53, 0
    v_mov_b32 v54, 0
    v_mov_b32 v55, 0
    s_lshl_b32 s44, s2, 13
    buffer_store_dwordx4 v[52:55], v2, s[4:7], s44 offen offset:0 sc1
    buffer_store_dwordx4 v[52:55], v2, s[4:7], s44 offen offset:1024 sc1
    buffer_store_dwordx4 v[52:55], v2, s[4:7], s44 offen offset:2048 sc1
    buffer_store_dwordx4 v[52:55], v2, s[4:7], s44 offen offset:3072 sc1
    s_add_u32 s44, s44, 4096
    buffer_store_dwordx4 v[52:55], v2, s[4:7], s44 offen offset:0 sc1
    buffer_store_dwordx4 v[52:55], v2, s[4:7], s44 offen offset:1024 sc1
    buffer_store_dwordx4 v[52:55], v2, s[4:7], s44 offen offset:2048 sc1
    buffer_store_dwordx4 v[52:55], v2, s[4:7], s44 offen offset:3072 sc1
    s_add_u32 s44, s44, 4096
    s_branch Li_3
Li_2:
    s_getpc_b64 s[46:47]
L_pc:
    s_lshl_b32 s44, s25, 11
    v_add_u32 v49, s44, v48
    v_min_u32 v49, (L_hotend-L_pc-4), v49
    s_mov_b64 exec, 0xffff
    global_load_dword v9, v49, s[46:47]
    s_mov_b64 exec, -1
    s_branch Li_3
L_front_end:
    v_mov_b32 v134, 0
    v_mov_b32 v135, 0
    v_mov_b32 v136, 0
    v_mov_b32 v137, 0
    s_mul_i32 s44, s26, 2304
    v_and_b32 v7, 28, v46
    v_lshlrev_b32 v14, 2, v1
    v_min_u32 v17, 92, v46
    v_add_u32 v130, s44, v128
    v_add_u32 v131, s44, v129
    s_waitcnt vmcnt(0)
    s_bfe_u32 s50, s52, 0x40000
    s_mul_i32 s51, s50, 8064
    s_add_u32 m0, s51, s61
    s_mul_i32 s51, s50, 215040
    s_add_u32 s51, s51, s59
    buffer_load_dwordx4 v120, s[12:15], s51 offen lds
    s_bfe_u32 s50, s52, 0x40004
    s_mul_i32 s51, s50, 8064
    s_add_u32 m0, s51, s61
    s_mul_i32 s51, s50, 215040
    s_add_u32 s51, s51, s59
    buffer_load_dwordx4 v120, s[12:15], s51 offen lds
    s_add_u32 m0, s62, 0
    s_add_u32 s51, s60, 0
    buffer_load_dwordx4 v121, s[8:11], s51 offen lds
    s_add_u32 m0, s62, 1024
    s_add_u32 s51, s60, 10240
    buffer_load_dwordx4 v122, s[8:11], s51 offen lds
    s_add_u32 m0, s62, 2048
    s_add_u32 s51, s60, 20480
    buffer_load_dwordx4 v121, s[8:11], s51 offen lds
    s_add_u32 m0, s62, 3072
    s_add_u32 s51, s60, 30720
    buffer_load_dwordx4 v122, s[8:11], s51 offen lds
    v_dot2c_f32_bf16 v134, s39, v20
    v_dot2c_f32_bf16 v135, v20, v20
    v_dot2c_f32_bf16 v134, s39, v21
    v_dot2c_f32_bf16 v135, v21, v21
    v_dot2c_f32_bf16 v134, s39, v22
    v_dot2c_f32_bf16 v135, v22, v22
    v_dot2c_f32_bf16 v134, s39, v23
    v_dot2c_f32_bf16 v135, v23, v23
    v_dot2c_f32_bf16 v134, s39, v24
    v_dot2c_f32_bf16 v135, v24, v24
    s_xor_b32 s44, s26, 6
    s_lshl_b32 s44, s44, 8
    s_or_b32 s44, s44, s2
    s_cmp_ge_u32 s44, 24
    s_cbranch_scc1 Larr_4
    s_lshl_b32 s44, s2, 2
    v_mov_b32 v12, s44
    v_mov_b32 v13, 1
    s_mov_b64 exec, 1
    global_store_dword v12, v13, s[82:83] offset:64 sc1
    s_mov_b64 exec, -1
Larr_4:
    s_add_u32 m0, s62, 4096
    s_add_u32 s51, s60, 128
    buffer_load_dwordx4 v121, s[8:11], s51 offen lds
    s_add_u32 m0, s62, 5120
    s_add_u32 s51, s60, 10368
    buffer_load_dwordx4 v122, s[8:11], s51 offen lds
    s_add_u32 m0, s62, 6144
    s_add_u32 s51, s60, 20608
    buffer_load_dwordx4 v121, s[8:11], s51 offen lds
    s_add_u32 m0, s62, 7168
    s_add_u32 s51, s60, 30848
    buffer_load_dwordx4 v122, s[8:11], s51 offen lds
    s_bfe_u32 s50, s52, 0x40008
    s_mul_i32 s51, s50, 8064
    s_add_u32 m0, s51, s61
    s_mul_i32 s51, s50, 215040
    s_add_u32 s51, s51, s59
    buffer_load_dwordx4 v120, s[12:15], s51 offen lds
    s_bfe_u32 s50, s52, 0x4000c
    s_mul_i32 s51, s50, 8064
    s_add_u32 m0, s51, s61
    s_mul_i32 s51, s50, 215040
    s_add_u32 s51, s51, s59
    buffer_load_dwordx4 v120, s[12:15], s51 offen lds
    v_add_f32_dpp v134, v134, v134 row_ror:8 row_mask:0xf bank_mask:0xf
    v_add_f32_dpp v135, v135, v135 row_ror:8 row_mask:0xf bank_mask:0xf
    s_nop 0
    v_add_f32_dpp v134, v134, v134 row_ror:4 row_mask:0xf bank_mask:0xf
    v_add_f32_dpp v135, v135, v135 row_ror:4 row_mask:0xf bank_mask:0xf
    s_nop 0
    v_add_f32_dpp v134, v134, v134 row_ror:2 row_mask:0xf bank_mask:0xf
    v_add_f32_dpp v135, v135, v135 row_ror:2 row_mask:0xf bank_mask:0xf
    s_nop 0
    v_add_f32_dpp v134, v134, v134 row_ror:1 row_mask:0xf bank_mask:0xf
    v_add_f32_dpp v135, v135, v135 row_ror:1 row_mask:0xf bank_mask:0xf
    s_nop 0
    v_mov_b32 v10, v134
    v_mov_b32 v11, v135
    s_nop 1
    v_permlane16_swap_b32 v134, v10
    v_permlane16_swap_b32 v135, v11
    v_add_f32 v134, v134, v10
    v_add_f32 v135, v135, v11
    v_mov_b32 v10, v134
    v_mov_b32 v11, v135
    s_nop 1
    v_permlane32_swap_b32 v134, v10
    v_permlane32_swap_b32 v135, v11
    v_add_f32 v134, v134, v10
    v_add_f32 v135, v135, v11
    v_mul_f32 v134, 0x3acccccd, v134
    v_mul_f32 v135, 0x3acccccd, v135
    v_fma_f32 v135, -v134, v134, v135
    v_max_f32 v135, 0, v135
    v_add_f32 v135, 0x3727c5ac, v135
    v_rsq_f32 v132, v135
    s_nop 0
    v_mul_f32 v133, -1.0, v132
    v_mul_f32 v133, v134, v133
    s_lshl_b32 s44, s26, 3
    s_add_u32 s44, s44, 163328
    v_or_b32 v132, 1, v132
    v_mov_b32 v10, s44
    ds_write_b64 v10, v[132:133]
    v_add_u32 v10, 163456, v47
    ds_write_b32 v10, v136
    s_waitcnt vmcnt(6)
    s_barrier
    ds_read_b128 v[144:147], v124 offset:0
    ds_read_b128 v[148:151], v125 offset:0
    ds_read_b128 v[152:155], v126 offset:0
    ds_read_b128 v[156:159], v127 offset:0
    ds_read_b64_tr_b16 v[176:177], v128 offset:0
    ds_read_b64_tr_b16 v[178:179], v128 offset:576
    ds_read_b64_tr_b16 v[180:181], v129 offset:0
    ds_read_b64_tr_b16 v[182:183], v129 offset:576
    ds_read_b64_tr_b16 v[184:185], v128 offset:2304
    ds_read_b64_tr_b16 v[186:187], v128 offset:2880
    ds_read_b64_tr_b16 v[188:189], v129 offset:2304
    ds_read_b64_tr_b16 v[190:191], v129 offset:2880
    s_waitcnt lgkmcnt(4)
    v_mfma_f32_32x32x16_bf16 v[224:239], v[176:179], v[144:147], 0
    v_mov_b32 v35, 0xdddddddd
    v_and_b32 v140, 31, v1
    v_and_b32 v141, 1, v1
    v_lshlrev_b32 v141, 4, v141
    v_mov_b32 v142, 0x3f80
    v_lshlrev_b32 v141, v141, v142
    v_mfma_f32_32x32x16_bf16 v[240:255], v[180:183], v[144:147], 0
    v_bfe_u32 v142, v1, 2, 1
    v_xor_b32 v142, v142, v5
    v_lshlrev_b32 v142, 4, v142
    v_lshrrev_b32 v143, 3, v140
    v_lshl_or_b32 v142, v143, 1, v142
    v_bfe_u32 v143, v1, 1, 1
    ds_read_b64_tr_b16 v[192:193], v128 offset:4608
    ds_read_b64_tr_b16 v[194:195], v128 offset:5184
    ds_read_b64_tr_b16 v[196:197], v129 offset:4608
    ds_read_b64_tr_b16 v[198:199], v129 offset:5184
    s_add_u32 m0, s62, 0
    s_add_u32 s51, s60, 256
    buffer_load_dwordx4 v121, s[8:11], s51 offen lds
    s_add_u32 m0, s62, 1024
    s_add_u32 s51, s60, 10496
    buffer_load_dwordx4 v122, s[8:11], s51 offen lds
    s_waitcnt lgkmcnt(4)
    v_mfma_f32_32x32x16_bf16 v[224:239], v[184:187], v[148:151], v[224:239]
    v_or_b32 v142, v142, v143
    v_cmp_eq_u32 vcc, 0, v142
    s_nop 1
    v_cndmask_b32 v28, 0, v141, vcc
    v_cmp_eq_u32 vcc, 1, v142
    s_nop 1
    v_mfma_f32_32x32x16_bf16 v[240:255], v[188:191], v[148:151], v[240:255]
    v_cndmask_b32 v29, 0, v141, vcc
    v_cmp_eq_u32 vcc, 2, v142
    s_nop 1
    v_cndmask_b32 v30, 0, v141, vcc
    v_cmp_eq_u32 vcc, 3, v142
    s_nop 1
    ds_read_b64_tr_b16 v[200:201], v128 offset:6912
    ds_read_b64_tr_b16 v[202:203], v128 offset:7488
    ds_read_b64_tr_b16 v[204:205], v129 offset:6912
    ds_read_b64_tr_b16 v[206:207], v129 offset:7488
    s_add_u32 m0, s62, 2048
    s_add_u32 s51, s60, 20736
    buffer_load_dwordx4 v121, s[8:11], s51 offen lds
    s_bfe_u32 s50, s52, 0x40010
    s_mul_i32 s51, s50, 8064
    s_add_u32 m0, s51, s61
    s_mul_i32 s51, s50, 215040
    s_add_u32 s51, s51, s59
    buffer_load_dwordx4 v120, s[12:15], s51 offen lds
    s_waitcnt vmcnt(4) lgkmcnt(4)
    s_barrier
    v_mfma_f32_32x32x16_bf16 v[224:239], v[192:195], v[152:155], v[224:239]
    v_cndmask_b32 v31, 0, v141, vcc
    v_lshrrev_b32 v142, 1, v1
    v_cmp_eq_u32 vcc, 24, v142
    s_nop 1
    v_cndmask_b32 v32, 0, v141, vcc
    v_cmp_eq_u32 vcc, 25, v142
    v_mfma_f32_32x32x16_bf16 v[240:255], v[196:199], v[152:155], v[240:255]
    s_nop 1
    v_cndmask_b32 v33, 0, v141, vcc
    v_mov_b32 v142, s39
    v_cmp_eq_u32 vcc, 20, v140
    s_nop 1
    v_cndmask_b32 v34, 0, v142, vcc
    ds_read_b128 v[160:163], v124 offset:4096
    ds_read_b128 v[164:167], v125 offset:4096
    ds_read_b128 v[168:171], v126 offset:4096
    ds_read_b128 v[172:175], v127 offset:4096
    ds_read_b64_tr_b16 v[176:177], v128 offset:9216
    ds_read_b64_tr_b16 v[178:179], v128 offset:9792
    ds_read_b64_tr_b16 v[180:181], v129 offset:9216
    ds_read_b64_tr_b16 v[182:183], v129 offset:9792
    s_add_u32 m0, s62, 3072
    s_add_u32 s51, s60, 30976
    buffer_load_dwordx4 v122, s[8:11], s51 offen lds
    s_waitcnt lgkmcnt(8)
    v_mfma_f32_32x32x16_bf16 v[224:239], v[200:203], v[156:159], v[224:239]
    v_and_b32 v141, 0x13, v140
    v_bfe_u32 v142, v140, 2, 1
    v_lshl_or_b32 v141, v142, 3, v141
    v_bfe_u32 v142, v140, 3, 1
    v_lshl_or_b32 v141, v142, 2, v141
    s_mul_i32 s44, s26, 2624
    v_mfma_f32_32x32x16_bf16 v[240:255], v[204:207], v[156:159], v[240:255]
    v_lshlrev_b32 v142, 9, v5
    v_lshl_add_u32 v142, v141, 4, v142
    v_add_u32 v36, s44, v142
    v_lshlrev_b32 v142, 3, v141
    v_add_u32 v37, s44, v142
    v_min_u32 v141, 20, v140
    ds_read_b64_tr_b16 v[184:185], v128 offset:11520
    ds_read_b64_tr_b16 v[186:187], v128 offset:12096
    ds_read_b64_tr_b16 v[188:189], v129 offset:11520
    ds_read_b64_tr_b16 v[190:191], v129 offset:12096
    s_bfe_u32 s50, s52, 0x40014
    s_mul_i32 s51, s50, 8064
    s_add_u32 m0, s51, s61
    s_mul_i32 s51, s50, 215040
    s_add_u32 s51, s51, s59
    buffer_load_dwordx4 v120, s[12:15], s51 offen lds
    s_waitcnt lgkmcnt(4)
    v_mfma_f32_32x32x16_bf16 v[224:239], v[176:179], v[160:163], v[224:239]
    v_mul_u32_u24 v142, 336, v5
    v_lshl_add_u32 v40, v141, 4, v142
    v_add_u32 v38, s44, v40
    v_mul_u32_u24 v142, 2624, v5
    v_lshl_add_u32 v39, v140, 3, v142
    v_lshrrev_b32 v141, 4, v140
    v_mfma_f32_32x32x16_bf16 v[240:255], v[180:183], v[160:163], v[240:255]
    v_mul_u32_u24 v141, 49152, v141
    v_lshl_add_u32 v141, v47, 2, v141
    s_mul_i32 s44, s35, 98304
    s_add_u32 s44, s44, 3080192
    s_lshl_b32 s45, s25, 9
    s_add_u32 s45, s45, s44
    ds_read_b64_tr_b16 v[192:193], v128 offset:13824
    ds_read_b64_tr_b16 v[194:195], v128 offset:14400
    ds_read_b64_tr_b16 v[196:197], v129 offset:13824
    ds_read_b64_tr_b16 v[198:199], v129 offset:14400
    s_add_u32 m0, s62, 4096
    s_add_u32 s51, s60, 384
    buffer_load_dwordx4 v121, s[8:11], s51 offen lds
    s_add_u32 m0, s62, 5120
    s_add_u32 s51, s60, 10624
    buffer_load_dwordx4 v122, s[8:11], s51 offen lds
    ds_read_b64_tr_b16 v[48:49], v130 offset:0
    ds_read_b64_tr_b16 v[50:51], v130 offset:576
    ds_read_b64_tr_b16 v[52:53], v131 offset:0
    ds_read_b64_tr_b16 v[54:55], v131 offset:576
    s_waitcnt lgkmcnt(8)
    v_mfma_f32_32x32x16_bf16 v[224:239], v[184:187], v[164:167], v[224:239]
    v_lshl_add_u32 v142, v5, 8, v141
    v_add_u32 v41, s45, v142
    s_lshr_b32 s45, s25, 1
    s_lshl_b32 s45, s45, 8
    s_and_b32 s46, s25, 1
    s_lshl_b32 s46, s46, 3
    v_mfma_f32_32x32x16_bf16 v[240:255], v[188:191], v[164:167], v[240:255]
    s_add_u32 s45, s45, s46
    s_add_u32 s45, s45, s44
    s_add_u32 s45, s45, 16384
    v_add_u32 v42, s45, v141
    s_lshr_b32 s44, s31, 1
    s_and_b32 s45, s31, 1
    ds_read_b64_tr_b16 v[200:201], v128 offset:16128
    ds_read_b64_tr_b16 v[202:203], v128 offset:16704
    ds_read_b64_tr_b16 v[204:205], v129 offset:16128
    ds_read_b64_tr_b16 v[206:207], v129 offset:16704
    s_add_u32 m0, s62, 6144
    s_add_u32 s51, s60, 20864
    buffer_load_dwordx4 v121, s[8:11], s51 offen lds
    s_bfe_u32 s50, s52, 0x40018
    s_mul_i32 s51, s50, 8064
    s_add_u32 m0, s51, s61
    s_mul_i32 s51, s50, 215040
    s_add_u32 s51, s51, s59
    buffer_load_dwordx4 v120, s[12:15], s51 offen lds
    s_cmp_lg_u32 s26, 5
    s_cbranch_scc1 Ld_5
    global_load_dword v16, v17, s[82:83] offset:64 sc1
Ld_5:
    s_waitcnt vmcnt(5) lgkmcnt(8)
    s_barrier
    v_mfma_f32_32x32x16_bf16 v[224:239], v[192:195], v[168:171], v[224:239]
    s_mul_i32 s46, s44, 40960
    s_mul_i32 s47, s33, 5120
    s_add_u32 s46, s46, s47
    s_lshl_b32 s47, s45, 8
    s_add_u32 s46, s46, s47
    s_add_u32 s46, s46, 458752
    v_mfma_f32_32x32x16_bf16 v[240:255], v[196:199], v[168:171], v[240:255]
    v_lshrrev_b32 v141, 4, v1
    v_lshlrev_b32 v142, 9, v141
    v_lshl_add_u32 v142, v47, 2, v142
    v_add_u32 v43, s46, v142
    v_lshlrev_b32 v142, 9, v5
    v_lshl_add_u32 v142, v47, 2, v142
    ds_read_b128 v[144:147], v124 offset:0
    ds_read_b128 v[148:151], v125 offset:0
    ds_read_b128 v[152:155], v126 offset:0
    ds_read_b128 v[156:159], v127 offset:0
    ds_read_b64_tr_b16 v[176:177], v128 offset:18432
    ds_read_b64_tr_b16 v[178:179], v128 offset:19008
    ds_read_b64_tr_b16 v[180:181], v129 offset:18432
    ds_read_b64_tr_b16 v[182:183], v129 offset:19008
    s_add_u32 m0, s62, 7168
    s_add_u32 s51, s60, 31104
    buffer_load_dwordx4 v122, s[8:11], s51 offen lds
    s_waitcnt lgkmcnt(12)
    v_dot2c_f32_bf16 v136, s39, v48
    v_dot2c_f32_bf16 v137, s39, v52
    v_dot2c_f32_bf16 v136, s39, v49
    v_dot2c_f32_bf16 v137, s39, v53
    v_dot2c_f32_bf16 v136, s39, v50
    v_dot2c_f32_bf16 v137, s39, v54
    v_dot2c_f32_bf16 v136, s39, v51
    v_dot2c_f32_bf16 v137, s39, v55
    s_waitcnt lgkmcnt(8)
    v_mfma_f32_32x32x16_bf16 v[224:239], v[200:203], v[172:175], v[224:239]
    v_and_b32 v143, 1, v141
    v_lshl_add_u32 v142, v143, 3, v142
    s_add_u32 s46, s46, 4096
    v_add_u32 v44, s46, v142
    s_lshl_b32 s46, s44, 11
    s_lshl_b32 s47, s45, 8
    v_mfma_f32_32x32x16_bf16 v[240:255], v[204:207], v[172:175], v[240:255]
    s_add_u32 s46, s46, s47
    s_lshr_b32 s47, s33, 1
    s_lshl_b32 s47, s47, 9
    s_add_u32 s46, s46, s47
    s_and_b32 s47, s33, 1
    s_lshl_b32 s47, s47, 3
    ds_read_b64_tr_b16 v[184:185], v128 offset:20736
    ds_read_b64_tr_b16 v[186:187], v128 offset:21312
    ds_read_b64_tr_b16 v[188:189], v129 offset:20736
    ds_read_b64_tr_b16 v[190:191], v129 offset:21312
    s_waitcnt lgkmcnt(4)
    v_mfma_f32_32x32x16_bf16 v[224:239], v[176:179], v[144:147], v[224:239]
    s_add_u32 s46, s46, s47
    s_add_u32 s46, s46, 196608
    v_lshlrev_b32 v142, 2, v47
    v_lshl_add_u32 v142, v5, 2, v142
    v_add_u32 v45, s46, v142
    v_mfma_f32_32x32x16_bf16 v[240:255], v[180:183], v[144:147], v[240:255]
    ds_read_b64_tr_b16 v[192:193], v128 offset:23040
    ds_read_b64_tr_b16 v[194:195], v128 offset:23616
    ds_read_b64_tr_b16 v[196:197], v129 offset:23040
    ds_read_b64_tr_b16 v[198:199], v129 offset:23616
    s_add_u32 m0, s62, 0
    s_add_u32 s51, s60, 512
    buffer_load_dwordx4 v121, s[8:11], s51 offen lds
    s_add_u32 m0, s62, 1024
    s_add_u32 s51, s60, 10752
    buffer_load_dwordx4 v122, s[8:11], s51 offen lds
    s_waitcnt lgkmcnt(4)
    v_mfma_f32_32x32x16_bf16 v[224:239], v[184:187], v[148:151], v[224:239]
    v_mfma_f32_32x32x16_bf16 v[240:255], v[188:191], v[148:151], v[240:255]
    ds_read_b64_tr_b16 v[200:201], v128 offset:25344
    ds_read_b64_tr_b16 v[202:203], v128 offset:25920
    ds_read_b64_tr_b16 v[204:205], v129 offset:25344
    ds_read_b64_tr_b16 v[206:207], v129 offset:25920
    s_add_u32 m0, s62, 2048
    s_add_u32 s51, s60, 20992
    buffer_load_dwordx4 v121, s[8:11], s51 offen lds
    s_bfe_u32 s50, s52, 0x4001c
    s_mul_i32 s51, s50, 8064
    s_add_u32 m0, s51, s61
    s_mul_i32 s51, s50, 215040
    s_add_u32 s51, s51, s59
    buffer_load_dwordx4 v120, s[12:15], s51 offen lds
    s_waitcnt vmcnt(4) lgkmcnt(4)
    s_barrier
    v_mfma_f32_32x32x16_bf16 v[224:239], v[192:195], v[152:155], v[224:239]
    v_mfma_f32_32x32x16_bf16 v[240:255], v[196:199], v[152:155], v[240:255]
    ds_read_b128 v[160:163], v124 offset:4096
    ds_read_b128 v[164:167], v125 offset:4096
    ds_read_b128 v[168:171], v126 offset:4096
    ds_read_b128 v[172:175], v127 offset:4096
    ds_read_b64_tr_b16 v[176:177], v128 offset:27648
    ds_read_b64_tr_b16 v[178:179], v128 offset:28224
    ds_read_b64_tr_b16 v[180:181], v129 offset:27648
    ds_read_b64_tr_b16 v[182:183], v129 offset:28224
    s_add_u32 m0, s62, 3072
    s_add_u32 s51, s60, 31232
    buffer_load_dwordx4 v122, s[8:11], s51 offen lds
    s_cmp_eq_u32 s26, 5
    s_cbranch_scc1 Lc_8
Lc_9:
    s_waitcnt lgkmcnt(8)
    v_mfma_f32_32x32x16_bf16 v[224:239], v[200:203], v[156:159], v[224:239]
    v_mfma_f32_32x32x16_bf16 v[240:255], v[204:207], v[156:159], v[240:255]
    ds_read_b64_tr_b16 v[184:185], v128 offset:29952
    ds_read_b64_tr_b16 v[186:187], v128 offset:30528
    ds_read_b64_tr_b16 v[188:189], v129 offset:29952
    ds_read_b64_tr_b16 v[190:191], v129 offset:30528
    s_bfe_u32 s50, s53, 0x40000
    s_mul_i32 s51, s50, 8064
    s_add_u32 m0, s51, s61
    s_mul_i32 s51, s50, 215040
    s_add_u32 s51, s51, s59
    buffer_load_dwordx4 v120, s[12:15], s51 offen lds
    s_waitcnt lgkmcnt(4)
    v_mfma_f32_32x32x16_bf16 v[224:239], v[176:179], v[160:163], v[224:239]
    v_mfma_f32_32x32x16_bf16 v[240:255], v[180:183], v[160:163], v[240:255]
    ds_read_b64_tr_b16 v[192:193], v128 offset:32256
    ds_read_b64_tr_b16 v[194:195], v128 offset:32832
    ds_read_b64_tr_b16 v[196:197], v129 offset:32256
    ds_read_b64_tr_b16 v[198:199], v129 offset:32832
    s_add_u32 m0, s62, 4096
    s_add_u32 s51, s60, 640
    buffer_load_dwordx4 v121, s[8:11], s51 offen lds
    s_add_u32 m0, s62, 5120
    s_add_u32 s51, s60, 10880
    buffer_load_dwordx4 v122, s[8:11], s51 offen lds
    ds_read_b64_tr_b16 v[56:57], v130 offset:18432
    ds_read_b64_tr_b16 v[58:59], v130 offset:19008
    ds_read_b64_tr_b16 v[60:61], v131 offset:18432
    ds_read_b64_tr_b16 v[62:63], v131 offset:19008
    s_waitcnt lgkmcnt(8)
    v_mfma_f32_32x32x16_bf16 v[224:239], v[184:187], v[164:167], v[224:239]
    v_mfma_f32_32x32x16_bf16 v[240:255], v[188:191], v[164:167], v[240:255]
    ds_read_b64_tr_b16 v[200:201], v128 offset:34560
    ds_read_b64_tr_b16 v[202:203], v128 offset:35136
    ds_read_b64_tr_b16 v[204:205], v129 offset:34560
    ds_read_b64_tr_b16 v[206:207], v129 offset:35136
    s_add_u32 m0, s62, 6144
    s_add_u32 s51, s60, 21120
    buffer_load_dwordx4 v121, s[8:11], s51 offen lds
    s_bfe_u32 s50, s53, 0x40004
    s_mul_i32 s51, s50, 8064
    s_add_u32 m0, s51, s61
    s_mul_i32 s51, s50, 215040
    s_add_u32 s51, s51, s59
    buffer_load_dwordx4 v120, s[12:15], s51 offen lds
    s_waitcnt vmcnt(5) lgkmcnt(8)
    s_barrier
    v_mfma_f32_32x32x16_bf16 v[224:239], v[192:195], v[168:171], v[224:239]
    v_mfma_f32_32x32x16_bf16 v[240:255], v[196:199], v[168:171], v[240:255]
    ds_read_b128 v[144:147], v124 offset:0
    ds_read_b128 v[148:151], v125 offset:0
    ds_read_b128 v[152:155], v126 offset:0
    ds_read_b128 v[156:159], v127 offset:0
    ds_read_b64_tr_b16 v[176:177], v128 offset:36864
    ds_read_b64_tr_b16 v[178:179], v128 offset:37440
    ds_read_b64_tr_b16 v[180:181], v129 offset:36864
    ds_read_b64_tr_b16 v[182:183], v129 offset:37440
    s_add_u32 m0, s62, 7168
    s_add_u32 s51, s60, 31360
    buffer_load_dwordx4 v122, s[8:11], s51 offen lds
    s_waitcnt lgkmcnt(12)
    v_dot2c_f32_bf16 v136, s39, v56
    v_dot2c_f32_bf16 v137, s39, v60
    v_dot2c_f32_bf16 v136, s39, v57
    v_dot2c_f32_bf16 v137, s39, v61
    v_dot2c_f32_bf16 v136, s39, v58
    v_dot2c_f32_bf16 v137, s39, v62
    v_dot2c_f32_bf16 v136, s39, v59
    v_dot2c_f32_bf16 v137, s39, v63
    s_waitcnt lgkmcnt(8)
    v_mfma_f32_32x32x16_bf16 v[224:239], v[200:203], v[172:175], v[224:239]
    v_mfma_f32_32x32x16_bf16 v[240:255], v[204:207], v[172:175], v[240:255]
    ds_read_b64_tr_b16 v[184:185], v128 offset:39168
    ds_read_b64_tr_b16 v[186:187], v128 offset:39744
    ds_read_b64_tr_b16 v[188:189], v129 offset:39168
    ds_read_b64_tr_b16 v[190:191], v129 offset:39744
    s_waitcnt lgkmcnt(4)
    v_mfma_f32_32x32x16_bf16 v[224:239], v[176:179], v[144:147], v[224:239]
    v_mfma_f32_32x32x16_bf16 v[240:255], v[180:183], v[144:147], v[240:255]
    ds_read_b64_tr_b16 v[192:193], v128 offset:41472
    ds_read_b64_tr_b16 v[194:195], v128 offset:42048
    ds_read_b64_tr_b16 v[196:197], v129 offset:41472
    ds_read_b64_tr_b16 v[198:199], v129 offset:42048
    s_add_u32 m0, s62, 0
    s_add_u32 s51, s60, 768
    buffer_load_dwordx4 v121, s[8:11], s51 offen lds
    s_add_u32 m0, s62, 1024
    s_add_u32 s51, s60, 11008
    buffer_load_dwordx4 v122, s[8:11], s51 offen lds
    s_waitcnt lgkmcnt(4)
    v_mfma_f32_32x32x16_bf16 v[224:239], v[184:187], v[148:151], v[224:239]
    v_mfma_f32_32x32x16_bf16 v[240:255], v[188:191], v[148:151], v[240:255]
    ds_read_b64_tr_b16 v[200:201], v128 offset:43776
    ds_read_b64_tr_b16 v[202:203], v128 offset:44352
    ds_read_b64_tr_b16 v[204:205], v129 offset:43776
    ds_read_b64_tr_b16 v[206:207], v129 offset:44352
    s_add_u32 m0, s62, 2048
    s_add_u32 s51, s60, 21248
    buffer_load_dwordx4 v121, s[8:11], s51 offen lds
    s_bfe_u32 s50, s53, 0x40008
    s_mul_i32 s51, s50, 8064
    s_add_u32 m0, s51, s61
    s_mul_i32 s51, s50, 215040
    s_add_u32 s51, s51, s59
    buffer_load_dwordx4 v120, s[12:15], s51 offen lds
    s_waitcnt vmcnt(4) lgkmcnt(4)
    s_barrier
    v_mfma_f32_32x32x16_bf16 v[224:239], v[192:195], v[152:155], v[224:239]
    v_mfma_f32_32x32x16_bf16 v[240:255], v[196:199], v[152:155], v[240:255]
    ds_read_b128 v[160:163], v124 offset:4096
    ds_read_b128 v[164:167], v125 offset:4096
    ds_read_b128 v[168:171], v126 offset:4096
    ds_read_b128 v[172:175], v127 offset:4096
    ds_read_b64_tr_b16 v[176:177], v128 offset:46080
    ds_read_b64_tr_b16 v[178:179], v128 offset:46656
    ds_read_b64_tr_b16 v[180:181], v129 offset:46080
    ds_read_b64_tr_b16 v[182:183], v129 offset:46656
    s_add_u32 m0, s62, 3072
    s_add_u32 s51, s60, 31488
    buffer_load_dwordx4 v122, s[8:11], s51 offen lds
    s_waitcnt lgkmcnt(8)
    v_mfma_f32_32x32x16_bf16 v[224:239], v[200:203], v[156:159], v[224:239]
    v_mfma_f32_32x32x16_bf16 v[240:255], v[204:207], v[156:159], v[240:255]
    ds_read_b64_tr_b16 v[184:185], v128 offset:48384
    ds_read_b64_tr_b16 v[186:187], v128 offset:48960
    ds_read_b64_tr_b16 v[188:189], v129 offset:48384
    ds_read_b64_tr_b16 v[190:191], v129 offset:48960
    s_bfe_u32 s50, s53, 0x4000c
    s_mul_i32 s51, s50, 8064
    s_add_u32 m0, s51, s61
    s_mul_i32 s51, s50, 215040
    s_add_u32 s51, s51, s59
    buffer_load_dwordx4 v120, s[12:15], s51 offen lds
    s_waitcnt lgkmcnt(4)
    v_mfma_f32_32x32x16_bf16 v[224:239], v[176:179], v[160:163], v[224:239]
    v_mfma_f32_32x32x16_bf16 v[240:255], v[180:183], v[160:163], v[240:255]
    ds_read_b64_tr_b16 v[192:193], v128 offset:50688
    ds_read_b64_tr_b16 v[194:195], v128 offset:51264
    ds_read_b64_tr_b16 v[196:197], v129 offset:50688
    ds_read_b64_tr_b16 v[198:199], v129 offset:51264
    s_add_u32 m0, s62, 4096
    s_add_u32 s51, s60, 896
    buffer_load_dwordx4 v121, s[8:11], s51 offen lds
    s_add_u32 m0, s62, 5120
    s_add_u32 s51, s60, 11136
    buffer_load_dwordx4 v122, s[8:11], s51 offen lds
    ds_read_b64_tr_b16 v[64:65], v130 offset:36864
    ds_read_b64_tr_b16 v[66:67], v130 offset:37440
    ds_read_b64_tr_b16 v[68:69], v131 offset:36864
    ds_read_b64_tr_b16 v[70:71], v131 offset:37440
    s_mov_b32 s44, 0x5d43c210
    s_mov_b32 s45, 0xba9f87e6
    s_lshl_b32 s46, s34, 2
    s_lshr_b64 s[44:45], s[44:45], s46
    s_and_b32 s44, s44, 15
    s_lshr_b32 s45, s25, 4
    s_lshr_b32 s46, s36, 9
    s_add_u32 s45, s45, s46
    s_cmp_ge_u32 s44, 12
    s_cselect_b32 s46, 4, 12
    s_cselect_b32 s47, 84, 0
    s_mul_i32 s45, s45, s46
    s_add_u32 s45, s45, s44
    s_add_u32 s45, s45, s47
    s_lshl_b32 s45, s45, 3
    s_add_u32 s40, s45, s24
    s_cmp_ge_u32 s26, 4
    s_cbranch_scc1 Lru_10
    s_mul_i32 s45, s40, 1152
    s_mov_b32 s40, 1000
    s_cmp_ge_u32 s45, 819200
    s_cbranch_scc1 Lru_10
    v_lshl_add_u32 v112, v1, 7, s45
    v_min_u32 v112, 819072, v112
    s_mov_b64 exec, 0x1ff
    global_load_dword v113, v112, s[68:69]
    s_mov_b64 exec, -1
Lru_10:
    s_sub_u32 s44, s40, 0
    s_cmp_ge_u32 s44, 768
    s_cbranch_scc1 Lrc_11
    s_call_b64 s[70:71], L_ri
Lrc_11:
    s_waitcnt lgkmcnt(8)
    v_mfma_f32_32x32x16_bf16 v[224:239], v[184:187], v[164:167], v[224:239]
    v_mfma_f32_32x32x16_bf16 v[240:255], v[188:191], v[164:167], v[240:255]
    ds_read_b64_tr_b16 v[200:201], v128 offset:52992
    ds_read_b64_tr_b16 v[202:203], v128 offset:53568
    ds_read_b64_tr_b16 v[204:205], v129 offset:52992
    ds_read_b64_tr_b16 v[206:207], v129 offset:53568
    s_add_u32 m0, s62, 6144
    s_add_u32 s51, s60, 21376
    buffer_load_dwordx4 v121, s[8:11], s51 offen lds
    s_waitcnt vmcnt(4) lgkmcnt(8)
    s_barrier
    v_mfma_f32_32x32x16_bf16 v[224:239], v[192:195], v[168:171], v[224:239]
    v_mfma_f32_32x32x16_bf16 v[240:255], v[196:199], v[168:171], v[240:255]
    ds_read_b128 v[144:147], v124 offset:0
    ds_read_b128 v[148:151], v125 offset:0
    ds_read_b128 v[152:155], v126 offset:0
    ds_read_b128 v[156:159], v127 offset:0
    ds_read_b64_tr_b16 v[176:177], v128 offset:55296
    ds_read_b64_tr_b16 v[178:179], v128 offset:55872
    ds_read_b64_tr_b16 v[180:181], v129 offset:55296
    ds_read_b64_tr_b16 v[182:183], v129 offset:55872
    s_add_u32 m0, s62, 7168
    s_add_u32 s51, s60, 31616
    buffer_load_dwordx4 v122, s[8:11], s51 offen lds
    s_waitcnt lgkmcnt(12)
    v_dot2c_f32_bf16 v136, s39, v64
    v_dot2c_f32_bf16 v137, s39, v68
    v_dot2c_f32_bf16 v136, s39, v65
    v_dot2c_f32_bf16 v137, s39, v69
    v_dot2c_f32_bf16 v136, s39, v66
    v_dot2c_f32_bf16 v137, s39, v70
    v_dot2c_f32_bf16 v136, s39, v67
    v_dot2c_f32_bf16 v137, s39, v71
    v_add_u32 v128, 55296, v128
    v_add_u32 v129, 55296, v129
    v_add_u32 v130, 55296, v130
    v_add_u32 v131, 55296, v131
    s_waitcnt lgkmcnt(8)
    v_mfma_f32_32x32x16_bf16 v[224:239], v[200:203], v[172:175], v[224:239]
    v_mfma_f32_32x32x16_bf16 v[240:255], v[204:207], v[172:175], v[240:255]
    ds_read_b64_tr_b16 v[184:185], v128 offset:2304
    ds_read_b64_tr_b16 v[186:187], v128 offset:2880
    ds_read_b64_tr_b16 v[188:189], v129 offset:2304
    ds_read_b64_tr_b16 v[190:191], v129 offset:2880
    s_waitcnt lgkmcnt(4)
    v_mfma_f32_32x32x16_bf16 v[224:239], v[176:179], v[144:147], v[224:239]
    v_mfma_f32_32x32x16_bf16 v[240:255], v[180:183], v[144:147], v[240:255]
    ds_read_b64_tr_b16 v[192:193], v128 offset:4608
    ds_read_b64_tr_b16 v[194:195], v128 offset:5184
    ds_read_b64_tr_b16 v[196:197], v129 offset:4608
    ds_read_b64_tr_b16 v[198:199], v129 offset:5184
    s_add_u32 m0, s62, 0
    s_add_u32 s51, s60, 1024
    buffer_load_dwordx4 v121, s[8:11], s51 offen lds
    s_add_u32 m0, s62, 1024
    s_add_u32 s51, s60, 11264
    buffer_load_dwordx4 v122, s[8:11], s51 offen lds
    ds_read_b64_tr_b16 v[72:73], v130 offset:0
    ds_read_b64_tr_b16 v[74:75], v130 offset:576
    ds_read_b64_tr_b16 v[76:77], v131 offset:0
    ds_read_b64_tr_b16 v[78:79], v131 offset:576
    s_waitcnt lgkmcnt(8)
    v_mfma_f32_32x32x16_bf16 v[224:239], v[184:187], v[148:151], v[224:239]
    v_mfma_f32_32x32x16_bf16 v[240:255], v[188:191], v[148:151], v[240:255]
    ds_read_b64_tr_b16 v[200:201], v128 offset:6912
    ds_read_b64_tr_b16 v[202:203], v128 offset:7488
    ds_read_b64_tr_b16 v[204:205], v129 offset:6912
    ds_read_b64_tr_b16 v[206:207], v129 offset:7488
    s_add_u32 m0, s62, 2048
    s_add_u32 s51, s60, 21504
    buffer_load_dwordx4 v121, s[8:11], s51 offen lds
    s_lshl_b32 s48, s26, 12
    s_lshl_b32 s45, s24, 7
    s_add_u32 s48, s48, s45
    s_add_u32 s48, s48, 32832
    v_bfe_u32 v123, v1, 3, 2
    v_lshlrev_b32 v123, 10, v123
    v_lshl_add_u32 v123, v7, 1, v123
    buffer_load_dwordx2 v[132:133], v123, s[4:7], s48 offen sc1
    s_waitcnt vmcnt(4) lgkmcnt(8)
    s_barrier
    v_mfma_f32_32x32x16_bf16 v[224:239], v[192:195], v[152:155], v[224:239]
    v_mfma_f32_32x32x16_bf16 v[240:255], v[196:199], v[152:155], v[240:255]
    ds_read_b128 v[160:163], v124 offset:4096
    ds_read_b128 v[164:167], v125 offset:4096
    ds_read_b128 v[168:171], v126 offset:4096
    ds_read_b128 v[172:175], v127 offset:4096
    ds_read_b64_tr_b16 v[176:177], v128 offset:9216
    ds_read_b64_tr_b16 v[178:179], v128 offset:9792
    ds_read_b64_tr_b16 v[180:181], v129 offset:9216
    ds_read_b64_tr_b16 v[182:183], v129 offset:9792
    s_add_u32 m0, s62, 3072
    s_add_u32 s51, s60, 31744
    buffer_load_dwordx4 v122, s[8:11], s51 offen lds
    s_waitcnt lgkmcnt(12)
    v_dot2c_f32_bf16 v136, s39, v72
    v_dot2c_f32_bf16 v137, s39, v76
    v_dot2c_f32_bf16 v136, s39, v73
    v_dot2c_f32_bf16 v137, s39, v77
    v_dot2c_f32_bf16 v136, s39, v74
    v_dot2c_f32_bf16 v137, s39, v78
    v_dot2c_f32_bf16 v136, s39, v75
    v_dot2c_f32_bf16 v137, s39, v79
    s_waitcnt lgkmcnt(8)
    v_mfma_f32_32x32x16_bf16 v[224:239], v[200:203], v[156:159], v[224:239]
    v_mfma_f32_32x32x16_bf16 v[240:255], v[204:207], v[156:159], v[240:255]
    ds_read_b64_tr_b16 v[184:185], v128 offset:11520
    ds_read_b64_tr_b16 v[186:187], v128 offset:12096
    ds_read_b64_tr_b16 v[188:189], v129 offset:11520
    ds_read_b64_tr_b16 v[190:191], v129 offset:12096
    ds_read_b64_tr_b16 v[80:81], v130 offset:18432
    ds_read_b64_tr_b16 v[82:83], v130 offset:19008
    ds_read_b64_tr_b16 v[84:85], v131 offset:18432
    ds_read_b64_tr_b16 v[86:87], v131 offset:19008
    s_waitcnt lgkmcnt(8)
    v_mfma_f32_32x32x16_bf16 v[224:239], v[176:179], v[160:163], v[224:239]
    v_mfma_f32_32x32x16_bf16 v[240:255], v[180:183], v[160:163], v[240:255]
    ds_read_b64_tr_b16 v[192:193], v128 offset:13824
    ds_read_b64_tr_b16 v[194:195], v128 offset:14400
    ds_read_b64_tr_b16 v[196:197], v129 offset:13824
    ds_read_b64_tr_b16 v[198:199], v129 offset:14400
    s_add_u32 m0, s62, 4096
    s_add_u32 s51, s60, 1152
    buffer_load_dwordx4 v121, s[8:11], s51 offen lds
    s_add_u32 m0, s62, 5120
    s_add_u32 s51, s60, 11392
    buffer_load_dwordx4 v122, s[8:11], s51 offen lds
    s_waitcnt lgkmcnt(8)
    v_mfma_f32_32x32x16_bf16 v[224:239], v[184:187], v[164:167], v[224:239]
    v_mfma_f32_32x32x16_bf16 v[240:255], v[188:191], v[164:167], v[240:255]
    ds_read_b64_tr_b16 v[200:201], v128 offset:16128
    ds_read_b64_tr_b16 v[202:203], v128 offset:16704
    ds_read_b64_tr_b16 v[204:205], v129 offset:16128
    ds_read_b64_tr_b16 v[206:207], v129 offset:16704
    s_add_u32 m0, s62, 6144
    s_add_u32 s51, s60, 21632
    buffer_load_dwordx4 v121, s[8:11], s51 offen lds
    s_waitcnt lgkmcnt(8)
    v_dot2c_f32_bf16 v136, s39, v80
    v_dot2c_f32_bf16 v137, s39, v84
    v_dot2c_f32_bf16 v136, s39, v81
    v_dot2c_f32_bf16 v137, s39, v85
    v_dot2c_f32_bf16 v136, s39, v82
    v_dot2c_f32_bf16 v137, s39, v86
    v_dot2c_f32_bf16 v136, s39, v83
    v_dot2c_f32_bf16 v137, s39, v87
    s_waitcnt vmcnt(3) lgkmcnt(4)
    s_barrier
    v_mfma_f32_32x32x16_bf16 v[224:239], v[192:195], v[168:171], v[224:239]
    v_mfma_f32_32x32x16_bf16 v[240:255], v[196:199], v[168:171], v[240:255]
    ds_read_b128 v[144:147], v124 offset:0
    ds_read_b128 v[148:151], v125 offset:0
    ds_read_b128 v[152:155], v126 offset:0
    ds_read_b128 v[156:159], v127 offset:0
    ds_read_b64_tr_b16 v[176:177], v128 offset:18432
    ds_read_b64_tr_b16 v[178:179], v128 offset:19008
    ds_read_b64_tr_b16 v[180:181], v129 offset:18432
    ds_read_b64_tr_b16 v[182:183], v129 offset:19008
    s_add_u32 m0, s62, 7168
    s_add_u32 s51, s60, 31872
    buffer_load_dwordx4 v122, s[8:11], s51 offen lds
    v_cmp_eq_u32 vcc, 0, v132
    s_cbranch_vccnz Lst_12
Lst_13:
    s_waitcnt lgkmcnt(8)
    v_mfma_f32_32x32x16_bf16 v[224:239], v[200:203], v[172:175], v[224:239]
    v_mfma_f32_32x32x16_bf16 v[240:255], v[204:207], v[172:175], v[240:255]
    ds_read_b64_tr_b16 v[184:185], v128 offset:20736
    ds_read_b64_tr_b16 v[186:187], v128 offset:21312
    ds_read_b64_tr_b16 v[188:189], v129 offset:20736
    ds_read_b64_tr_b16 v[190:191], v129 offset:21312
    s_lshl_b32 s44, s26, 8
    s_add_u32 s44, s44, 157952
    v_permlane32_swap_b32 v136, v137
    v_add_f32 v136, v136, v137
    v_add_u32 v139, s44, v14
    ds_write_b32 v139, v136
    v_add_u32 v139, 157952, v14
    v_add_u32 v138, 161792, v14
    s_waitcnt lgkmcnt(5)
    v_mfma_f32_32x32x16_bf16 v[224:239], v[176:179], v[144:147], v[224:239]
    v_mfma_f32_32x32x16_bf16 v[240:255], v[180:183], v[144:147], v[240:255]
    ds_read_b64_tr_b16 v[192:193], v128 offset:23040
    ds_read_b64_tr_b16 v[194:195], v128 offset:23616
    ds_read_b64_tr_b16 v[196:197], v129 offset:23040
    ds_read_b64_tr_b16 v[198:199], v129 offset:23616
    s_waitcnt lgkmcnt(5)
    v_mfma_f32_32x32x16_bf16 v[224:239], v[184:187], v[148:151], v[224:239]
    v_mfma_f32_32x32x16_bf16 v[240:255], v[188:191], v[148:151], v[240:255]
    ds_read_b64_tr_b16 v[200:201], v128 offset:25344
    ds_read_b64_tr_b16 v[202:203], v128 offset:25920
    ds_read_b64_tr_b16 v[204:205], v129 offset:25344
    ds_read_b64_tr_b16 v[206:207], v129 offset:25920
    s_waitcnt vmcnt(0) lgkmcnt(4)
    s_barrier
    v_mfma_f32_32x32x16_bf16 v[224:239], v[192:195], v[152:155], v[224:239]
    v_mfma_f32_32x32x16_bf16 v[240:255], v[196:199], v[152:155], v[240:255]
    ds_read_b128 v[160:163], v124 offset:4096
    ds_read_b128 v[164:167], v125 offset:4096
    ds_read_b128 v[168:171], v126 offset:4096
    ds_read_b128 v[172:175], v127 offset:4096
    ds_read_b64_tr_b16 v[176:177], v128 offset:27648
    ds_read_b64_tr_b16 v[178:179], v128 offset:28224
    ds_read_b64_tr_b16 v[180:181], v129 offset:27648
    ds_read_b64_tr_b16 v[182:183], v129 offset:28224
    s_cmp_ge_u32 s26, 4
    s_cbranch_scc1 Lri_14
    v_and_b32 v112, 15, v1
    v_mul_u32_u24 v112, 1280, v112
    v_lshrrev_b32 v113, 4, v1
    v_lshl_add_u32 v114, v113, 3, v112
    v_lshl_add_u32 v112, v113, 4, v112
    s_mul_i32 s44, s31, 20480
    s_mul_i32 s45, s33, 160
    s_add_u32 s44, s44, s45
    buffer_load_dwordx4 v[18:21], v112, s[8:11], s44 offen
    buffer_load_dwordx4 v[22:25], v112, s[8:11], s44 offen offset:64
    buffer_load_dwordx2 v[26:27], v114, s[8:11], s44 offen offset:128
Lri_14:
    s_sub_u32 s44, s40, 768
    s_cmp_ge_u32 s44, 96
    s_cbranch_scc1 Lrc_15
    s_call_b64 s[70:71], L_ri
Lrc_15:
    s_waitcnt lgkmcnt(8)
    v_mfma_f32_32x32x16_bf16 v[224:239], v[200:203], v[156:159], v[224:239]
    v_mfma_f32_32x32x16_bf16 v[240:255], v[204:207], v[156:159], v[240:255]
    ds_read_b64_tr_b16 v[184:185], v128 offset:29952
    ds_read_b64_tr_b16 v[186:187], v128 offset:30528
    ds_read_b64_tr_b16 v[188:189], v129 offset:29952
    ds_read_b64_tr_b16 v[190:191], v129 offset:30528
    s_waitcnt lgkmcnt(4)
    v_mfma_f32_32x32x16_bf16 v[224:239], v[176:179], v[160:163], v[224:239]
    v_mfma_f32_32x32x16_bf16 v[240:255], v[180:183], v[160:163], v[240:255]
    ds_read_b64_tr_b16 v[192:193], v128 offset:32256
    ds_read_b64_tr_b16 v[194:195], v128 offset:32832
    ds_read_b64_tr_b16 v[196:197], v129 offset:32256
    ds_read_b64_tr_b16 v[198:199], v129 offset:32832
    ds_read_b32 v208, v139 offset:0
    ds_read_b32 v209, v139 offset:256
    ds_read_b32 v210, v139 offset:512
    ds_read_b32 v211, v139 offset:768
    ds_read_b32 v212, v139 offset:1024
    ds_read_b32 v213, v139 offset:1280
    ds_read_b32 v214, v139 offset:1536
    ds_read_b32 v215, v139 offset:1792
    s_waitcnt lgkmcnt(12)
    v_mfma_f32_32x32x16_bf16 v[224:239], v[184:187], v[164:167], v[224:239]
    v_mfma_f32_32x32x16_bf16 v[240:255], v[188:191], v[164:167], v[240:255]
    ds_read_b64_tr_b16 v[200:201], v128 offset:34560
    ds_read_b64_tr_b16 v[202:203], v128 offset:35136
    ds_read_b64_tr_b16 v[204:205], v129 offset:34560
    ds_read_b64_tr_b16 v[206:207], v129 offset:35136
    s_waitcnt lgkmcnt(12)
    s_barrier
    v_mfma_f32_32x32x16_bf16 v[224:239], v[192:195], v[168:171], v[224:239]
    v_mfma_f32_32x32x16_bf16 v[240:255], v[196:199], v[168:171], v[240:255]
    s_waitcnt lgkmcnt(4)
    v_add_f32 v208, v208, v209
    v_add_f32 v208, v208, v210
    v_add_f32 v208, v208, v211
    v_add_f32 v208, v208, v212
    v_add_f32 v208, v208, v213
    v_add_f32 v208, v208, v214
    v_add_f32 v208, v208, v215
    ds_write_b32 v138, v208
    s_waitcnt lgkmcnt(1)
    v_mfma_f32_32x32x16_bf16 v[224:239], v[200:203], v[172:175], v[224:239]
    v_mfma_f32_32x32x16_bf16 v[240:255], v[204:207], v[172:175], v[240:255]
    v_lshlrev_b32 v7, 4, v5
    v_add_u32 v7, 161792, v7
    ds_read_b128 v[192:195], v7 offset:0
    ds_read_b128 v[196:199], v7 offset:32
    ds_read_b128 v[200:203], v7 offset:64
    ds_read_b128 v[204:207], v7 offset:96
    ds_read_b128 v[208:211], v7 offset:128
    ds_read_b128 v[212:215], v7 offset:160
    ds_read_b128 v[216:219], v7 offset:192
    ds_read_b128 v[220:223], v7 offset:224
    v_mul_f32 v134, 0x3ea52b5c, v132
    v_mul_f32 v135, 0x3ea52b5c, v133
    s_mul_i32 s46, s35, 2688
    s_add_u32 s46, s46, s38
    s_lshl_b32 s47, s24, 9
    s_add_u32 s47, s47, s91
    s_and_b32 s44, s26, 4
    s_add_u32 s47, s47, s44
    s_add_u32 s45, s27, 1
    v_mov_b32 v126, 0
    v_mov_b32 v127, s45
    s_mul_i32 s44, s36, 5
    s_lshr_b32 s44, s44, 2
    s_add_u32 s44, s44, 65536
    v_add_u32 v128, s44, v2
    v_lshl_add_u32 v129, v46, 1, s44
    v_add_u32 v7, s90, v2
    s_waitcnt lgkmcnt(0)
    v_mul_f32 v192, v133, v192
    v_mul_f32 v193, v133, v193
    v_mul_f32 v194, v133, v194
    v_mul_f32 v195, v133, v195
    v_mul_f32 v196, v133, v196
    v_mul_f32 v197, v133, v197
    v_mul_f32 v198, v133, v198
    v_mul_f32 v199, v133, v199
    v_mul_f32 v200, v133, v200
    v_mul_f32 v201, v133, v201
    v_mul_f32 v202, v133, v202
    v_mul_f32 v203, v133, v203
    v_mul_f32 v204, v133, v204
    v_mul_f32 v205, v133, v205
    v_mul_f32 v206, v133, v206
    v_mul_f32 v207, v133, v207
    v_mul_f32 v208, v133, v208
    v_mul_f32 v209, v133, v209
    v_mul_f32 v210, v133, v210
    v_mul_f32 v211, v133, v211
    v_mul_f32 v212, v135, v212
    v_mul_f32 v213, v135, v213
    v_mul_f32 v214, v135, v214
    v_mul_f32 v215, v135, v215
    v_mul_f32 v216, v135, v216
    v_mul_f32 v217, v135, v217
    v_mul_f32 v218, v135, v218
    v_mul_f32 v219, v135, v219
    v_mul_f32 v220, v135, v220
    v_mul_f32 v221, v135, v221
    v_mul_f32 v222, v135, v222
    v_mul_f32 v223, v135, v223
    s_cmp_lt_u32 s26, 4
    s_cbranch_scc1 Lep_16
    s_bitcmp1_b32 s30, 0
    s_mov_b32 s99, 0x76543210
    s_cmov_b32 s99, 0x76543210
    v_and_b32 v8, 28, v46
    v_bfe_u32 v8, s99, v8, 3
    v_xor_b32 v8, s24, v8
    v_lshlrev_b32 v8, 9, v8
    v_lshl_add_u32 v8, v5, 2, v8
    v_mov_b32 v9, 0
Lep_16:
L_epi1:
    v_pk_fma_f32 v[224:225], v[224:225], v[132:133], v[192:193] op_sel_hi:[1,0,1]
    v_pk_fma_f32 v[226:227], v[226:227], v[132:133], v[194:195] op_sel_hi:[1,0,1]
    v_pk_fma_f32 v[228:229], v[228:229], v[132:133], v[196:197] op_sel_hi:[1,0,1]
    v_pk_fma_f32 v[230:231], v[230:231], v[132:133], v[198:199] op_sel_hi:[1,0,1]
    v_pk_fma_f32 v[232:233], v[232:233], v[132:133], v[200:201] op_sel_hi:[1,0,1]
    v_pk_fma_f32 v[234:235], v[234:235], v[132:133], v[202:203] op_sel_hi:[1,0,1]
    v_pk_fma_f32 v[236:237], v[236:237], v[132:133], v[204:205] op_sel_hi:[1,0,1]
    v_pk_fma_f32 v[238:239], v[238:239], v[132:133], v[206:207] op_sel_hi:[1,0,1]
    v_pk_fma_f32 v[240:241], v[240:241], v[132:133], v[208:209] op_sel_hi:[1,0,1]
    v_pk_fma_f32 v[242:243], v[242:243], v[132:133], v[210:211] op_sel_hi:[1,0,1]
    v_cvt_pk_bf16_f32 v196, v232, v233
    v_cvt_pk_bf16_f32 v197, v234, v235
    v_cvt_pk_bf16_f32 v198, v236, v237
    v_cvt_pk_bf16_f32 v199, v238, v239
    v_cvt_pk_bf16_f32 v200, v240, v241
    v_cvt_pk_bf16_f32 v201, v242, v243
    v_cvt_pk_bf16_f32 v192, v224, v225
    v_cvt_pk_bf16_f32 v193, v226, v227
    v_cvt_pk_bf16_f32 v194, v228, v229
    v_cvt_pk_bf16_f32 v195, v230, v231
    v_pk_fma_f32 v[244:245], v[244:245], v[134:135], v[212:213] op_sel_hi:[1,0,1]
    v_pk_fma_f32 v[246:247], v[246:247], v[134:135], v[214:215] op_sel_hi:[1,0,1]
    v_pk_fma_f32 v[248:249], v[248:249], v[134:135], v[216:217] op_sel_hi:[1,0,1]
    v_pk_fma_f32 v[250:251], v[250:251], v[134:135], v[218:219] op_sel_hi:[1,0,1]
    v_pk_fma_f32 v[252:253], v[252:253], v[134:135], v[220:221] op_sel_hi:[1,0,1]
    v_pk_fma_f32 v[254:255], v[254:255], v[134:135], v[222:223] op_sel_hi:[1,0,1]
    v_mfma_f32_32x32x16_bf16 v[160:175], v[196:199], v[28:31], 0
    v_mfma_f32_32x32x8_bf16 v[160:175], v[200:201], v[32:33], v[160:175]
    ds_write_b128 v36, v[192:195] offset:20992
    s_mov_b32 exec_hi, 0
    ds_write_b64 v37, v[200:201] offset:23360
    s_mov_b64 exec, -1
    v_cvt_pk_bf16_f32 v140, v244, v245
    v_cvt_pk_bf16_f32 v141, v246, v247
    v_cvt_pk_bf16_f32 v136, v248, v249
    v_cvt_pk_bf16_f32 v137, v250, v251
    v_cvt_pk_bf16_f32 v138, v252, v253
    v_cvt_pk_bf16_f32 v139, v254, v255
    s_nop 1
    v_cvt_pk_bf16_f32 v204, v160, v161
    v_cvt_pk_bf16_f32 v205, v162, v163
    v_cvt_pk_bf16_f32 v206, v164, v165
    v_cvt_pk_bf16_f32 v207, v166, v167
    v_cvt_pk_bf16_f32 v208, v168, v169
    v_cvt_pk_bf16_f32 v209, v170, v171
    v_cvt_pk_bf16_f32 v210, v172, v173
    v_cvt_pk_bf16_f32 v211, v174, v175
    v_or_b32 v204, v204, v34
    v_or_b32 v205, v205, v34
    v_or_b32 v206, v206, v34
    v_or_b32 v207, v207, v34
    v_or_b32 v208, v208, v34
    v_or_b32 v209, v209, v34
    v_or_b32 v210, v210, v34
    v_or_b32 v211, v211, v34
    s_mov_b32 exec_lo, 0x1fffff
    s_mov_b32 exec_hi, 0x1fffff
    ds_write_b128 v38, v[204:207] offset:22016
    ds_write_b128 v38, v[208:211] offset:22688
    s_mov_b64 exec, -1
    s_cmp_ge_u32 s26, 4
    s_cbranch_scc1 L_att_helper
    ds_read_b128 v[212:215], v7 offset:20992
    ds_read_b128 v[216:219], v7 offset:22016
    ds_read_b128 v[220:223], v7 offset:23040
    v_cmp_lt_u32 vcc, 80, v46
    s_movk_i32 s44, 96
    v_cmp_ne_u32 s[52:53], s44, v46
    v_mov_b32 v124, 0x30000
    s_and_b64 vcc, vcc, s[52:53]
    s_mov_b64 s[100:101], -1
    s_setprio 1
    v_cndmask_b32 v124, v40, v124, vcc
    v_mov_b32 v88, 0
    v_mov_b32 v89, 0
    v_mov_b32 v90, 0
    v_mov_b32 v91, 0
    v_mov_b32 v92, 0
    v_mov_b32 v93, 0
    v_mov_b32 v94, 0
    v_mov_b32 v95, 0
    v_mov_b32 v96, 0
    v_mov_b32 v97, 0
    v_mov_b32 v98, 0
    v_mov_b32 v99, 0
    v_mov_b32 v100, 0
    v_mov_b32 v101, 0
    v_mov_b32 v102, 0
    v_mov_b32 v103, 0
    s_waitcnt lgkmcnt(2)
    buffer_store_dwordx4 v[212:215], v2, s[4:7], s46 offen offset:0 sc1
    s_waitcnt lgkmcnt(1)
    buffer_store_dwordx4 v[216:219], v2, s[4:7], s46 offen offset:1024 sc1
    s_waitcnt lgkmcnt(0)
    s_mov_b32 exec_hi, 0xff
    buffer_store_dwordx4 v[220:223], v2, s[4:7], s46 offen offset:2048 sc1
    s_mov_b32 exec_hi, -1
    v_mov_b32 v104, 0
    v_mov_b32 v105, 0
    v_mov_b32 v106, 0
    v_mov_b32 v107, 0
    v_mov_b32 v108, 0
    v_mov_b32 v109, 0
    v_mov_b32 v110, 0
    v_mov_b32 v111, 0
    v_mov_b32 v112, 0
    v_mov_b32 v113, 0
    v_mov_b32 v114, 0
    v_mov_b32 v115, 0
    v_mov_b32 v116, 0
    v_mov_b32 v117, 0
    v_mov_b32 v118, 0
    v_mov_b32 v119, 0
    s_cmp_eq_u32 s27, 0
    s_cbranch_scc1 Lres_17
Lres_18:
    s_waitcnt lgkmcnt(0)
    s_barrier
    ds_read_b128 v[144:147], v2 offset:20992
    ds_read_b128 v[120:123], v128
    ds_read_b64 v[142:143], v39 offset:23360
    s_mov_b32 exec_lo, 0
    ds_read_b64 v[140:141], v129 offset:1024
    s_mov_b32 exec_lo, -1
    ds_read_b128 v[148:151], v2 offset:23616
    ds_read_b128 v[224:227], v124 offset:22016
    ds_read_b128 v[232:235], v124 offset:22688
    s_waitcnt lgkmcnt(6)
    v_mfma_f32_32x32x16_bf16 v[160:175], v[144:147], v[136:139], 0
    s_waitcnt lgkmcnt(5)
    v_mfma_f32_32x32x16_bf16 v[176:191], v[144:147], v[120:123], 0
    s_waitcnt lgkmcnt(3)
    s_nop 8
    v_mfma_f32_32x32x4_2b_bf16 v[160:191], v[142:143], v[140:141], v[160:191] cbsz:1 abid:0
    v_mov_b32 v130, 163328
    s_waitcnt lgkmcnt(0)
    s_nop 15
.p2align 3
    v_mfma_f32_32x32x16_bf16 v[192:207], v[148:151], v[136:139], 0
    ds_read_b128 v[144:147], v2 offset:26240
    v_exp_f32 v160, v160
    v_exp_f32 v161, v161
    v_exp_f32 v162, v162
    ds_read_b128 v[236:239], v124 offset:25312
    v_exp_f32 v163, v163
    v_exp_f32 v164, v164
    v_exp_f32 v165, v165
    v_mfma_f32_32x32x16_bf16 v[208:223], v[148:151], v[120:123], 0
    ds_read_b128 v[228:231], v124 offset:24640
    v_exp_f32 v166, v166
    v_exp_f32 v167, v167
    v_exp_f32 v168, v168
    v_exp_f32 v169, v169
    v_smfmac_f32_32x32x32_bf16 v[88:103], v[224:227], v[160:167], v35
    v_exp_f32 v170, v170
    v_exp_f32 v171, v171
    v_exp_f32 v172, v172
    v_exp_f32 v173, v173
    v_mfma_f32_32x32x4_2b_bf16 v[192:223], v[142:143], v[140:141], v[192:223] cbsz:1 abid:1
    ds_read_b64 v[142:143], v39 offset:28608
    v_exp_f32 v174, v174
    v_exp_f32 v175, v175
    v_exp_f32 v176, v176
    v_exp_f32 v177, v177
    v_exp_f32 v178, v178
    v_exp_f32 v179, v179
    v_exp_f32 v180, v180
    v_exp_f32 v181, v181
    v_smfmac_f32_32x32x32_bf16 v[88:103], v[232:235], v[168:175], v35
    v_exp_f32 v182, v182
    v_exp_f32 v183, v183
    v_exp_f32 v184, v184
    v_exp_f32 v185, v185
    v_exp_f32 v186, v186
    v_smfmac_f32_32x32x32_bf16 v[104:119], v[224:227], v[176:183], v35
    s_waitcnt lgkmcnt(0)
    v_exp_f32 v187, v187
    v_exp_f32 v188, v188
    v_exp_f32 v189, v189
    v_exp_f32 v190, v190
    v_exp_f32 v191, v191
    v_mfma_f32_32x32x16_bf16 v[160:175], v[144:147], v[136:139], 0
    ds_read_b128 v[148:151], v2 offset:28864
    v_exp_f32 v192, v192
    v_exp_f32 v193, v193
    v_exp_f32 v194, v194
    v_smfmac_f32_32x32x32_bf16 v[104:119], v[232:235], v[184:191], v35
    ds_read_b128 v[232:235], v124 offset:27936
    v_exp_f32 v195, v195
    v_exp_f32 v196, v196
    v_exp_f32 v197, v197
    v_mfma_f32_32x32x16_bf16 v[176:191], v[144:147], v[120:123], 0
    ds_read_b128 v[224:227], v124 offset:27264
    v_exp_f32 v198, v198
    v_exp_f32 v199, v199
    v_exp_f32 v200, v200
    v_exp_f32 v201, v201
    v_smfmac_f32_32x32x32_bf16 v[88:103], v[228:231], v[192:199], v35
    v_exp_f32 v202, v202
    v_exp_f32 v203, v203
    v_exp_f32 v204, v204
    v_exp_f32 v205, v205
    v_mfma_f32_32x32x4_2b_bf16 v[160:191], v[142:143], v[140:141], v[160:191] cbsz:1 abid:0
    s_waitcnt vmcnt(0)
    s_mov_b64 exec, 1
    buffer_store_dword v127, v126, s[4:7], s47 offen sc1
    s_mov_b64 exec, -1
    v_exp_f32 v206, v206
    v_exp_f32 v207, v207
    v_exp_f32 v208, v208
    v_exp_f32 v209, v209
    v_exp_f32 v210, v210
    v_exp_f32 v211, v211
    v_exp_f32 v212, v212
    v_exp_f32 v213, v213
    v_smfmac_f32_32x32x32_bf16 v[88:103], v[236:239], v[200:207], v35
    v_exp_f32 v214, v214
    v_exp_f32 v215, v215
    v_exp_f32 v216, v216
    v_exp_f32 v217, v217
    v_exp_f32 v218, v218
    v_smfmac_f32_32x32x32_bf16 v[104:119], v[228:231], v[208:215], v35
    s_waitcnt lgkmcnt(0)
    v_exp_f32 v219, v219
    v_exp_f32 v220, v220
    v_exp_f32 v221, v221
    v_exp_f32 v222, v222
    v_exp_f32 v223, v223
    v_mfma_f32_32x32x16_bf16 v[192:207], v[148:151], v[136:139], 0
    ds_read_b128 v[144:147], v2 offset:31488
    v_exp_f32 v160, v160
    v_exp_f32 v161, v161
    v_exp_f32 v162, v162
    v_smfmac_f32_32x32x32_bf16 v[104:119], v[236:239], v[216:223], v35
    ds_read_b128 v[236:239], v124 offset:30560
    v_exp_f32 v163, v163
    v_exp_f32 v164, v164
    v_exp_f32 v165, v165
    v_mfma_f32_32x32x16_bf16 v[208:223], v[148:151], v[120:123], 0
    ds_read_b128 v[228:231], v124 offset:29888
    v_exp_f32 v166, v166
    v_exp_f32 v167, v167
    v_exp_f32 v168, v168
    v_exp_f32 v169, v169
    v_smfmac_f32_32x32x32_bf16 v[88:103], v[224:227], v[160:167], v35
    v_exp_f32 v170, v170
    v_exp_f32 v171, v171
    v_exp_f32 v172, v172
    v_exp_f32 v173, v173
    v_mfma_f32_32x32x4_2b_bf16 v[192:223], v[142:143], v[140:141], v[192:223] cbsz:1 abid:1
    ds_read_b64 v[142:143], v39 offset:33856
    v_exp_f32 v174, v174
    v_exp_f32 v175, v175
    v_exp_f32 v176, v176
    v_exp_f32 v177, v177
    v_exp_f32 v178, v178
    v_exp_f32 v179, v179
    v_exp_f32 v180, v180
    v_exp_f32 v181, v181
    v_smfmac_f32_32x32x32_bf16 v[88:103], v[232:235], v[168:175], v35
    v_exp_f32 v182, v182
    v_exp_f32 v183, v183
    v_exp_f32 v184, v184
    v_exp_f32 v185, v185
    v_exp_f32 v186, v186
    v_smfmac_f32_32x32x32_bf16 v[104:119], v[224:227], v[176:183], v35
    s_waitcnt lgkmcnt(0)
    v_exp_f32 v187, v187
    v_exp_f32 v188, v188
    v_exp_f32 v189, v189
    v_exp_f32 v190, v190
    v_exp_f32 v191, v191
    v_mfma_f32_32x32x16_bf16 v[160:175], v[144:147], v[136:139], 0
    ds_read_b128 v[148:151], v2 offset:34112
    v_exp_f32 v192, v192
    v_exp_f32 v193, v193
    v_exp_f32 v194, v194
    v_smfmac_f32_32x32x32_bf16 v[104:119], v[232:235], v[184:191], v35
    ds_read_b128 v[232:235], v124 offset:33184
    v_exp_f32 v195, v195
    v_exp_f32 v196, v196
    v_exp_f32 v197, v197
    v_mfma_f32_32x32x16_bf16 v[176:191], v[144:147], v[120:123], 0
    ds_read_b128 v[224:227], v124 offset:32512
    v_exp_f32 v198, v198
    v_exp_f32 v199, v199
    v_exp_f32 v200, v200
    v_exp_f32 v201, v201
    v_smfmac_f32_32x32x32_bf16 v[88:103], v[228:231], v[192:199], v35
    v_exp_f32 v202, v202
    v_exp_f32 v203, v203
    v_exp_f32 v204, v204
    v_exp_f32 v205, v205
    v_mfma_f32_32x32x4_2b_bf16 v[160:191], v[142:143], v[140:141], v[160:191] cbsz:1 abid:0
    v_exp_f32 v206, v206
    v_exp_f32 v207, v207
    v_exp_f32 v208, v208
    v_exp_f32 v209, v209
    v_exp_f32 v210, v210
    v_exp_f32 v211, v211
    v_exp_f32 v212, v212
    v_exp_f32 v213, v213
    v_smfmac_f32_32x32x32_bf16 v[88:103], v[236:239], v[200:207], v35
    v_exp_f32 v214, v214
    v_exp_f32 v215, v215
    v_exp_f32 v216, v216
    v_exp_f32 v217, v217
    v_exp_f32 v218, v218
    v_smfmac_f32_32x32x32_bf16 v[104:119], v[228:231], v[208:215], v35
    s_waitcnt lgkmcnt(0)
    v_exp_f32 v219, v219
    v_exp_f32 v220, v220
    v_exp_f32 v221, v221
    v_exp_f32 v222, v222
    v_exp_f32 v223, v223
    v_mfma_f32_32x32x16_bf16 v[192:207], v[148:151], v[136:139], 0
    ds_read_b128 v[144:147], v2 offset:36736
    v_exp_f32 v160, v160
    v_exp_f32 v161, v161
    v_exp_f32 v162, v162
    v_smfmac_f32_32x32x32_bf16 v[104:119], v[236:239], v[216:223], v35
    ds_read_b128 v[236:239], v124 offset:35808
    v_exp_f32 v163, v163
    v_exp_f32 v164, v164
    v_exp_f32 v165, v165
    v_mfma_f32_32x32x16_bf16 v[208:223], v[148:151], v[120:123], 0
    ds_read_b128 v[228:231], v124 offset:35136
    v_exp_f32 v166, v166
    v_exp_f32 v167, v167
    v_exp_f32 v168, v168
    v_exp_f32 v169, v169
    v_smfmac_f32_32x32x32_bf16 v[88:103], v[224:227], v[160:167], v35
    v_exp_f32 v170, v170
    v_exp_f32 v171, v171
    v_exp_f32 v172, v172
    v_exp_f32 v173, v173
    v_mfma_f32_32x32x4_2b_bf16 v[192:223], v[142:143], v[140:141], v[192:223] cbsz:1 abid:1
    ds_read_b64 v[142:143], v39 offset:39104
    v_exp_f32 v174, v174
    v_exp_f32 v175, v175
    v_exp_f32 v176, v176
    v_exp_f32 v177, v177
    v_exp_f32 v178, v178
    v_exp_f32 v179, v179
    v_exp_f32 v180, v180
    v_exp_f32 v181, v181
    v_smfmac_f32_32x32x32_bf16 v[88:103], v[232:235], v[168:175], v35
    v_exp_f32 v182, v182
    v_exp_f32 v183, v183
    v_exp_f32 v184, v184
    v_exp_f32 v185, v185
    v_exp_f32 v186, v186
    v_smfmac_f32_32x32x32_bf16 v[104:119], v[224:227], v[176:183], v35
    s_waitcnt lgkmcnt(0)
    v_exp_f32 v187, v187
    v_exp_f32 v188, v188
    v_exp_f32 v189, v189
    v_exp_f32 v190, v190
    v_exp_f32 v191, v191
    v_mfma_f32_32x32x16_bf16 v[160:175], v[144:147], v[136:139], 0
    ds_read_b128 v[148:151], v2 offset:39360
    v_exp_f32 v192, v192
    v_exp_f32 v193, v193
    v_exp_f32 v194, v194
    v_smfmac_f32_32x32x32_bf16 v[104:119], v[232:235], v[184:191], v35
    ds_read_b128 v[232:235], v124 offset:38432
    v_exp_f32 v195, v195
    v_exp_f32 v196, v196
    v_exp_f32 v197, v197
    v_mfma_f32_32x32x16_bf16 v[176:191], v[144:147], v[120:123], 0
    ds_read_b128 v[224:227], v124 offset:37760
    v_exp_f32 v198, v198
    v_exp_f32 v199, v199
    v_exp_f32 v200, v200
    v_exp_f32 v201, v201
    v_smfmac_f32_32x32x32_bf16 v[88:103], v[228:231], v[192:199], v35
    v_exp_f32 v202, v202
    v_exp_f32 v203, v203
    v_exp_f32 v204, v204
    v_exp_f32 v205, v205
    v_mfma_f32_32x32x4_2b_bf16 v[160:191], v[142:143], v[140:141], v[160:191] cbsz:1 abid:0
    v_exp_f32 v206, v206
    v_exp_f32 v207, v207
    v_exp_f32 v208, v208
    v_exp_f32 v209, v209
    v_exp_f32 v210, v210
    v_exp_f32 v211, v211
    v_exp_f32 v212, v212
    v_exp_f32 v213, v213
    v_smfmac_f32_32x32x32_bf16 v[88:103], v[236:239], v[200:207], v35
    v_exp_f32 v214, v214
    v_exp_f32 v215, v215
    v_exp_f32 v216, v216
    v_exp_f32 v217, v217
    v_exp_f32 v218, v218
    v_smfmac_f32_32x32x32_bf16 v[104:119], v[228:231], v[208:215], v35
    s_waitcnt lgkmcnt(0)
    v_exp_f32 v219, v219
    v_exp_f32 v220, v220
    v_exp_f32 v221, v221
    v_exp_f32 v222, v222
    v_exp_f32 v223, v223
    v_mfma_f32_32x32x16_bf16 v[192:207], v[148:151], v[136:139], 0
    s_barrier
    ds_read_b128 v[144:147], v2 offset:41984
    v_exp_f32 v160, v160
    v_exp_f32 v161, v161
    v_exp_f32 v162, v162
    v_smfmac_f32_32x32x32_bf16 v[104:119], v[236:239], v[216:223], v35
    ds_read_b128 v[236:239], v124 offset:41056
    v_exp_f32 v163, v163
    v_exp_f32 v164, v164
    v_exp_f32 v165, v165
    v_mfma_f32_32x32x16_bf16 v[208:223], v[148:151], v[120:123], 0
    ds_read_b128 v[228:231], v124 offset:40384
    v_exp_f32 v166, v166
    v_exp_f32 v167, v167
    v_exp_f32 v168, v168
    v_exp_f32 v169, v169
    v_smfmac_f32_32x32x32_bf16 v[88:103], v[224:227], v[160:167], v35
    v_exp_f32 v170, v170
    v_exp_f32 v171, v171
    v_exp_f32 v172, v172
    v_exp_f32 v173, v173
    v_mfma_f32_32x32x4_2b_bf16 v[192:223], v[142:143], v[140:141], v[192:223] cbsz:1 abid:1
    ds_read_b64 v[142:143], v39 offset:44352
    v_exp_f32 v174, v174
    v_exp_f32 v175, v175
    v_exp_f32 v176, v176
    v_exp_f32 v177, v177
    v_exp_f32 v178, v178
    v_exp_f32 v179, v179
    v_exp_f32 v180, v180
    v_exp_f32 v181, v181
    v_smfmac_f32_32x32x32_bf16 v[88:103], v[232:235], v[168:175], v35
    v_exp_f32 v182, v182
    v_exp_f32 v183, v183
    v_exp_f32 v184, v184
    v_exp_f32 v185, v185
    v_exp_f32 v186, v186
    v_smfmac_f32_32x32x32_bf16 v[104:119], v[224:227], v[176:183], v35
    s_waitcnt lgkmcnt(0)
    v_exp_f32 v187, v187
    v_exp_f32 v188, v188
    v_exp_f32 v189, v189
    v_exp_f32 v190, v190
    v_exp_f32 v191, v191
    v_mfma_f32_32x32x16_bf16 v[160:175], v[144:147], v[136:139], 0
    ds_read_b128 v[148:151], v2 offset:44608
    v_exp_f32 v192, v192
    v_exp_f32 v193, v193
    v_exp_f32 v194, v194
    v_smfmac_f32_32x32x32_bf16 v[104:119], v[232:235], v[184:191], v35
    ds_read_b128 v[232:235], v124 offset:43680
    v_exp_f32 v195, v195
    v_exp_f32 v196, v196
    v_exp_f32 v197, v197
    v_mfma_f32_32x32x16_bf16 v[176:191], v[144:147], v[120:123], 0
    ds_read_b128 v[224:227], v124 offset:43008
    v_exp_f32 v198, v198
    v_exp_f32 v199, v199
    v_exp_f32 v200, v200
    v_exp_f32 v201, v201
    v_smfmac_f32_32x32x32_bf16 v[88:103], v[228:231], v[192:199], v35
    v_exp_f32 v202, v202
    v_exp_f32 v203, v203
    v_exp_f32 v204, v204
    v_exp_f32 v205, v205
    v_mfma_f32_32x32x4_2b_bf16 v[160:191], v[142:143], v[140:141], v[160:191] cbsz:1 abid:0
    v_exp_f32 v206, v206
    v_exp_f32 v207, v207
    v_exp_f32 v208, v208
    v_exp_f32 v209, v209
    v_exp_f32 v210, v210
    v_exp_f32 v211, v211
    v_exp_f32 v212, v212
    v_exp_f32 v213, v213
    v_smfmac_f32_32x32x32_bf16 v[88:103], v[236:239], v[200:207], v35
    v_exp_f32 v214, v214
    v_exp_f32 v215, v215
    v_exp_f32 v216, v216
    v_exp_f32 v217, v217
    v_exp_f32 v218, v218
    v_smfmac_f32_32x32x32_bf16 v[104:119], v[228:231], v[208:215], v35
    s_waitcnt lgkmcnt(0)
    v_exp_f32 v219, v219
    v_exp_f32 v220, v220
    v_exp_f32 v221, v221
    v_exp_f32 v222, v222
    v_exp_f32 v223, v223
    v_mfma_f32_32x32x16_bf16 v[192:207], v[148:151], v[136:139], 0
    ds_read_b128 v[144:147], v2 offset:47232
    v_exp_f32 v160, v160
    v_exp_f32 v161, v161
    v_exp_f32 v162, v162
    v_smfmac_f32_32x32x32_bf16 v[104:119], v[236:239], v[216:223], v35
    ds_read_b128 v[236:239], v124 offset:46304
    v_exp_f32 v163, v163
    v_exp_f32 v164, v164
    v_exp_f32 v165, v165
    v_mfma_f32_32x32x16_bf16 v[208:223], v[148:151], v[120:123], 0
    ds_read_b128 v[228:231], v124 offset:45632
    v_exp_f32 v166, v166
    v_exp_f32 v167, v167
    v_exp_f32 v168, v168
    v_exp_f32 v169, v169
    v_smfmac_f32_32x32x32_bf16 v[88:103], v[224:227], v[160:167], v35
    v_exp_f32 v170, v170
    v_exp_f32 v171, v171
    v_exp_f32 v172, v172
    v_exp_f32 v173, v173
    v_mfma_f32_32x32x4_2b_bf16 v[192:223], v[142:143], v[140:141], v[192:223] cbsz:1 abid:1
    ds_read_b64 v[142:143], v39 offset:49600
    v_exp_f32 v174, v174
    v_exp_f32 v175, v175
    v_exp_f32 v176, v176
    v_exp_f32 v177, v177
    v_exp_f32 v178, v178
    v_exp_f32 v179, v179
    v_exp_f32 v180, v180
    v_exp_f32 v181, v181
    v_smfmac_f32_32x32x32_bf16 v[88:103], v[232:235], v[168:175], v35
    v_exp_f32 v182, v182
    v_exp_f32 v183, v183
    v_exp_f32 v184, v184
    v_exp_f32 v185, v185
    v_exp_f32 v186, v186
    v_smfmac_f32_32x32x32_bf16 v[104:119], v[224:227], v[176:183], v35
    s_waitcnt lgkmcnt(0)
    v_exp_f32 v187, v187
    v_exp_f32 v188, v188
    v_exp_f32 v189, v189
    v_exp_f32 v190, v190
    v_exp_f32 v191, v191
    v_mfma_f32_32x32x16_bf16 v[160:175], v[144:147], v[136:139], 0
    ds_read_b128 v[148:151], v2 offset:49856
    v_exp_f32 v192, v192
    v_exp_f32 v193, v193
    v_exp_f32 v194, v194
    v_smfmac_f32_32x32x32_bf16 v[104:119], v[232:235], v[184:191], v35
    ds_read_b128 v[232:235], v124 offset:48928
    v_exp_f32 v195, v195
    v_exp_f32 v196, v196
    v_exp_f32 v197, v197
    v_mfma_f32_32x32x16_bf16 v[176:191], v[144:147], v[120:123], 0
    ds_read_b128 v[224:227], v124 offset:48256
    v_exp_f32 v198, v198
    v_exp_f32 v199, v199
    v_exp_f32 v200, v200
    v_exp_f32 v201, v201
    v_smfmac_f32_32x32x32_bf16 v[88:103], v[228:231], v[192:199], v35
    v_exp_f32 v202, v202
    v_exp_f32 v203, v203
    v_exp_f32 v204, v204
    v_exp_f32 v205, v205
    v_mfma_f32_32x32x4_2b_bf16 v[160:191], v[142:143], v[140:141], v[160:191] cbsz:1 abid:0
    v_exp_f32 v206, v206
    v_exp_f32 v207, v207
    v_exp_f32 v208, v208
    v_exp_f32 v209, v209
    v_exp_f32 v210, v210
    v_exp_f32 v211, v211
    v_exp_f32 v212, v212
    v_exp_f32 v213, v213
    v_smfmac_f32_32x32x32_bf16 v[88:103], v[236:239], v[200:207], v35
    v_exp_f32 v214, v214
    v_exp_f32 v215, v215
    v_exp_f32 v216, v216
    v_exp_f32 v217, v217
    v_exp_f32 v218, v218
    v_smfmac_f32_32x32x32_bf16 v[104:119], v[228:231], v[208:215], v35
    s_waitcnt lgkmcnt(0)
    v_exp_f32 v219, v219
    v_exp_f32 v220, v220
    v_exp_f32 v221, v221
    v_exp_f32 v222, v222
    v_exp_f32 v223, v223
    v_mfma_f32_32x32x16_bf16 v[192:207], v[148:151], v[136:139], 0
    s_barrier
    ds_read_b128 v[144:147], v2 offset:52480
    v_exp_f32 v160, v160
    v_exp_f32 v161, v161
    v_exp_f32 v162, v162
    v_smfmac_f32_32x32x32_bf16 v[104:119], v[236:239], v[216:223], v35
    ds_read_b128 v[236:239], v124 offset:51552
    v_exp_f32 v163, v163
    v_exp_f32 v164, v164
    v_exp_f32 v165, v165
    v_mfma_f32_32x32x16_bf16 v[208:223], v[148:151], v[120:123], 0
    ds_read_b128 v[228:231], v124 offset:50880
    v_exp_f32 v166, v166
    v_exp_f32 v167, v167
    v_exp_f32 v168, v168
    v_exp_f32 v169, v169
    v_smfmac_f32_32x32x32_bf16 v[88:103], v[224:227], v[160:167], v35
    v_exp_f32 v170, v170
    v_exp_f32 v171, v171
    v_exp_f32 v172, v172
    v_exp_f32 v173, v173
    v_mfma_f32_32x32x4_2b_bf16 v[192:223], v[142:143], v[140:141], v[192:223] cbsz:1 abid:1
    ds_read_b64 v[142:143], v39 offset:54848
    v_exp_f32 v174, v174
    v_exp_f32 v175, v175
    v_exp_f32 v176, v176
    v_exp_f32 v177, v177
    v_exp_f32 v178, v178
    v_exp_f32 v179, v179
    v_exp_f32 v180, v180
    v_exp_f32 v181, v181
    v_smfmac_f32_32x32x32_bf16 v[88:103], v[232:235], v[168:175], v35
    v_exp_f32 v182, v182
    v_exp_f32 v183, v183
    v_exp_f32 v184, v184
    v_exp_f32 v185, v185
    v_exp_f32 v186, v186
    v_smfmac_f32_32x32x32_bf16 v[104:119], v[224:227], v[176:183], v35
    s_waitcnt lgkmcnt(0)
    v_exp_f32 v187, v187
    v_exp_f32 v188, v188
    v_exp_f32 v189, v189
    v_exp_f32 v190, v190
    v_exp_f32 v191, v191
    v_mfma_f32_32x32x16_bf16 v[160:175], v[144:147], v[136:139], 0
    ds_read_b128 v[148:151], v2 offset:55104
    v_exp_f32 v192, v192
    v_exp_f32 v193, v193
    v_exp_f32 v194, v194
    v_smfmac_f32_32x32x32_bf16 v[104:119], v[232:235], v[184:191], v35
    ds_read_b128 v[232:235], v124 offset:54176
    v_exp_f32 v195, v195
    v_exp_f32 v196, v196
    v_exp_f32 v197, v197
    v_mfma_f32_32x32x16_bf16 v[176:191], v[144:147], v[120:123], 0
    ds_read_b128 v[224:227], v124 offset:53504
    v_exp_f32 v198, v198
    v_exp_f32 v199, v199
    v_exp_f32 v200, v200
    v_exp_f32 v201, v201
    v_smfmac_f32_32x32x32_bf16 v[88:103], v[228:231], v[192:199], v35
    v_exp_f32 v202, v202
    v_exp_f32 v203, v203
    v_exp_f32 v204, v204
    v_exp_f32 v205, v205
    v_mfma_f32_32x32x4_2b_bf16 v[160:191], v[142:143], v[140:141], v[160:191] cbsz:1 abid:0
    v_exp_f32 v206, v206
    v_exp_f32 v207, v207
    v_exp_f32 v208, v208
    v_exp_f32 v209, v209
    v_exp_f32 v210, v210
    v_exp_f32 v211, v211
    v_exp_f32 v212, v212
    v_exp_f32 v213, v213
    v_smfmac_f32_32x32x32_bf16 v[88:103], v[236:239], v[200:207], v35
    v_exp_f32 v214, v214
    v_exp_f32 v215, v215
    v_exp_f32 v216, v216
    v_exp_f32 v217, v217
    v_exp_f32 v218, v218
    v_smfmac_f32_32x32x32_bf16 v[104:119], v[228:231], v[208:215], v35
    s_waitcnt lgkmcnt(0)
    v_exp_f32 v219, v219
    v_exp_f32 v220, v220
    v_exp_f32 v221, v221
    v_exp_f32 v222, v222
    v_exp_f32 v223, v223
    v_mfma_f32_32x32x16_bf16 v[192:207], v[148:151], v[136:139], 0
    ds_read_b128 v[144:147], v2 offset:57728
    v_exp_f32 v160, v160
    v_exp_f32 v161, v161
    v_exp_f32 v162, v162
    v_smfmac_f32_32x32x32_bf16 v[104:119], v[236:239], v[216:223], v35
    ds_read_b128 v[236:239], v124 offset:56800
    v_exp_f32 v163, v163
    v_exp_f32 v164, v164
    v_exp_f32 v165, v165
    v_mfma_f32_32x32x16_bf16 v[208:223], v[148:151], v[120:123], 0
    ds_read_b128 v[228:231], v124 offset:56128
    v_exp_f32 v166, v166
    v_exp_f32 v167, v167
    v_exp_f32 v168, v168
    v_exp_f32 v169, v169
    v_smfmac_f32_32x32x32_bf16 v[88:103], v[224:227], v[160:167], v35
    v_exp_f32 v170, v170
    v_exp_f32 v171, v171
    v_exp_f32 v172, v172
    v_exp_f32 v173, v173
    v_mfma_f32_32x32x4_2b_bf16 v[192:223], v[142:143], v[140:141], v[192:223] cbsz:1 abid:1
    ds_read_b64 v[142:143], v39 offset:60096
    v_exp_f32 v174, v174
    v_exp_f32 v175, v175
    v_exp_f32 v176, v176
    v_exp_f32 v177, v177
    v_exp_f32 v178, v178
    v_exp_f32 v179, v179
    v_exp_f32 v180, v180
    v_exp_f32 v181, v181
    v_smfmac_f32_32x32x32_bf16 v[88:103], v[232:235], v[168:175], v35
    v_exp_f32 v182, v182
    v_exp_f32 v183, v183
    v_exp_f32 v184, v184
    v_exp_f32 v185, v185
    v_exp_f32 v186, v186
    v_smfmac_f32_32x32x32_bf16 v[104:119], v[224:227], v[176:183], v35
    s_waitcnt lgkmcnt(0)
    v_exp_f32 v187, v187
    v_exp_f32 v188, v188
    v_exp_f32 v189, v189
    v_exp_f32 v190, v190
    v_exp_f32 v191, v191
    v_mfma_f32_32x32x16_bf16 v[160:175], v[144:147], v[136:139], 0
    ds_read_b128 v[148:151], v2 offset:60352
    v_exp_f32 v192, v192
    v_exp_f32 v193, v193
    v_exp_f32 v194, v194
    v_smfmac_f32_32x32x32_bf16 v[104:119], v[232:235], v[184:191], v35
    ds_read_b128 v[232:235], v124 offset:59424
    v_exp_f32 v195, v195
    v_exp_f32 v196, v196
    v_exp_f32 v197, v197
    v_mfma_f32_32x32x16_bf16 v[176:191], v[144:147], v[120:123], 0
    ds_read_b128 v[224:227], v124 offset:58752
    v_exp_f32 v198, v198
    v_exp_f32 v199, v199
    v_exp_f32 v200, v200
    v_exp_f32 v201, v201
    v_smfmac_f32_32x32x32_bf16 v[88:103], v[228:231], v[192:199], v35
    v_exp_f32 v202, v202
    v_exp_f32 v203, v203
    v_exp_f32 v204, v204
    v_exp_f32 v205, v205
    v_mfma_f32_32x32x4_2b_bf16 v[160:191], v[142:143], v[140:141], v[160:191] cbsz:1 abid:0
    v_exp_f32 v206, v206
    v_exp_f32 v207, v207
    v_exp_f32 v208, v208
    v_exp_f32 v209, v209
    v_exp_f32 v210, v210
    v_exp_f32 v211, v211
    v_exp_f32 v212, v212
    v_exp_f32 v213, v213
    v_smfmac_f32_32x32x32_bf16 v[88:103], v[236:239], v[200:207], v35
    v_exp_f32 v214, v214
    v_exp_f32 v215, v215
    v_exp_f32 v216, v216
    v_exp_f32 v217, v217
    v_exp_f32 v218, v218
    v_smfmac_f32_32x32x32_bf16 v[104:119], v[228:231], v[208:215], v35
    s_waitcnt lgkmcnt(0)
    v_exp_f32 v219, v219
    v_exp_f32 v220, v220
    v_exp_f32 v221, v221
    v_exp_f32 v222, v222
    v_exp_f32 v223, v223
    v_mfma_f32_32x32x16_bf16 v[192:207], v[148:151], v[136:139], 0
    s_barrier
    ds_read_b128 v[144:147], v2 offset:0
    v_exp_f32 v160, v160
    v_exp_f32 v161, v161
    v_exp_f32 v162, v162
    v_smfmac_f32_32x32x32_bf16 v[104:119], v[236:239], v[216:223], v35
    ds_read_b128 v[236:239], v124 offset:62048
    v_exp_f32 v163, v163
    v_exp_f32 v164, v164
    v_exp_f32 v165, v165
    v_mfma_f32_32x32x16_bf16 v[208:223], v[148:151], v[120:123], 0
    ds_read_b128 v[228:231], v124 offset:61376
    v_exp_f32 v166, v166
    v_exp_f32 v167, v167
    v_exp_f32 v168, v168
    v_exp_f32 v169, v169
    v_smfmac_f32_32x32x32_bf16 v[88:103], v[224:227], v[160:167], v35
    v_exp_f32 v170, v170
    v_exp_f32 v171, v171
    v_exp_f32 v172, v172
    v_exp_f32 v173, v173
    v_mfma_f32_32x32x4_2b_bf16 v[192:223], v[142:143], v[140:141], v[192:223] cbsz:1 abid:1
    ds_read_b64 v[142:143], v39 offset:2368
    v_exp_f32 v174, v174
    v_exp_f32 v175, v175
    v_exp_f32 v176, v176
    v_exp_f32 v177, v177
    v_exp_f32 v178, v178
    v_exp_f32 v179, v179
    v_exp_f32 v180, v180
    v_exp_f32 v181, v181
    v_smfmac_f32_32x32x32_bf16 v[88:103], v[232:235], v[168:175], v35
    v_exp_f32 v182, v182
    v_exp_f32 v183, v183
    v_exp_f32 v184, v184
    v_exp_f32 v185, v185
    v_exp_f32 v186, v186
    v_smfmac_f32_32x32x32_bf16 v[104:119], v[224:227], v[176:183], v35
    s_waitcnt lgkmcnt(0)
    v_exp_f32 v187, v187
    v_exp_f32 v188, v188
    v_exp_f32 v189, v189
    v_exp_f32 v190, v190
    v_exp_f32 v191, v191
    v_mfma_f32_32x32x16_bf16 v[160:175], v[144:147], v[136:139], 0
    ds_read_b128 v[148:151], v2 offset:2624
    v_exp_f32 v192, v192
    v_exp_f32 v193, v193
    v_exp_f32 v194, v194
    v_smfmac_f32_32x32x32_bf16 v[104:119], v[232:235], v[184:191], v35
    ds_read_b128 v[232:235], v124 offset:1696
    v_exp_f32 v195, v195
    v_exp_f32 v196, v196
    v_exp_f32 v197, v197
    v_mfma_f32_32x32x16_bf16 v[176:191], v[144:147], v[120:123], 0
    ds_read_b128 v[224:227], v124 offset:1024
    v_exp_f32 v198, v198
    v_exp_f32 v199, v199
    v_exp_f32 v200, v200
    v_exp_f32 v201, v201
    v_smfmac_f32_32x32x32_bf16 v[88:103], v[228:231], v[192:199], v35
    v_exp_f32 v202, v202
    v_exp_f32 v203, v203
    v_exp_f32 v204, v204
    v_exp_f32 v205, v205
    v_mfma_f32_32x32x4_2b_bf16 v[160:191], v[142:143], v[140:141], v[160:191] cbsz:1 abid:0
    v_exp_f32 v206, v206
    v_exp_f32 v207, v207
    v_exp_f32 v208, v208
    v_exp_f32 v209, v209
    v_exp_f32 v210, v210
    v_exp_f32 v211, v211
    v_exp_f32 v212, v212
    v_exp_f32 v213, v213
    v_smfmac_f32_32x32x32_bf16 v[88:103], v[236:239], v[200:207], v35
    v_exp_f32 v214, v214
    v_exp_f32 v215, v215
    v_exp_f32 v216, v216
    v_exp_f32 v217, v217
    v_exp_f32 v218, v218
    v_smfmac_f32_32x32x32_bf16 v[104:119], v[228:231], v[208:215], v35
    s_waitcnt lgkmcnt(0)
    v_exp_f32 v219, v219
    v_exp_f32 v220, v220
    v_exp_f32 v221, v221
    v_exp_f32 v222, v222
    v_exp_f32 v223, v223
    v_mfma_f32_32x32x16_bf16 v[192:207], v[148:151], v[136:139], 0
    ds_read_b128 v[144:147], v2 offset:5248
    v_exp_f32 v160, v160
    v_exp_f32 v161, v161
    v_exp_f32 v162, v162
    v_smfmac_f32_32x32x32_bf16 v[104:119], v[236:239], v[216:223], v35
    ds_read_b128 v[236:239], v124 offset:4320
    v_exp_f32 v163, v163
    v_exp_f32 v164, v164
    v_exp_f32 v165, v165
    v_mfma_f32_32x32x16_bf16 v[208:223], v[148:151], v[120:123], 0
    ds_read_b128 v[228:231], v124 offset:3648
    v_exp_f32 v166, v166
    v_exp_f32 v167, v167
    v_exp_f32 v168, v168
    v_exp_f32 v169, v169
    v_smfmac_f32_32x32x32_bf16 v[88:103], v[224:227], v[160:167], v35
    v_exp_f32 v170, v170
    v_exp_f32 v171, v171
    v_exp_f32 v172, v172
    v_exp_f32 v173, v173
    v_mfma_f32_32x32x4_2b_bf16 v[192:223], v[142:143], v[140:141], v[192:223] cbsz:1 abid:1
    ds_read_b64 v[142:143], v39 offset:7616
    v_exp_f32 v174, v174
    v_exp_f32 v175, v175
    v_exp_f32 v176, v176
    v_exp_f32 v177, v177
    v_exp_f32 v178, v178
    v_exp_f32 v179, v179
    v_exp_f32 v180, v180
    v_exp_f32 v181, v181
    v_smfmac_f32_32x32x32_bf16 v[88:103], v[232:235], v[168:175], v35
    v_exp_f32 v182, v182
    v_exp_f32 v183, v183
    v_exp_f32 v184, v184
    v_exp_f32 v185, v185
    v_exp_f32 v186, v186
    v_smfmac_f32_32x32x32_bf16 v[104:119], v[224:227], v[176:183], v35
    s_waitcnt lgkmcnt(0)
    v_exp_f32 v187, v187
    v_exp_f32 v188, v188
    v_exp_f32 v189, v189
    v_exp_f32 v190, v190
    v_exp_f32 v191, v191
    v_mfma_f32_32x32x16_bf16 v[160:175], v[144:147], v[136:139], 0
    ds_read_b128 v[148:151], v2 offset:7872
    v_exp_f32 v192, v192
    v_exp_f32 v193, v193
    v_exp_f32 v194, v194
    v_smfmac_f32_32x32x32_bf16 v[104:119], v[232:235], v[184:191], v35
    ds_read_b128 v[232:235], v124 offset:6944
    v_exp_f32 v195, v195
    v_exp_f32 v196, v196
    v_exp_f32 v197, v197
    v_mfma_f32_32x32x16_bf16 v[176:191], v[144:147], v[120:123], 0
    ds_read_b128 v[224:227], v124 offset:6272
    v_exp_f32 v198, v198
    v_exp_f32 v199, v199
    v_exp_f32 v200, v200
    v_exp_f32 v201, v201
    v_smfmac_f32_32x32x32_bf16 v[88:103], v[228:231], v[192:199], v35
    v_exp_f32 v202, v202
    v_exp_f32 v203, v203
    v_exp_f32 v204, v204
    v_exp_f32 v205, v205
    v_mfma_f32_32x32x4_2b_bf16 v[160:191], v[142:143], v[140:141], v[160:191] cbsz:1 abid:0
    v_exp_f32 v206, v206
    v_exp_f32 v207, v207
    v_exp_f32 v208, v208
    v_exp_f32 v209, v209
    v_exp_f32 v210, v210
    v_exp_f32 v211, v211
    v_exp_f32 v212, v212
    v_exp_f32 v213, v213
    v_smfmac_f32_32x32x32_bf16 v[88:103], v[236:239], v[200:207], v35
    v_exp_f32 v214, v214
    v_exp_f32 v215, v215
    v_exp_f32 v216, v216
    v_exp_f32 v217, v217
    v_exp_f32 v218, v218
    v_smfmac_f32_32x32x32_bf16 v[104:119], v[228:231], v[208:215], v35
    s_waitcnt lgkmcnt(0)
    v_exp_f32 v219, v219
    v_exp_f32 v220, v220
    v_exp_f32 v221, v221
    v_exp_f32 v222, v222
    v_exp_f32 v223, v223
    v_mfma_f32_32x32x16_bf16 v[192:207], v[148:151], v[136:139], 0
    ds_read_b128 v[144:147], v2 offset:10496
    v_exp_f32 v160, v160
    v_exp_f32 v161, v161
    v_exp_f32 v162, v162
    v_smfmac_f32_32x32x32_bf16 v[104:119], v[236:239], v[216:223], v35
    ds_read_b128 v[236:239], v124 offset:9568
    v_exp_f32 v163, v163
    v_exp_f32 v164, v164
    v_exp_f32 v165, v165
    v_mfma_f32_32x32x16_bf16 v[208:223], v[148:151], v[120:123], 0
    ds_read_b128 v[228:231], v124 offset:8896
    v_exp_f32 v166, v166
    v_exp_f32 v167, v167
    v_exp_f32 v168, v168
    v_exp_f32 v169, v169
    v_smfmac_f32_32x32x32_bf16 v[88:103], v[224:227], v[160:167], v35
    v_exp_f32 v170, v170
    v_exp_f32 v171, v171
    v_exp_f32 v172, v172
    v_exp_f32 v173, v173
    v_mfma_f32_32x32x4_2b_bf16 v[192:223], v[142:143], v[140:141], v[192:223] cbsz:1 abid:1
    ds_read_b64 v[142:143], v39 offset:12864
    v_exp_f32 v174, v174
    v_exp_f32 v175, v175
    v_exp_f32 v176, v176
    v_exp_f32 v177, v177
    v_exp_f32 v178, v178
    v_exp_f32 v179, v179
    v_exp_f32 v180, v180
    v_exp_f32 v181, v181
    v_smfmac_f32_32x32x32_bf16 v[88:103], v[232:235], v[168:175], v35
    v_exp_f32 v182, v182
    v_exp_f32 v183, v183
    v_exp_f32 v184, v184
    v_exp_f32 v185, v185
    v_exp_f32 v186, v186
    v_smfmac_f32_32x32x32_bf16 v[104:119], v[224:227], v[176:183], v35
    s_waitcnt lgkmcnt(0)
    v_exp_f32 v187, v187
    v_exp_f32 v188, v188
    v_exp_f32 v189, v189
    v_exp_f32 v190, v190
    v_exp_f32 v191, v191
    v_mfma_f32_32x32x16_bf16 v[160:175], v[144:147], v[136:139], 0
    ds_read_b128 v[148:151], v2 offset:13120
    v_exp_f32 v192, v192
    v_exp_f32 v193, v193
    v_exp_f32 v194, v194
    v_smfmac_f32_32x32x32_bf16 v[104:119], v[232:235], v[184:191], v35
    ds_read_b128 v[232:235], v124 offset:12192
    v_exp_f32 v195, v195
    v_exp_f32 v196, v196
    v_exp_f32 v197, v197
    v_mfma_f32_32x32x16_bf16 v[176:191], v[144:147], v[120:123], 0
    ds_read_b128 v[224:227], v124 offset:11520
    v_exp_f32 v198, v198
    v_exp_f32 v199, v199
    v_exp_f32 v200, v200
    v_exp_f32 v201, v201
    v_smfmac_f32_32x32x32_bf16 v[88:103], v[228:231], v[192:199], v35
    v_exp_f32 v202, v202
    v_exp_f32 v203, v203
    v_exp_f32 v204, v204
    v_exp_f32 v205, v205
    v_mfma_f32_32x32x4_2b_bf16 v[160:191], v[142:143], v[140:141], v[160:191] cbsz:1 abid:0
    v_exp_f32 v206, v206
    v_exp_f32 v207, v207
    v_exp_f32 v208, v208
    v_exp_f32 v209, v209
    v_exp_f32 v210, v210
    v_exp_f32 v211, v211
    v_exp_f32 v212, v212
    v_exp_f32 v213, v213
    v_smfmac_f32_32x32x32_bf16 v[88:103], v[236:239], v[200:207], v35
    v_exp_f32 v214, v214
    v_exp_f32 v215, v215
    v_exp_f32 v216, v216
    v_exp_f32 v217, v217
    v_exp_f32 v218, v218
    v_smfmac_f32_32x32x32_bf16 v[104:119], v[228:231], v[208:215], v35
    s_waitcnt lgkmcnt(0)
    v_exp_f32 v219, v219
    v_exp_f32 v220, v220
    v_exp_f32 v221, v221
    v_exp_f32 v222, v222
    v_exp_f32 v223, v223
    v_mfma_f32_32x32x16_bf16 v[192:207], v[148:151], v[136:139], 0
    ds_read_b128 v[144:147], v2 offset:15744
    v_exp_f32 v160, v160
    v_exp_f32 v161, v161
    v_exp_f32 v162, v162
    v_smfmac_f32_32x32x32_bf16 v[104:119], v[236:239], v[216:223], v35
    ds_read_b128 v[236:239], v124 offset:14816
    v_exp_f32 v163, v163
    v_exp_f32 v164, v164
    v_exp_f32 v165, v165
    v_mfma_f32_32x32x16_bf16 v[208:223], v[148:151], v[120:123], 0
    ds_read_b128 v[228:231], v124 offset:14144
    v_exp_f32 v166, v166
    v_exp_f32 v167, v167
    v_exp_f32 v168, v168
    v_exp_f32 v169, v169
    v_smfmac_f32_32x32x32_bf16 v[88:103], v[224:227], v[160:167], v35
    v_exp_f32 v170, v170
    v_exp_f32 v171, v171
    v_exp_f32 v172, v172
    v_exp_f32 v173, v173
    v_mfma_f32_32x32x4_2b_bf16 v[192:223], v[142:143], v[140:141], v[192:223] cbsz:1 abid:1
    ds_read_b64 v[142:143], v39 offset:18112
    v_exp_f32 v174, v174
    v_exp_f32 v175, v175
    v_exp_f32 v176, v176
    v_exp_f32 v177, v177
    v_exp_f32 v178, v178
    v_exp_f32 v179, v179
    v_exp_f32 v180, v180
    v_exp_f32 v181, v181
    v_smfmac_f32_32x32x32_bf16 v[88:103], v[232:235], v[168:175], v35
    v_exp_f32 v182, v182
    v_exp_f32 v183, v183
    v_exp_f32 v184, v184
    v_exp_f32 v185, v185
    v_exp_f32 v186, v186
    v_smfmac_f32_32x32x32_bf16 v[104:119], v[224:227], v[176:183], v35
    s_waitcnt lgkmcnt(0)
    v_exp_f32 v187, v187
    v_exp_f32 v188, v188
    v_exp_f32 v189, v189
    v_exp_f32 v190, v190
    v_exp_f32 v191, v191
    v_mfma_f32_32x32x16_bf16 v[160:175], v[144:147], v[136:139], 0
    ds_read_b128 v[148:151], v2 offset:18368
    v_exp_f32 v192, v192
    v_exp_f32 v193, v193
    v_exp_f32 v194, v194
    v_smfmac_f32_32x32x32_bf16 v[104:119], v[232:235], v[184:191], v35
    ds_read_b128 v[232:235], v124 offset:17440
    v_exp_f32 v195, v195
    v_exp_f32 v196, v196
    v_exp_f32 v197, v197
    v_mfma_f32_32x32x16_bf16 v[176:191], v[144:147], v[120:123], 0
    ds_read_b128 v[224:227], v124 offset:16768
    v_exp_f32 v198, v198
    v_exp_f32 v199, v199
    v_exp_f32 v200, v200
    v_exp_f32 v201, v201
    v_smfmac_f32_32x32x32_bf16 v[88:103], v[228:231], v[192:199], v35
    v_exp_f32 v202, v202
    v_exp_f32 v203, v203
    v_exp_f32 v204, v204
    v_exp_f32 v205, v205
    v_mfma_f32_32x32x4_2b_bf16 v[160:191], v[142:143], v[140:141], v[160:191] cbsz:1 abid:0
    v_exp_f32 v206, v206
    v_exp_f32 v207, v207
    v_exp_f32 v208, v208
    v_exp_f32 v209, v209
    v_exp_f32 v210, v210
    v_exp_f32 v211, v211
    v_exp_f32 v212, v212
    v_exp_f32 v213, v213
    v_smfmac_f32_32x32x32_bf16 v[88:103], v[236:239], v[200:207], v35
    v_exp_f32 v214, v214
    v_exp_f32 v215, v215
    v_exp_f32 v216, v216
    v_exp_f32 v217, v217
    v_exp_f32 v218, v218
    v_smfmac_f32_32x32x32_bf16 v[104:119], v[228:231], v[208:215], v35
    s_waitcnt lgkmcnt(0)
    v_exp_f32 v219, v219
    v_exp_f32 v220, v220
    v_exp_f32 v221, v221
    v_exp_f32 v222, v222
    v_exp_f32 v223, v223
    v_mfma_f32_32x32x16_bf16 v[192:207], v[148:151], v[136:139], 0
    s_barrier
    ds_read_b128 v[144:147], v2 offset:20992
    v_exp_f32 v160, v160
    v_exp_f32 v161, v161
    v_exp_f32 v162, v162
    v_smfmac_f32_32x32x32_bf16 v[104:119], v[236:239], v[216:223], v35
    ds_read_b128 v[236:239], v124 offset:20064
    v_exp_f32 v163, v163
    v_exp_f32 v164, v164
    v_exp_f32 v165, v165
    v_mfma_f32_32x32x16_bf16 v[208:223], v[148:151], v[120:123], 0
    ds_read_b128 v[228:231], v124 offset:19392
    v_exp_f32 v166, v166
    v_exp_f32 v167, v167
    v_exp_f32 v168, v168
    v_exp_f32 v169, v169
    v_smfmac_f32_32x32x32_bf16 v[88:103], v[224:227], v[160:167], v35
    v_exp_f32 v170, v170
    v_exp_f32 v171, v171
    v_exp_f32 v172, v172
    v_exp_f32 v173, v173
    v_mfma_f32_32x32x4_2b_bf16 v[192:223], v[142:143], v[140:141], v[192:223] cbsz:1 abid:1
    ds_read_b64 v[142:143], v39 offset:23360
    v_exp_f32 v174, v174
    v_exp_f32 v175, v175
    v_exp_f32 v176, v176
    v_exp_f32 v177, v177
    v_exp_f32 v178, v178
    v_exp_f32 v179, v179
    v_exp_f32 v180, v180
    v_exp_f32 v181, v181
    v_smfmac_f32_32x32x32_bf16 v[88:103], v[232:235], v[168:175], v35
    v_exp_f32 v182, v182
    v_exp_f32 v183, v183
    v_exp_f32 v184, v184
    v_exp_f32 v185, v185
    v_exp_f32 v186, v186
    v_smfmac_f32_32x32x32_bf16 v[104:119], v[224:227], v[176:183], v35
    s_waitcnt lgkmcnt(0)
    v_exp_f32 v187, v187
    v_exp_f32 v188, v188
    v_exp_f32 v189, v189
    v_exp_f32 v190, v190
    v_exp_f32 v191, v191
    v_mfma_f32_32x32x16_bf16 v[160:175], v[144:147], v[136:139], 0
    ds_read_b128 v[148:151], v2 offset:23616
    v_exp_f32 v192, v192
    v_exp_f32 v193, v193
    v_exp_f32 v194, v194
    v_smfmac_f32_32x32x32_bf16 v[104:119], v[232:235], v[184:191], v35
    ds_read_b128 v[232:235], v124 offset:22688
    v_exp_f32 v195, v195
    v_exp_f32 v196, v196
    v_exp_f32 v197, v197
    v_mfma_f32_32x32x16_bf16 v[176:191], v[144:147], v[120:123], 0
    ds_read_b128 v[224:227], v124 offset:22016
    v_exp_f32 v198, v198
    v_exp_f32 v199, v199
    v_exp_f32 v200, v200
    v_exp_f32 v201, v201
    v_smfmac_f32_32x32x32_bf16 v[88:103], v[228:231], v[192:199], v35
    v_exp_f32 v202, v202
    v_exp_f32 v203, v203
    v_exp_f32 v204, v204
    v_exp_f32 v205, v205
    v_mfma_f32_32x32x4_2b_bf16 v[160:191], v[142:143], v[140:141], v[160:191] cbsz:1 abid:0
    v_exp_f32 v206, v206
    v_exp_f32 v207, v207
    v_exp_f32 v208, v208
    v_exp_f32 v209, v209
    v_exp_f32 v210, v210
    v_exp_f32 v211, v211
    v_exp_f32 v212, v212
    v_exp_f32 v213, v213
    v_smfmac_f32_32x32x32_bf16 v[88:103], v[236:239], v[200:207], v35
    v_exp_f32 v214, v214
    v_exp_f32 v215, v215
    v_exp_f32 v216, v216
    v_exp_f32 v217, v217
    v_exp_f32 v218, v218
    v_smfmac_f32_32x32x32_bf16 v[104:119], v[228:231], v[208:215], v35
    s_waitcnt lgkmcnt(0)
    v_exp_f32 v219, v219
    v_exp_f32 v220, v220
    v_exp_f32 v221, v221
    v_exp_f32 v222, v222
    v_exp_f32 v223, v223
    v_mfma_f32_32x32x16_bf16 v[192:207], v[148:151], v[136:139], 0
    ds_read_b128 v[144:147], v2 offset:26240
    v_exp_f32 v160, v160
    v_exp_f32 v161, v161
    v_exp_f32 v162, v162
    v_smfmac_f32_32x32x32_bf16 v[104:119], v[236:239], v[216:223], v35
    ds_read_b128 v[236:239], v124 offset:25312
    v_exp_f32 v163, v163
    v_exp_f32 v164, v164
    v_exp_f32 v165, v165
    v_mfma_f32_32x32x16_bf16 v[208:223], v[148:151], v[120:123], 0
    ds_read_b128 v[228:231], v124 offset:24640
    v_exp_f32 v166, v166
    v_exp_f32 v167, v167
    v_exp_f32 v168, v168
    v_exp_f32 v169, v169
    v_smfmac_f32_32x32x32_bf16 v[88:103], v[224:227], v[160:167], v35
    v_exp_f32 v170, v170
    v_exp_f32 v171, v171
    v_exp_f32 v172, v172
    v_exp_f32 v173, v173
    v_mfma_f32_32x32x4_2b_bf16 v[192:223], v[142:143], v[140:141], v[192:223] cbsz:1 abid:1
    ds_read_b64 v[142:143], v39 offset:28608
    v_exp_f32 v174, v174
    v_exp_f32 v175, v175
    v_exp_f32 v176, v176
    v_exp_f32 v177, v177
    v_exp_f32 v178, v178
    v_exp_f32 v179, v179
    v_exp_f32 v180, v180
    v_exp_f32 v181, v181
    v_smfmac_f32_32x32x32_bf16 v[88:103], v[232:235], v[168:175], v35
    v_exp_f32 v182, v182
    v_exp_f32 v183, v183
    v_exp_f32 v184, v184
    v_exp_f32 v185, v185
    v_exp_f32 v186, v186
    v_smfmac_f32_32x32x32_bf16 v[104:119], v[224:227], v[176:183], v35
    s_waitcnt lgkmcnt(0)
    v_exp_f32 v187, v187
    v_exp_f32 v188, v188
    v_exp_f32 v189, v189
    v_exp_f32 v190, v190
    v_exp_f32 v191, v191
    v_mfma_f32_32x32x16_bf16 v[160:175], v[144:147], v[136:139], 0
    ds_read_b128 v[148:151], v2 offset:28864
    v_exp_f32 v192, v192
    v_exp_f32 v193, v193
    v_exp_f32 v194, v194
    v_smfmac_f32_32x32x32_bf16 v[104:119], v[232:235], v[184:191], v35
    ds_read_b128 v[232:235], v124 offset:27936
    v_exp_f32 v195, v195
    v_exp_f32 v196, v196
    v_exp_f32 v197, v197
    v_mfma_f32_32x32x16_bf16 v[176:191], v[144:147], v[120:123], 0
    ds_read_b128 v[224:227], v124 offset:27264
    v_exp_f32 v198, v198
    v_exp_f32 v199, v199
    v_exp_f32 v200, v200
    v_exp_f32 v201, v201
    v_smfmac_f32_32x32x32_bf16 v[88:103], v[228:231], v[192:199], v35
    v_exp_f32 v202, v202
    v_exp_f32 v203, v203
    v_exp_f32 v204, v204
    v_exp_f32 v205, v205
    v_mfma_f32_32x32x4_2b_bf16 v[160:191], v[142:143], v[140:141], v[160:191] cbsz:1 abid:0
    v_exp_f32 v206, v206
    v_exp_f32 v207, v207
    v_exp_f32 v208, v208
    v_exp_f32 v209, v209
    v_exp_f32 v210, v210
    v_exp_f32 v211, v211
    v_exp_f32 v212, v212
    v_exp_f32 v213, v213
    v_smfmac_f32_32x32x32_bf16 v[88:103], v[236:239], v[200:207], v35
    v_exp_f32 v214, v214
    v_exp_f32 v215, v215
    v_exp_f32 v216, v216
    v_exp_f32 v217, v217
    v_exp_f32 v218, v218
    v_smfmac_f32_32x32x32_bf16 v[104:119], v[228:231], v[208:215], v35
    s_waitcnt lgkmcnt(0)
    v_exp_f32 v219, v219
    v_exp_f32 v220, v220
    v_exp_f32 v221, v221
    v_exp_f32 v222, v222
    v_exp_f32 v223, v223
    v_mfma_f32_32x32x16_bf16 v[192:207], v[148:151], v[136:139], 0
    ds_read_b128 v[144:147], v2 offset:31488
    v_exp_f32 v160, v160
    v_exp_f32 v161, v161
    v_exp_f32 v162, v162
    v_smfmac_f32_32x32x32_bf16 v[104:119], v[236:239], v[216:223], v35
    ds_read_b128 v[236:239], v124 offset:30560
    v_exp_f32 v163, v163
    v_exp_f32 v164, v164
    v_exp_f32 v165, v165
    v_mfma_f32_32x32x16_bf16 v[208:223], v[148:151], v[120:123], 0
    ds_read_b128 v[228:231], v124 offset:29888
    v_exp_f32 v166, v166
    v_exp_f32 v167, v167
    v_exp_f32 v168, v168
    v_exp_f32 v169, v169
    v_smfmac_f32_32x32x32_bf16 v[88:103], v[224:227], v[160:167], v35
    v_exp_f32 v170, v170
    v_exp_f32 v171, v171
    v_exp_f32 v172, v172
    v_exp_f32 v173, v173
    v_mfma_f32_32x32x4_2b_bf16 v[192:223], v[142:143], v[140:141], v[192:223] cbsz:1 abid:1
    ds_read_b64 v[142:143], v39 offset:33856
    v_exp_f32 v174, v174
    v_exp_f32 v175, v175
    v_exp_f32 v176, v176
    v_exp_f32 v177, v177
    v_exp_f32 v178, v178
    v_exp_f32 v179, v179
    v_exp_f32 v180, v180
    v_exp_f32 v181, v181
    v_smfmac_f32_32x32x32_bf16 v[88:103], v[232:235], v[168:175], v35
    v_exp_f32 v182, v182
    v_exp_f32 v183, v183
    v_exp_f32 v184, v184
    v_exp_f32 v185, v185
    v_exp_f32 v186, v186
    v_smfmac_f32_32x32x32_bf16 v[104:119], v[224:227], v[176:183], v35
    s_waitcnt lgkmcnt(0)
    v_exp_f32 v187, v187
    v_exp_f32 v188, v188
    v_exp_f32 v189, v189
    v_exp_f32 v190, v190
    v_exp_f32 v191, v191
    v_mfma_f32_32x32x16_bf16 v[160:175], v[144:147], v[136:139], 0
    ds_read_b128 v[148:151], v2 offset:34112
    v_exp_f32 v192, v192
    v_exp_f32 v193, v193
    v_exp_f32 v194, v194
    v_smfmac_f32_32x32x32_bf16 v[104:119], v[232:235], v[184:191], v35
    ds_read_b128 v[232:235], v124 offset:33184
    v_exp_f32 v195, v195
    v_exp_f32 v196, v196
    v_exp_f32 v197, v197
    v_mfma_f32_32x32x16_bf16 v[176:191], v[144:147], v[120:123], 0
    ds_read_b128 v[224:227], v124 offset:32512
    v_exp_f32 v198, v198
    v_exp_f32 v199, v199
    v_exp_f32 v200, v200
    v_exp_f32 v201, v201
    v_smfmac_f32_32x32x32_bf16 v[88:103], v[228:231], v[192:199], v35
    v_exp_f32 v202, v202
    v_exp_f32 v203, v203
    v_exp_f32 v204, v204
    v_exp_f32 v205, v205
    v_mfma_f32_32x32x4_2b_bf16 v[160:191], v[142:143], v[140:141], v[160:191] cbsz:1 abid:0
    v_exp_f32 v206, v206
    v_exp_f32 v207, v207
    v_exp_f32 v208, v208
    v_exp_f32 v209, v209
    v_exp_f32 v210, v210
    v_exp_f32 v211, v211
    v_exp_f32 v212, v212
    v_exp_f32 v213, v213
    v_smfmac_f32_32x32x32_bf16 v[88:103], v[236:239], v[200:207], v35
    v_exp_f32 v214, v214
    v_exp_f32 v215, v215
    v_exp_f32 v216, v216
    v_exp_f32 v217, v217
    v_exp_f32 v218, v218
    v_smfmac_f32_32x32x32_bf16 v[104:119], v[228:231], v[208:215], v35
    s_waitcnt lgkmcnt(0)
    v_exp_f32 v219, v219
    v_exp_f32 v220, v220
    v_exp_f32 v221, v221
    v_exp_f32 v222, v222
    v_exp_f32 v223, v223
    v_mfma_f32_32x32x16_bf16 v[192:207], v[148:151], v[136:139], 0
    ds_read_b128 v[144:147], v2 offset:36736
    v_exp_f32 v160, v160
    v_exp_f32 v161, v161
    v_exp_f32 v162, v162
    v_smfmac_f32_32x32x32_bf16 v[104:119], v[236:239], v[216:223], v35
    ds_read_b128 v[236:239], v124 offset:35808
    v_exp_f32 v163, v163
    v_exp_f32 v164, v164
    v_exp_f32 v165, v165
    v_mfma_f32_32x32x16_bf16 v[208:223], v[148:151], v[120:123], 0
    ds_read_b128 v[228:231], v124 offset:35136
    v_exp_f32 v166, v166
    v_exp_f32 v167, v167
    v_exp_f32 v168, v168
    v_exp_f32 v169, v169
    v_smfmac_f32_32x32x32_bf16 v[88:103], v[224:227], v[160:167], v35
    v_exp_f32 v170, v170
    v_exp_f32 v171, v171
    v_exp_f32 v172, v172
    v_exp_f32 v173, v173
    v_mfma_f32_32x32x4_2b_bf16 v[192:223], v[142:143], v[140:141], v[192:223] cbsz:1 abid:1
    ds_read_b64 v[142:143], v39 offset:39104
    v_exp_f32 v174, v174
    v_exp_f32 v175, v175
    v_exp_f32 v176, v176
    v_exp_f32 v177, v177
    v_exp_f32 v178, v178
    v_exp_f32 v179, v179
    v_exp_f32 v180, v180
    v_exp_f32 v181, v181
    v_smfmac_f32_32x32x32_bf16 v[88:103], v[232:235], v[168:175], v35
    v_exp_f32 v182, v182
    v_exp_f32 v183, v183
    v_exp_f32 v184, v184
    v_exp_f32 v185, v185
    v_exp_f32 v186, v186
    v_smfmac_f32_32x32x32_bf16 v[104:119], v[224:227], v[176:183], v35
    s_waitcnt lgkmcnt(0)
    v_exp_f32 v187, v187
    v_exp_f32 v188, v188
    v_exp_f32 v189, v189
    v_exp_f32 v190, v190
    v_exp_f32 v191, v191
    v_mfma_f32_32x32x16_bf16 v[160:175], v[144:147], v[136:139], 0
    ds_read_b128 v[148:151], v2 offset:39360
    v_exp_f32 v192, v192
    v_exp_f32 v193, v193
    v_exp_f32 v194, v194
    v_smfmac_f32_32x32x32_bf16 v[104:119], v[232:235], v[184:191], v35
    ds_read_b128 v[232:235], v124 offset:38432
    v_exp_f32 v195, v195
    v_exp_f32 v196, v196
    v_exp_f32 v197, v197
    v_mfma_f32_32x32x16_bf16 v[176:191], v[144:147], v[120:123], 0
    ds_read_b128 v[224:227], v124 offset:37760
    v_exp_f32 v198, v198
    v_exp_f32 v199, v199
    v_exp_f32 v200, v200
    v_exp_f32 v201, v201
    v_smfmac_f32_32x32x32_bf16 v[88:103], v[228:231], v[192:199], v35
    v_exp_f32 v202, v202
    v_exp_f32 v203, v203
    v_exp_f32 v204, v204
    v_exp_f32 v205, v205
    v_mfma_f32_32x32x4_2b_bf16 v[160:191], v[142:143], v[140:141], v[160:191] cbsz:1 abid:0
    v_exp_f32 v206, v206
    v_exp_f32 v207, v207
    v_exp_f32 v208, v208
    v_exp_f32 v209, v209
    v_exp_f32 v210, v210
    v_exp_f32 v211, v211
    v_exp_f32 v212, v212
    v_exp_f32 v213, v213
    v_smfmac_f32_32x32x32_bf16 v[88:103], v[236:239], v[200:207], v35
    v_exp_f32 v214, v214
    v_exp_f32 v215, v215
    v_exp_f32 v216, v216
    v_exp_f32 v217, v217
    v_exp_f32 v218, v218
    v_smfmac_f32_32x32x32_bf16 v[104:119], v[228:231], v[208:215], v35
    s_waitcnt lgkmcnt(0)
    v_exp_f32 v219, v219
    v_exp_f32 v220, v220
    v_exp_f32 v221, v221
    v_exp_f32 v222, v222
    v_exp_f32 v223, v223
    v_mfma_f32_32x32x16_bf16 v[192:207], v[148:151], v[136:139], 0
    s_barrier
    ds_read_b128 v[144:147], v2 offset:41984
    v_exp_f32 v160, v160
    v_exp_f32 v161, v161
    v_exp_f32 v162, v162
    v_smfmac_f32_32x32x32_bf16 v[104:119], v[236:239], v[216:223], v35
    ds_read_b128 v[236:239], v124 offset:41056
    v_exp_f32 v163, v163
    v_exp_f32 v164, v164
    v_exp_f32 v165, v165
    v_mfma_f32_32x32x16_bf16 v[208:223], v[148:151], v[120:123], 0
    ds_read_b128 v[228:231], v124 offset:40384
    v_exp_f32 v166, v166
    v_exp_f32 v167, v167
    v_exp_f32 v168, v168
    v_exp_f32 v169, v169
    v_smfmac_f32_32x32x32_bf16 v[88:103], v[224:227], v[160:167], v35
    v_exp_f32 v170, v170
    v_exp_f32 v171, v171
    v_exp_f32 v172, v172
    v_exp_f32 v173, v173
    v_mfma_f32_32x32x4_2b_bf16 v[192:223], v[142:143], v[140:141], v[192:223] cbsz:1 abid:1
    ds_read_b64 v[142:143], v39 offset:44352
    v_exp_f32 v174, v174
    v_exp_f32 v175, v175
    v_exp_f32 v176, v176
    v_exp_f32 v177, v177
    v_exp_f32 v178, v178
    v_exp_f32 v179, v179
    v_exp_f32 v180, v180
    v_exp_f32 v181, v181
    v_smfmac_f32_32x32x32_bf16 v[88:103], v[232:235], v[168:175], v35
    v_exp_f32 v182, v182
    v_exp_f32 v183, v183
    v_exp_f32 v184, v184
    v_exp_f32 v185, v185
    v_exp_f32 v186, v186
    v_smfmac_f32_32x32x32_bf16 v[104:119], v[224:227], v[176:183], v35
    s_waitcnt lgkmcnt(0)
    v_exp_f32 v187, v187
    v_exp_f32 v188, v188
    v_exp_f32 v189, v189
    v_exp_f32 v190, v190
    v_exp_f32 v191, v191
    v_mfma_f32_32x32x16_bf16 v[160:175], v[144:147], v[136:139], 0
    ds_read_b128 v[148:151], v2 offset:44608
    v_exp_f32 v192, v192
    v_exp_f32 v193, v193
    v_exp_f32 v194, v194
    v_smfmac_f32_32x32x32_bf16 v[104:119], v[232:235], v[184:191], v35
    ds_read_b128 v[232:235], v124 offset:43680
    v_exp_f32 v195, v195
    v_exp_f32 v196, v196
    v_exp_f32 v197, v197
    v_mfma_f32_32x32x16_bf16 v[176:191], v[144:147], v[120:123], 0
    ds_read_b128 v[224:227], v124 offset:43008
    v_exp_f32 v198, v198
    v_exp_f32 v199, v199
    v_exp_f32 v200, v200
    v_exp_f32 v201, v201
    v_smfmac_f32_32x32x32_bf16 v[88:103], v[228:231], v[192:199], v35
    v_exp_f32 v202, v202
    v_exp_f32 v203, v203
    v_exp_f32 v204, v204
    v_exp_f32 v205, v205
    v_mfma_f32_32x32x4_2b_bf16 v[160:191], v[142:143], v[140:141], v[160:191] cbsz:1 abid:0
    v_exp_f32 v206, v206
    v_exp_f32 v207, v207
    v_exp_f32 v208, v208
    v_exp_f32 v209, v209
    v_exp_f32 v210, v210
    v_exp_f32 v211, v211
    v_exp_f32 v212, v212
    v_exp_f32 v213, v213
    v_smfmac_f32_32x32x32_bf16 v[88:103], v[236:239], v[200:207], v35
    v_exp_f32 v214, v214
    v_exp_f32 v215, v215
    v_exp_f32 v216, v216
    v_exp_f32 v217, v217
    v_exp_f32 v218, v218
    v_smfmac_f32_32x32x32_bf16 v[104:119], v[228:231], v[208:215], v35
    s_waitcnt lgkmcnt(0)
    v_exp_f32 v219, v219
    v_exp_f32 v220, v220
    v_exp_f32 v221, v221
    v_exp_f32 v222, v222
    v_exp_f32 v223, v223
    v_mfma_f32_32x32x16_bf16 v[192:207], v[148:151], v[136:139], 0
    ds_read_b128 v[144:147], v2 offset:47232
    v_exp_f32 v160, v160
    v_exp_f32 v161, v161
    v_exp_f32 v162, v162
    v_smfmac_f32_32x32x32_bf16 v[104:119], v[236:239], v[216:223], v35
    ds_read_b128 v[236:239], v124 offset:46304
    v_exp_f32 v163, v163
    v_exp_f32 v164, v164
    v_exp_f32 v165, v165
    v_mfma_f32_32x32x16_bf16 v[208:223], v[148:151], v[120:123], 0
    ds_read_b128 v[228:231], v124 offset:45632
    v_exp_f32 v166, v166
    v_exp_f32 v167, v167
    v_exp_f32 v168, v168
    v_exp_f32 v169, v169
    v_smfmac_f32_32x32x32_bf16 v[88:103], v[224:227], v[160:167], v35
    v_exp_f32 v170, v170
    v_exp_f32 v171, v171
    v_exp_f32 v172, v172
    v_exp_f32 v173, v173
    v_mfma_f32_32x32x4_2b_bf16 v[192:223], v[142:143], v[140:141], v[192:223] cbsz:1 abid:1
    ds_read_b64 v[142:143], v39 offset:49600
    v_exp_f32 v174, v174
    v_exp_f32 v175, v175
    v_exp_f32 v176, v176
    v_exp_f32 v177, v177
    v_exp_f32 v178, v178
    v_exp_f32 v179, v179
    v_exp_f32 v180, v180
    v_exp_f32 v181, v181
    v_smfmac_f32_32x32x32_bf16 v[88:103], v[232:235], v[168:175], v35
    v_exp_f32 v182, v182
    v_exp_f32 v183, v183
    v_exp_f32 v184, v184
    v_exp_f32 v185, v185
    v_exp_f32 v186, v186
    v_smfmac_f32_32x32x32_bf16 v[104:119], v[224:227], v[176:183], v35
    s_waitcnt lgkmcnt(0)
    v_exp_f32 v187, v187
    v_exp_f32 v188, v188
    v_exp_f32 v189, v189
    v_exp_f32 v190, v190
    v_exp_f32 v191, v191
    v_mfma_f32_32x32x16_bf16 v[160:175], v[144:147], v[136:139], 0
    ds_read_b128 v[148:151], v2 offset:49856
    v_exp_f32 v192, v192
    v_exp_f32 v193, v193
    v_exp_f32 v194, v194
    v_smfmac_f32_32x32x32_bf16 v[104:119], v[232:235], v[184:191], v35
    ds_read_b128 v[232:235], v124 offset:48928
    v_exp_f32 v195, v195
    v_exp_f32 v196, v196
    v_exp_f32 v197, v197
    v_mfma_f32_32x32x16_bf16 v[176:191], v[144:147], v[120:123], 0
    ds_read_b128 v[224:227], v124 offset:48256
    v_exp_f32 v198, v198
    v_exp_f32 v199, v199
    v_exp_f32 v200, v200
    v_exp_f32 v201, v201
    v_smfmac_f32_32x32x32_bf16 v[88:103], v[228:231], v[192:199], v35
    v_exp_f32 v202, v202
    v_exp_f32 v203, v203
    v_exp_f32 v204, v204
    v_exp_f32 v205, v205
    v_mfma_f32_32x32x4_2b_bf16 v[160:191], v[142:143], v[140:141], v[160:191] cbsz:1 abid:0
    v_exp_f32 v206, v206
    v_exp_f32 v207, v207
    v_exp_f32 v208, v208
    v_exp_f32 v209, v209
    v_exp_f32 v210, v210
    v_exp_f32 v211, v211
    v_exp_f32 v212, v212
    v_exp_f32 v213, v213
    v_smfmac_f32_32x32x32_bf16 v[88:103], v[236:239], v[200:207], v35
    v_exp_f32 v214, v214
    v_exp_f32 v215, v215
    v_exp_f32 v216, v216
    v_exp_f32 v217, v217
    v_exp_f32 v218, v218
    v_smfmac_f32_32x32x32_bf16 v[104:119], v[228:231], v[208:215], v35
    s_waitcnt lgkmcnt(0)
    v_exp_f32 v219, v219
    v_exp_f32 v220, v220
    v_exp_f32 v221, v221
    v_exp_f32 v222, v222
    v_exp_f32 v223, v223
    v_mfma_f32_32x32x16_bf16 v[192:207], v[148:151], v[136:139], 0
    ds_read_b128 v[144:147], v2 offset:52480
    v_exp_f32 v160, v160
    v_exp_f32 v161, v161
    v_exp_f32 v162, v162
    v_smfmac_f32_32x32x32_bf16 v[104:119], v[236:239], v[216:223], v35
    ds_read_b128 v[236:239], v124 offset:51552
    v_exp_f32 v163, v163
    v_exp_f32 v164, v164
    v_exp_f32 v165, v165
    v_mfma_f32_32x32x16_bf16 v[208:223], v[148:151], v[120:123], 0
    ds_read_b128 v[228:231], v124 offset:50880
    v_exp_f32 v166, v166
    v_exp_f32 v167, v167
    v_exp_f32 v168, v168
    v_exp_f32 v169, v169
    v_smfmac_f32_32x32x32_bf16 v[88:103], v[224:227], v[160:167], v35
    v_exp_f32 v170, v170
    v_exp_f32 v171, v171
    v_exp_f32 v172, v172
    v_exp_f32 v173, v173
    v_mfma_f32_32x32x4_2b_bf16 v[192:223], v[142:143], v[140:141], v[192:223] cbsz:1 abid:1
    ds_read_b64 v[142:143], v39 offset:54848
    v_exp_f32 v174, v174
    v_exp_f32 v175, v175
    v_exp_f32 v176, v176
    v_exp_f32 v177, v177
    v_exp_f32 v178, v178
    v_exp_f32 v179, v179
    v_exp_f32 v180, v180
    v_exp_f32 v181, v181
    v_smfmac_f32_32x32x32_bf16 v[88:103], v[232:235], v[168:175], v35
    v_exp_f32 v182, v182
    v_exp_f32 v183, v183
    v_exp_f32 v184, v184
    v_exp_f32 v185, v185
    v_exp_f32 v186, v186
    v_smfmac_f32_32x32x32_bf16 v[104:119], v[224:227], v[176:183], v35
    s_waitcnt lgkmcnt(0)
    v_exp_f32 v187, v187
    v_exp_f32 v188, v188
    v_exp_f32 v189, v189
    v_exp_f32 v190, v190
    v_exp_f32 v191, v191
    v_mfma_f32_32x32x16_bf16 v[160:175], v[144:147], v[136:139], 0
    ds_read_b128 v[148:151], v2 offset:55104
    v_exp_f32 v192, v192
    v_exp_f32 v193, v193
    v_exp_f32 v194, v194
    v_smfmac_f32_32x32x32_bf16 v[104:119], v[232:235], v[184:191], v35
    ds_read_b128 v[232:235], v124 offset:54176
    v_exp_f32 v195, v195
    v_exp_f32 v196, v196
    v_exp_f32 v197, v197
    v_mfma_f32_32x32x16_bf16 v[176:191], v[144:147], v[120:123], 0
    ds_read_b128 v[224:227], v124 offset:53504
    v_exp_f32 v198, v198
    v_exp_f32 v199, v199
    v_exp_f32 v200, v200
    v_exp_f32 v201, v201
    v_smfmac_f32_32x32x32_bf16 v[88:103], v[228:231], v[192:199], v35
    v_exp_f32 v202, v202
    v_exp_f32 v203, v203
    v_exp_f32 v204, v204
    v_exp_f32 v205, v205
    v_mfma_f32_32x32x4_2b_bf16 v[160:191], v[142:143], v[140:141], v[160:191] cbsz:1 abid:0
    v_exp_f32 v206, v206
    v_exp_f32 v207, v207
    v_exp_f32 v208, v208
    v_exp_f32 v209, v209
    v_exp_f32 v210, v210
    v_exp_f32 v211, v211
    v_exp_f32 v212, v212
    v_exp_f32 v213, v213
    v_smfmac_f32_32x32x32_bf16 v[88:103], v[236:239], v[200:207], v35
    v_exp_f32 v214, v214
    v_exp_f32 v215, v215
    v_exp_f32 v216, v216
    v_exp_f32 v217, v217
    v_exp_f32 v218, v218
    v_smfmac_f32_32x32x32_bf16 v[104:119], v[228:231], v[208:215], v35
    s_waitcnt lgkmcnt(0)
    v_exp_f32 v219, v219
    v_exp_f32 v220, v220
    v_exp_f32 v221, v221
    v_exp_f32 v222, v222
    v_exp_f32 v223, v223
    v_mfma_f32_32x32x16_bf16 v[192:207], v[148:151], v[136:139], 0
    ds_read_b128 v[144:147], v2 offset:57728
    v_exp_f32 v160, v160
    v_exp_f32 v161, v161
    v_exp_f32 v162, v162
    v_smfmac_f32_32x32x32_bf16 v[104:119], v[236:239], v[216:223], v35
    ds_read_b128 v[236:239], v124 offset:56800
    v_exp_f32 v163, v163
    v_exp_f32 v164, v164
    v_exp_f32 v165, v165
    v_mfma_f32_32x32x16_bf16 v[208:223], v[148:151], v[120:123], 0
    ds_read_b128 v[228:231], v124 offset:56128
    v_exp_f32 v166, v166
    v_exp_f32 v167, v167
    v_exp_f32 v168, v168
    v_exp_f32 v169, v169
    v_smfmac_f32_32x32x32_bf16 v[88:103], v[224:227], v[160:167], v35
    v_exp_f32 v170, v170
    v_exp_f32 v171, v171
    v_exp_f32 v172, v172
    v_exp_f32 v173, v173
    v_mfma_f32_32x32x4_2b_bf16 v[192:223], v[142:143], v[140:141], v[192:223] cbsz:1 abid:1
    ds_read_b64 v[142:143], v39 offset:60096
    v_exp_f32 v174, v174
    v_exp_f32 v175, v175
    v_exp_f32 v176, v176
    v_exp_f32 v177, v177
    v_exp_f32 v178, v178
    v_exp_f32 v179, v179
    v_exp_f32 v180, v180
    v_exp_f32 v181, v181
    v_smfmac_f32_32x32x32_bf16 v[88:103], v[232:235], v[168:175], v35
    v_exp_f32 v182, v182
    v_exp_f32 v183, v183
    v_exp_f32 v184, v184
    v_exp_f32 v185, v185
    v_exp_f32 v186, v186
    v_smfmac_f32_32x32x32_bf16 v[104:119], v[224:227], v[176:183], v35
    s_waitcnt lgkmcnt(0)
    v_exp_f32 v187, v187
    v_exp_f32 v188, v188
    v_exp_f32 v189, v189
    v_exp_f32 v190, v190
    v_exp_f32 v191, v191
    v_mfma_f32_32x32x16_bf16 v[160:175], v[144:147], v[136:139], 0
    ds_read_b128 v[148:151], v2 offset:60352
    v_exp_f32 v192, v192
    v_exp_f32 v193, v193
    v_exp_f32 v194, v194
    v_smfmac_f32_32x32x32_bf16 v[104:119], v[232:235], v[184:191], v35
    ds_read_b128 v[232:235], v124 offset:59424
    v_exp_f32 v195, v195
    v_exp_f32 v196, v196
    v_exp_f32 v197, v197
    v_mfma_f32_32x32x16_bf16 v[176:191], v[144:147], v[120:123], 0
    ds_read_b128 v[224:227], v124 offset:58752
    v_exp_f32 v198, v198
    v_exp_f32 v199, v199
    v_exp_f32 v200, v200
    v_exp_f32 v201, v201
    v_smfmac_f32_32x32x32_bf16 v[88:103], v[228:231], v[192:199], v35
    v_exp_f32 v202, v202
    v_exp_f32 v203, v203
    v_exp_f32 v204, v204
    v_exp_f32 v205, v205
    v_mfma_f32_32x32x4_2b_bf16 v[160:191], v[142:143], v[140:141], v[160:191] cbsz:1 abid:0
    v_exp_f32 v206, v206
    v_exp_f32 v207, v207
    v_exp_f32 v208, v208
    v_exp_f32 v209, v209
    v_exp_f32 v210, v210
    v_exp_f32 v211, v211
    v_exp_f32 v212, v212
    v_exp_f32 v213, v213
    v_smfmac_f32_32x32x32_bf16 v[88:103], v[236:239], v[200:207], v35
    v_exp_f32 v214, v214
    v_exp_f32 v215, v215
    v_exp_f32 v216, v216
    v_exp_f32 v217, v217
    v_exp_f32 v218, v218
    v_smfmac_f32_32x32x32_bf16 v[104:119], v[228:231], v[208:215], v35
    s_waitcnt lgkmcnt(0)
    v_exp_f32 v219, v219
    v_exp_f32 v220, v220
    v_exp_f32 v221, v221
    v_exp_f32 v222, v222
    v_exp_f32 v223, v223
    v_mfma_f32_32x32x16_bf16 v[192:207], v[148:151], v[136:139], 0
    s_barrier
    ds_read_b128 v[144:147], v2 offset:0
    v_exp_f32 v160, v160
    v_exp_f32 v161, v161
    v_exp_f32 v162, v162
    v_smfmac_f32_32x32x32_bf16 v[104:119], v[236:239], v[216:223], v35
    ds_read_b128 v[236:239], v124 offset:62048
    v_exp_f32 v163, v163
    v_exp_f32 v164, v164
    v_exp_f32 v165, v165
    v_mfma_f32_32x32x16_bf16 v[208:223], v[148:151], v[120:123], 0
    ds_read_b128 v[228:231], v124 offset:61376
    v_exp_f32 v166, v166
    v_exp_f32 v167, v167
    v_exp_f32 v168, v168
    v_exp_f32 v169, v169
    v_smfmac_f32_32x32x32_bf16 v[88:103], v[224:227], v[160:167], v35
    v_exp_f32 v170, v170
    v_exp_f32 v171, v171
    v_exp_f32 v172, v172
    v_exp_f32 v173, v173
    v_mfma_f32_32x32x4_2b_bf16 v[192:223], v[142:143], v[140:141], v[192:223] cbsz:1 abid:1
    ds_read_b64 v[142:143], v39 offset:2368
    v_exp_f32 v174, v174
    v_exp_f32 v175, v175
    v_exp_f32 v176, v176
    v_exp_f32 v177, v177
    v_exp_f32 v178, v178
    v_exp_f32 v179, v179
    v_exp_f32 v180, v180
    v_exp_f32 v181, v181
    v_smfmac_f32_32x32x32_bf16 v[88:103], v[232:235], v[168:175], v35
    v_exp_f32 v182, v182
    v_exp_f32 v183, v183
    v_exp_f32 v184, v184
    v_exp_f32 v185, v185
    v_exp_f32 v186, v186
    v_smfmac_f32_32x32x32_bf16 v[104:119], v[224:227], v[176:183], v35
    s_waitcnt lgkmcnt(0)
    v_exp_f32 v187, v187
    v_exp_f32 v188, v188
    v_exp_f32 v189, v189
    v_exp_f32 v190, v190
    v_exp_f32 v191, v191
    v_mfma_f32_32x32x16_bf16 v[160:175], v[144:147], v[136:139], 0
    ds_read_b128 v[148:151], v2 offset:2624
    v_exp_f32 v192, v192
    v_exp_f32 v193, v193
    v_exp_f32 v194, v194
    v_smfmac_f32_32x32x32_bf16 v[104:119], v[232:235], v[184:191], v35
    ds_read_b128 v[232:235], v124 offset:1696
    v_exp_f32 v195, v195
    v_exp_f32 v196, v196
    v_exp_f32 v197, v197
    v_mfma_f32_32x32x16_bf16 v[176:191], v[144:147], v[120:123], 0
    ds_read_b128 v[224:227], v124 offset:1024
    v_exp_f32 v198, v198
    v_exp_f32 v199, v199
    v_exp_f32 v200, v200
    v_exp_f32 v201, v201
    v_smfmac_f32_32x32x32_bf16 v[88:103], v[228:231], v[192:199], v35
    v_exp_f32 v202, v202
    v_exp_f32 v203, v203
    v_exp_f32 v204, v204
    v_exp_f32 v205, v205
    v_mfma_f32_32x32x4_2b_bf16 v[160:191], v[142:143], v[140:141], v[160:191] cbsz:1 abid:0
    v_exp_f32 v206, v206
    v_exp_f32 v207, v207
    v_exp_f32 v208, v208
    v_exp_f32 v209, v209
    v_exp_f32 v210, v210
    v_exp_f32 v211, v211
    v_exp_f32 v212, v212
    v_exp_f32 v213, v213
    v_smfmac_f32_32x32x32_bf16 v[88:103], v[236:239], v[200:207], v35
    v_exp_f32 v214, v214
    v_exp_f32 v215, v215
    v_exp_f32 v216, v216
    v_exp_f32 v217, v217
    v_exp_f32 v218, v218
    v_smfmac_f32_32x32x32_bf16 v[104:119], v[228:231], v[208:215], v35
    s_waitcnt lgkmcnt(0)
    v_exp_f32 v219, v219
    v_exp_f32 v220, v220
    v_exp_f32 v221, v221
    v_exp_f32 v222, v222
    v_exp_f32 v223, v223
    v_mfma_f32_32x32x16_bf16 v[192:207], v[148:151], v[136:139], 0
    ds_read_b128 v[144:147], v2 offset:5248
    v_exp_f32 v160, v160
    v_exp_f32 v161, v161
    v_exp_f32 v162, v162
    v_smfmac_f32_32x32x32_bf16 v[104:119], v[236:239], v[216:223], v35
    ds_read_b128 v[236:239], v124 offset:4320
    v_exp_f32 v163, v163
    v_exp_f32 v164, v164
    v_exp_f32 v165, v165
    v_mfma_f32_32x32x16_bf16 v[208:223], v[148:151], v[120:123], 0
    ds_read_b128 v[228:231], v124 offset:3648
    v_exp_f32 v166, v166
    v_exp_f32 v167, v167
    v_exp_f32 v168, v168
    v_exp_f32 v169, v169
    v_smfmac_f32_32x32x32_bf16 v[88:103], v[224:227], v[160:167], v35
    v_exp_f32 v170, v170
    v_exp_f32 v171, v171
    v_exp_f32 v172, v172
    v_exp_f32 v173, v173
    v_mfma_f32_32x32x4_2b_bf16 v[192:223], v[142:143], v[140:141], v[192:223] cbsz:1 abid:1
    ds_read_b64 v[142:143], v39 offset:7616
    v_exp_f32 v174, v174
    v_exp_f32 v175, v175
    v_exp_f32 v176, v176
    v_exp_f32 v177, v177
    v_exp_f32 v178, v178
    v_exp_f32 v179, v179
    v_exp_f32 v180, v180
    v_exp_f32 v181, v181
    v_smfmac_f32_32x32x32_bf16 v[88:103], v[232:235], v[168:175], v35
    v_exp_f32 v182, v182
    v_exp_f32 v183, v183
    v_exp_f32 v184, v184
    v_exp_f32 v185, v185
    v_exp_f32 v186, v186
    v_smfmac_f32_32x32x32_bf16 v[104:119], v[224:227], v[176:183], v35
    s_waitcnt lgkmcnt(0)
    v_exp_f32 v187, v187
    v_exp_f32 v188, v188
    v_exp_f32 v189, v189
    v_exp_f32 v190, v190
    v_exp_f32 v191, v191
    v_mfma_f32_32x32x16_bf16 v[160:175], v[144:147], v[136:139], 0
    ds_read_b128 v[148:151], v2 offset:7872
    v_exp_f32 v192, v192
    v_exp_f32 v193, v193
    v_exp_f32 v194, v194
    v_smfmac_f32_32x32x32_bf16 v[104:119], v[232:235], v[184:191], v35
    ds_read_b128 v[232:235], v124 offset:6944
    v_exp_f32 v195, v195
    v_exp_f32 v196, v196
    v_exp_f32 v197, v197
    v_mfma_f32_32x32x16_bf16 v[176:191], v[144:147], v[120:123], 0
    ds_read_b128 v[224:227], v124 offset:6272
    v_exp_f32 v198, v198
    v_exp_f32 v199, v199
    v_exp_f32 v200, v200
    v_exp_f32 v201, v201
    v_smfmac_f32_32x32x32_bf16 v[88:103], v[228:231], v[192:199], v35
    v_exp_f32 v202, v202
    v_exp_f32 v203, v203
    v_exp_f32 v204, v204
    v_exp_f32 v205, v205
    v_mfma_f32_32x32x4_2b_bf16 v[160:191], v[142:143], v[140:141], v[160:191] cbsz:1 abid:0
    v_exp_f32 v206, v206
    v_exp_f32 v207, v207
    v_exp_f32 v208, v208
    v_exp_f32 v209, v209
    v_exp_f32 v210, v210
    v_exp_f32 v211, v211
    v_exp_f32 v212, v212
    v_exp_f32 v213, v213
    v_smfmac_f32_32x32x32_bf16 v[88:103], v[236:239], v[200:207], v35
    v_exp_f32 v214, v214
    v_exp_f32 v215, v215
    v_exp_f32 v216, v216
    v_exp_f32 v217, v217
    v_exp_f32 v218, v218
    v_smfmac_f32_32x32x32_bf16 v[104:119], v[228:231], v[208:215], v35
    s_waitcnt lgkmcnt(0)
    v_exp_f32 v219, v219
    v_exp_f32 v220, v220
    v_exp_f32 v221, v221
    v_exp_f32 v222, v222
    v_exp_f32 v223, v223
    v_mfma_f32_32x32x16_bf16 v[192:207], v[148:151], v[136:139], 0
    ds_read_b128 v[144:147], v2 offset:10496
    v_exp_f32 v160, v160
    v_exp_f32 v161, v161
    v_exp_f32 v162, v162
    v_smfmac_f32_32x32x32_bf16 v[104:119], v[236:239], v[216:223], v35
    ds_read_b128 v[236:239], v124 offset:9568
    v_exp_f32 v163, v163
    v_exp_f32 v164, v164
    v_exp_f32 v165, v165
    v_mfma_f32_32x32x16_bf16 v[208:223], v[148:151], v[120:123], 0
    ds_read_b128 v[228:231], v124 offset:8896
    v_exp_f32 v166, v166
    v_exp_f32 v167, v167
    v_exp_f32 v168, v168
    v_exp_f32 v169, v169
    v_smfmac_f32_32x32x32_bf16 v[88:103], v[224:227], v[160:167], v35
    v_exp_f32 v170, v170
    v_exp_f32 v171, v171
    v_exp_f32 v172, v172
    v_exp_f32 v173, v173
    v_mfma_f32_32x32x4_2b_bf16 v[192:223], v[142:143], v[140:141], v[192:223] cbsz:1 abid:1
    ds_read_b64 v[142:143], v39 offset:12864
    v_exp_f32 v174, v174
    v_exp_f32 v175, v175
    v_exp_f32 v176, v176
    v_exp_f32 v177, v177
    v_exp_f32 v178, v178
    v_exp_f32 v179, v179
    v_exp_f32 v180, v180
    v_exp_f32 v181, v181
    v_smfmac_f32_32x32x32_bf16 v[88:103], v[232:235], v[168:175], v35
    v_exp_f32 v182, v182
    v_exp_f32 v183, v183
    v_exp_f32 v184, v184
    v_exp_f32 v185, v185
    v_exp_f32 v186, v186
    v_smfmac_f32_32x32x32_bf16 v[104:119], v[224:227], v[176:183], v35
    s_waitcnt lgkmcnt(0)
    v_exp_f32 v187, v187
    v_exp_f32 v188, v188
    v_exp_f32 v189, v189
    v_exp_f32 v190, v190
    v_exp_f32 v191, v191
    v_mfma_f32_32x32x16_bf16 v[160:175], v[144:147], v[136:139], 0
    ds_read_b128 v[148:151], v2 offset:13120
    v_exp_f32 v192, v192
    v_exp_f32 v193, v193
    v_exp_f32 v194, v194
    v_smfmac_f32_32x32x32_bf16 v[104:119], v[232:235], v[184:191], v35
    ds_read_b128 v[232:235], v124 offset:12192
    v_exp_f32 v195, v195
    v_exp_f32 v196, v196
    v_exp_f32 v197, v197
    v_mfma_f32_32x32x16_bf16 v[176:191], v[144:147], v[120:123], 0
    ds_read_b128 v[224:227], v124 offset:11520
    v_exp_f32 v198, v198
    v_exp_f32 v199, v199
    v_exp_f32 v200, v200
    v_exp_f32 v201, v201
    v_smfmac_f32_32x32x32_bf16 v[88:103], v[228:231], v[192:199], v35
    v_exp_f32 v202, v202
    v_exp_f32 v203, v203
    v_exp_f32 v204, v204
    v_exp_f32 v205, v205
    v_mfma_f32_32x32x4_2b_bf16 v[160:191], v[142:143], v[140:141], v[160:191] cbsz:1 abid:0
    v_exp_f32 v206, v206
    v_exp_f32 v207, v207
    v_exp_f32 v208, v208
    v_exp_f32 v209, v209
    v_exp_f32 v210, v210
    v_exp_f32 v211, v211
    v_exp_f32 v212, v212
    v_exp_f32 v213, v213
    v_smfmac_f32_32x32x32_bf16 v[88:103], v[236:239], v[200:207], v35
    v_exp_f32 v214, v214
    v_exp_f32 v215, v215
    v_exp_f32 v216, v216
    v_exp_f32 v217, v217
    v_exp_f32 v218, v218
    v_smfmac_f32_32x32x32_bf16 v[104:119], v[228:231], v[208:215], v35
    s_waitcnt lgkmcnt(0)
    v_exp_f32 v219, v219
    v_exp_f32 v220, v220
    v_exp_f32 v221, v221
    v_exp_f32 v222, v222
    v_exp_f32 v223, v223
    v_mfma_f32_32x32x16_bf16 v[192:207], v[148:151], v[136:139], 0
    ds_read_b128 v[144:147], v2 offset:15744
    v_exp_f32 v160, v160
    v_exp_f32 v161, v161
    v_exp_f32 v162, v162
    v_smfmac_f32_32x32x32_bf16 v[104:119], v[236:239], v[216:223], v35
    ds_read_b128 v[236:239], v124 offset:14816
    v_exp_f32 v163, v163
    v_exp_f32 v164, v164
    v_exp_f32 v165, v165
    v_mfma_f32_32x32x16_bf16 v[208:223], v[148:151], v[120:123], 0
    ds_read_b128 v[228:231], v124 offset:14144
    v_exp_f32 v166, v166
    v_exp_f32 v167, v167
    v_exp_f32 v168, v168
    v_exp_f32 v169, v169
    v_smfmac_f32_32x32x32_bf16 v[88:103], v[224:227], v[160:167], v35
    v_exp_f32 v170, v170
    v_exp_f32 v171, v171
    v_exp_f32 v172, v172
    v_exp_f32 v173, v173
    v_mfma_f32_32x32x4_2b_bf16 v[192:223], v[142:143], v[140:141], v[192:223] cbsz:1 abid:1
    ds_read_b64 v[142:143], v39 offset:18112
    v_exp_f32 v174, v174
    v_exp_f32 v175, v175
    v_exp_f32 v176, v176
    v_exp_f32 v177, v177
    v_exp_f32 v178, v178
    v_exp_f32 v179, v179
    v_exp_f32 v180, v180
    v_exp_f32 v181, v181
    v_smfmac_f32_32x32x32_bf16 v[88:103], v[232:235], v[168:175], v35
    v_exp_f32 v182, v182
    v_exp_f32 v183, v183
    v_exp_f32 v184, v184
    v_exp_f32 v185, v185
    v_exp_f32 v186, v186
    v_smfmac_f32_32x32x32_bf16 v[104:119], v[224:227], v[176:183], v35
    s_waitcnt lgkmcnt(0)
    v_exp_f32 v187, v187
    v_exp_f32 v188, v188
    v_exp_f32 v189, v189
    v_exp_f32 v190, v190
    v_exp_f32 v191, v191
    v_mfma_f32_32x32x16_bf16 v[160:175], v[144:147], v[136:139], 0
    ds_read_b128 v[148:151], v2 offset:18368
    v_exp_f32 v192, v192
    v_exp_f32 v193, v193
    v_exp_f32 v194, v194
    v_smfmac_f32_32x32x32_bf16 v[104:119], v[232:235], v[184:191], v35
    ds_read_b128 v[232:235], v124 offset:17440
    v_exp_f32 v195, v195
    v_exp_f32 v196, v196
    v_exp_f32 v197, v197
    v_mfma_f32_32x32x16_bf16 v[176:191], v[144:147], v[120:123], 0
    ds_read_b128 v[224:227], v124 offset:16768
    v_exp_f32 v198, v198
    v_exp_f32 v199, v199
    v_exp_f32 v200, v200
    v_exp_f32 v201, v201
    v_smfmac_f32_32x32x32_bf16 v[88:103], v[228:231], v[192:199], v35
    v_exp_f32 v202, v202
    v_exp_f32 v203, v203
    v_exp_f32 v204, v204
    v_exp_f32 v205, v205
    v_mfma_f32_32x32x4_2b_bf16 v[160:191], v[142:143], v[140:141], v[160:191] cbsz:1 abid:0
    v_exp_f32 v206, v206
    v_exp_f32 v207, v207
    v_exp_f32 v208, v208
    v_exp_f32 v209, v209
    v_exp_f32 v210, v210
    v_exp_f32 v211, v211
    v_exp_f32 v212, v212
    v_exp_f32 v213, v213
    v_smfmac_f32_32x32x32_bf16 v[88:103], v[236:239], v[200:207], v35
    v_exp_f32 v214, v214
    v_exp_f32 v215, v215
    v_exp_f32 v216, v216
    v_exp_f32 v217, v217
    v_exp_f32 v218, v218
    v_smfmac_f32_32x32x32_bf16 v[104:119], v[228:231], v[208:215], v35
    s_waitcnt lgkmcnt(0)
    v_exp_f32 v219, v219
    v_exp_f32 v220, v220
    v_exp_f32 v221, v221
    v_exp_f32 v222, v222
    v_exp_f32 v223, v223
    v_mfma_f32_32x32x16_bf16 v[192:207], v[148:151], v[136:139], 0
    s_barrier
    ds_read_b128 v[144:147], v2 offset:20992
    v_exp_f32 v160, v160
    v_exp_f32 v161, v161
    v_exp_f32 v162, v162
    v_smfmac_f32_32x32x32_bf16 v[104:119], v[236:239], v[216:223], v35
    ds_read_b128 v[236:239], v124 offset:20064
    v_exp_f32 v163, v163
    v_exp_f32 v164, v164
    v_exp_f32 v165, v165
    v_mfma_f32_32x32x16_bf16 v[208:223], v[148:151], v[120:123], 0
    ds_read_b128 v[228:231], v124 offset:19392
    v_exp_f32 v166, v166
    v_exp_f32 v167, v167
    v_exp_f32 v168, v168
    v_exp_f32 v169, v169
    v_smfmac_f32_32x32x32_bf16 v[88:103], v[224:227], v[160:167], v35
    v_exp_f32 v170, v170
    v_exp_f32 v171, v171
    v_exp_f32 v172, v172
    v_exp_f32 v173, v173
    v_mfma_f32_32x32x4_2b_bf16 v[192:223], v[142:143], v[140:141], v[192:223] cbsz:1 abid:1
    ds_read_b64 v[142:143], v39 offset:23360
    v_exp_f32 v174, v174
    v_exp_f32 v175, v175
    v_exp_f32 v176, v176
    v_exp_f32 v177, v177
    v_exp_f32 v178, v178
    v_exp_f32 v179, v179
    v_exp_f32 v180, v180
    v_exp_f32 v181, v181
    v_smfmac_f32_32x32x32_bf16 v[88:103], v[232:235], v[168:175], v35
    v_exp_f32 v182, v182
    v_exp_f32 v183, v183
    v_exp_f32 v184, v184
    v_exp_f32 v185, v185
    v_exp_f32 v186, v186
    v_smfmac_f32_32x32x32_bf16 v[104:119], v[224:227], v[176:183], v35
    s_waitcnt lgkmcnt(0)
    v_exp_f32 v187, v187
    v_exp_f32 v188, v188
    v_exp_f32 v189, v189
    v_exp_f32 v190, v190
    v_exp_f32 v191, v191
    v_mfma_f32_32x32x16_bf16 v[160:175], v[144:147], v[136:139], 0
    ds_read_b128 v[148:151], v2 offset:23616
    v_exp_f32 v192, v192
    v_exp_f32 v193, v193
    v_exp_f32 v194, v194
    v_smfmac_f32_32x32x32_bf16 v[104:119], v[232:235], v[184:191], v35
    ds_read_b128 v[232:235], v124 offset:22688
    v_exp_f32 v195, v195
    v_exp_f32 v196, v196
    v_exp_f32 v197, v197
    v_mfma_f32_32x32x16_bf16 v[176:191], v[144:147], v[120:123], 0
    ds_read_b128 v[224:227], v124 offset:22016
    v_exp_f32 v198, v198
    v_exp_f32 v199, v199
    v_exp_f32 v200, v200
    v_exp_f32 v201, v201
    v_smfmac_f32_32x32x32_bf16 v[88:103], v[228:231], v[192:199], v35
    v_exp_f32 v202, v202
    v_exp_f32 v203, v203
    v_exp_f32 v204, v204
    v_exp_f32 v205, v205
    v_mfma_f32_32x32x4_2b_bf16 v[160:191], v[142:143], v[140:141], v[160:191] cbsz:1 abid:0
    v_exp_f32 v206, v206
    v_exp_f32 v207, v207
    v_exp_f32 v208, v208
    v_exp_f32 v209, v209
    v_exp_f32 v210, v210
    v_exp_f32 v211, v211
    v_exp_f32 v212, v212
    v_exp_f32 v213, v213
    v_smfmac_f32_32x32x32_bf16 v[88:103], v[236:239], v[200:207], v35
    v_exp_f32 v214, v214
    v_exp_f32 v215, v215
    v_exp_f32 v216, v216
    v_exp_f32 v217, v217
    v_exp_f32 v218, v218
    v_smfmac_f32_32x32x32_bf16 v[104:119], v[228:231], v[208:215], v35
    s_waitcnt lgkmcnt(0)
    v_exp_f32 v219, v219
    v_exp_f32 v220, v220
    v_exp_f32 v221, v221
    v_exp_f32 v222, v222
    v_exp_f32 v223, v223
    v_mfma_f32_32x32x16_bf16 v[192:207], v[148:151], v[136:139], 0
    ds_read_b128 v[144:147], v2 offset:26240
    v_exp_f32 v160, v160
    v_exp_f32 v161, v161
    v_exp_f32 v162, v162
    v_smfmac_f32_32x32x32_bf16 v[104:119], v[236:239], v[216:223], v35
    ds_read_b128 v[236:239], v124 offset:25312
    v_exp_f32 v163, v163
    v_exp_f32 v164, v164
    v_exp_f32 v165, v165
    v_mfma_f32_32x32x16_bf16 v[208:223], v[148:151], v[120:123], 0
    ds_read_b128 v[228:231], v124 offset:24640
    v_exp_f32 v166, v166
    v_exp_f32 v167, v167
    v_exp_f32 v168, v168
    v_exp_f32 v169, v169
    v_smfmac_f32_32x32x32_bf16 v[88:103], v[224:227], v[160:167], v35
    v_exp_f32 v170, v170
    v_exp_f32 v171, v171
    v_exp_f32 v172, v172
    v_exp_f32 v173, v173
    v_mfma_f32_32x32x4_2b_bf16 v[192:223], v[142:143], v[140:141], v[192:223] cbsz:1 abid:1
    ds_read_b64 v[142:143], v39 offset:28608
    v_exp_f32 v174, v174
    v_exp_f32 v175, v175
    v_exp_f32 v176, v176
    v_exp_f32 v177, v177
    v_exp_f32 v178, v178
    v_exp_f32 v179, v179
    v_exp_f32 v180, v180
    v_exp_f32 v181, v181
    v_smfmac_f32_32x32x32_bf16 v[88:103], v[232:235], v[168:175], v35
    v_exp_f32 v182, v182
    v_exp_f32 v183, v183
    v_exp_f32 v184, v184
    v_exp_f32 v185, v185
    v_exp_f32 v186, v186
    v_smfmac_f32_32x32x32_bf16 v[104:119], v[224:227], v[176:183], v35
    s_waitcnt lgkmcnt(0)
    v_exp_f32 v187, v187
    v_exp_f32 v188, v188
    v_exp_f32 v189, v189
    v_exp_f32 v190, v190
    v_exp_f32 v191, v191
    v_mfma_f32_32x32x16_bf16 v[160:175], v[144:147], v[136:139], 0
    ds_read_b128 v[148:151], v2 offset:28864
    v_exp_f32 v192, v192
    v_exp_f32 v193, v193
    v_exp_f32 v194, v194
    v_smfmac_f32_32x32x32_bf16 v[104:119], v[232:235], v[184:191], v35
    ds_read_b128 v[232:235], v124 offset:27936
    v_exp_f32 v195, v195
    v_exp_f32 v196, v196
    v_exp_f32 v197, v197
    v_mfma_f32_32x32x16_bf16 v[176:191], v[144:147], v[120:123], 0
    ds_read_b128 v[224:227], v124 offset:27264
    v_exp_f32 v198, v198
    v_exp_f32 v199, v199
    v_exp_f32 v200, v200
    v_exp_f32 v201, v201
    v_smfmac_f32_32x32x32_bf16 v[88:103], v[228:231], v[192:199], v35
    v_exp_f32 v202, v202
    v_exp_f32 v203, v203
    v_exp_f32 v204, v204
    v_exp_f32 v205, v205
    v_mfma_f32_32x32x4_2b_bf16 v[160:191], v[142:143], v[140:141], v[160:191] cbsz:1 abid:0
    v_exp_f32 v206, v206
    v_exp_f32 v207, v207
    v_exp_f32 v208, v208
    v_exp_f32 v209, v209
    v_exp_f32 v210, v210
    v_exp_f32 v211, v211
    v_exp_f32 v212, v212
    v_exp_f32 v213, v213
    v_smfmac_f32_32x32x32_bf16 v[88:103], v[236:239], v[200:207], v35
    v_exp_f32 v214, v214
    v_exp_f32 v215, v215
    v_exp_f32 v216, v216
    v_exp_f32 v217, v217
    v_exp_f32 v218, v218
    v_smfmac_f32_32x32x32_bf16 v[104:119], v[228:231], v[208:215], v35
    s_waitcnt lgkmcnt(0)
    v_exp_f32 v219, v219
    v_exp_f32 v220, v220
    v_exp_f32 v221, v221
    v_exp_f32 v222, v222
    v_exp_f32 v223, v223
    v_mfma_f32_32x32x16_bf16 v[192:207], v[148:151], v[136:139], 0
    ds_read_b128 v[144:147], v2 offset:31488
    v_exp_f32 v160, v160
    v_exp_f32 v161, v161
    v_exp_f32 v162, v162
    v_smfmac_f32_32x32x32_bf16 v[104:119], v[236:239], v[216:223], v35
    ds_read_b128 v[236:239], v124 offset:30560
    v_exp_f32 v163, v163
    v_exp_f32 v164, v164
    v_exp_f32 v165, v165
    v_mfma_f32_32x32x16_bf16 v[208:223], v[148:151], v[120:123], 0
    ds_read_b128 v[228:231], v124 offset:29888
    v_exp_f32 v166, v166
    v_exp_f32 v167, v167
    v_exp_f32 v168, v168
    v_exp_f32 v169, v169
    v_smfmac_f32_32x32x32_bf16 v[88:103], v[224:227], v[160:167], v35
    v_exp_f32 v170, v170
    v_exp_f32 v171, v171
    v_exp_f32 v172, v172
    v_exp_f32 v173, v173
    v_mfma_f32_32x32x4_2b_bf16 v[192:223], v[142:143], v[140:141], v[192:223] cbsz:1 abid:1
    ds_read_b64 v[142:143], v39 offset:33856
    v_exp_f32 v174, v174
    v_exp_f32 v175, v175
    v_exp_f32 v176, v176
    v_exp_f32 v177, v177
    v_exp_f32 v178, v178
    v_exp_f32 v179, v179
    v_exp_f32 v180, v180
    v_exp_f32 v181, v181
    v_smfmac_f32_32x32x32_bf16 v[88:103], v[232:235], v[168:175], v35
    v_exp_f32 v182, v182
    v_exp_f32 v183, v183
    v_exp_f32 v184, v184
    v_exp_f32 v185, v185
    v_exp_f32 v186, v186
    v_smfmac_f32_32x32x32_bf16 v[104:119], v[224:227], v[176:183], v35
    s_waitcnt lgkmcnt(0)
    v_exp_f32 v187, v187
    v_exp_f32 v188, v188
    v_exp_f32 v189, v189
    v_exp_f32 v190, v190
    v_exp_f32 v191, v191
    v_mfma_f32_32x32x16_bf16 v[160:175], v[144:147], v[136:139], 0
    ds_read_b128 v[148:151], v2 offset:34112
    v_exp_f32 v192, v192
    v_exp_f32 v193, v193
    v_exp_f32 v194, v194
    v_smfmac_f32_32x32x32_bf16 v[104:119], v[232:235], v[184:191], v35
    ds_read_b128 v[232:235], v124 offset:33184
    v_exp_f32 v195, v195
    v_exp_f32 v196, v196
    v_exp_f32 v197, v197
    v_mfma_f32_32x32x16_bf16 v[176:191], v[144:147], v[120:123], 0
    ds_read_b128 v[224:227], v124 offset:32512
    v_exp_f32 v198, v198
    v_exp_f32 v199, v199
    v_exp_f32 v200, v200
    v_exp_f32 v201, v201
    v_smfmac_f32_32x32x32_bf16 v[88:103], v[228:231], v[192:199], v35
    v_exp_f32 v202, v202
    v_exp_f32 v203, v203
    v_exp_f32 v204, v204
    v_exp_f32 v205, v205
    v_mfma_f32_32x32x4_2b_bf16 v[160:191], v[142:143], v[140:141], v[160:191] cbsz:1 abid:0
    v_exp_f32 v206, v206
    v_exp_f32 v207, v207
    v_exp_f32 v208, v208
    v_exp_f32 v209, v209
    v_exp_f32 v210, v210
    v_exp_f32 v211, v211
    v_exp_f32 v212, v212
    v_exp_f32 v213, v213
    v_smfmac_f32_32x32x32_bf16 v[88:103], v[236:239], v[200:207], v35
    v_exp_f32 v214, v214
    v_exp_f32 v215, v215
    v_exp_f32 v216, v216
    v_exp_f32 v217, v217
    v_exp_f32 v218, v218
    v_smfmac_f32_32x32x32_bf16 v[104:119], v[228:231], v[208:215], v35
    s_waitcnt lgkmcnt(0)
    v_exp_f32 v219, v219
    v_exp_f32 v220, v220
    v_exp_f32 v221, v221
    v_exp_f32 v222, v222
    v_exp_f32 v223, v223
    v_mfma_f32_32x32x16_bf16 v[192:207], v[148:151], v[136:139], 0
    ds_read_b128 v[144:147], v2 offset:36736
    v_exp_f32 v160, v160
    v_exp_f32 v161, v161
    v_exp_f32 v162, v162
    v_smfmac_f32_32x32x32_bf16 v[104:119], v[236:239], v[216:223], v35
    ds_read_b128 v[236:239], v124 offset:35808
    v_exp_f32 v163, v163
    v_exp_f32 v164, v164
    v_exp_f32 v165, v165
    v_mfma_f32_32x32x16_bf16 v[208:223], v[148:151], v[120:123], 0
    ds_read_b128 v[228:231], v124 offset:35136
    v_exp_f32 v166, v166
    v_exp_f32 v167, v167
    v_exp_f32 v168, v168
    v_exp_f32 v169, v169
    v_smfmac_f32_32x32x32_bf16 v[88:103], v[224:227], v[160:167], v35
    v_exp_f32 v170, v170
    v_exp_f32 v171, v171
    v_exp_f32 v172, v172
    v_exp_f32 v173, v173
    v_mfma_f32_32x32x4_2b_bf16 v[192:223], v[142:143], v[140:141], v[192:223] cbsz:1 abid:1
    ds_read_b64 v[142:143], v39 offset:39104
    v_exp_f32 v174, v174
    v_exp_f32 v175, v175
    v_exp_f32 v176, v176
    v_exp_f32 v177, v177
    v_exp_f32 v178, v178
    v_exp_f32 v179, v179
    v_exp_f32 v180, v180
    v_exp_f32 v181, v181
    v_smfmac_f32_32x32x32_bf16 v[88:103], v[232:235], v[168:175], v35
    v_exp_f32 v182, v182
    v_exp_f32 v183, v183
    v_exp_f32 v184, v184
    v_exp_f32 v185, v185
    v_exp_f32 v186, v186
    v_smfmac_f32_32x32x32_bf16 v[104:119], v[224:227], v[176:183], v35
    s_waitcnt lgkmcnt(0)
    v_exp_f32 v187, v187
    v_exp_f32 v188, v188
    v_exp_f32 v189, v189
    v_exp_f32 v190, v190
    v_exp_f32 v191, v191
    v_mfma_f32_32x32x16_bf16 v[160:175], v[144:147], v[136:139], 0
    ds_read_b128 v[148:151], v2 offset:39360
    v_exp_f32 v192, v192
    v_exp_f32 v193, v193
    v_exp_f32 v194, v194
    v_smfmac_f32_32x32x32_bf16 v[104:119], v[232:235], v[184:191], v35
    ds_read_b128 v[232:235], v124 offset:38432
    v_exp_f32 v195, v195
    v_exp_f32 v196, v196
    v_exp_f32 v197, v197
    v_mfma_f32_32x32x16_bf16 v[176:191], v[144:147], v[120:123], 0
    ds_read_b128 v[224:227], v124 offset:37760
    v_exp_f32 v198, v198
    v_exp_f32 v199, v199
    v_exp_f32 v200, v200
    v_exp_f32 v201, v201
    v_smfmac_f32_32x32x32_bf16 v[88:103], v[228:231], v[192:199], v35
    v_exp_f32 v202, v202
    v_exp_f32 v203, v203
    v_exp_f32 v204, v204
    v_exp_f32 v205, v205
    v_mfma_f32_32x32x4_2b_bf16 v[160:191], v[142:143], v[140:141], v[160:191] cbsz:1 abid:0
    v_exp_f32 v206, v206
    v_exp_f32 v207, v207
    v_exp_f32 v208, v208
    v_exp_f32 v209, v209
    v_exp_f32 v210, v210
    v_exp_f32 v211, v211
    v_exp_f32 v212, v212
    v_exp_f32 v213, v213
    v_smfmac_f32_32x32x32_bf16 v[88:103], v[236:239], v[200:207], v35
    v_exp_f32 v214, v214
    v_exp_f32 v215, v215
    v_exp_f32 v216, v216
    v_exp_f32 v217, v217
    v_exp_f32 v218, v218
    v_smfmac_f32_32x32x32_bf16 v[104:119], v[228:231], v[208:215], v35
    s_waitcnt lgkmcnt(0)
    v_exp_f32 v219, v219
    v_exp_f32 v220, v220
    v_exp_f32 v221, v221
    v_exp_f32 v222, v222
    v_exp_f32 v223, v223
    v_mfma_f32_32x32x16_bf16 v[192:207], v[148:151], v[136:139], 0
    s_barrier
    ds_read_b128 v[144:147], v2 offset:41984
    v_exp_f32 v160, v160
    v_exp_f32 v161, v161
    v_exp_f32 v162, v162
    v_smfmac_f32_32x32x32_bf16 v[104:119], v[236:239], v[216:223], v35
    ds_read_b128 v[236:239], v124 offset:41056
    v_exp_f32 v163, v163
    v_exp_f32 v164, v164
    v_exp_f32 v165, v165
    v_mfma_f32_32x32x16_bf16 v[208:223], v[148:151], v[120:123], 0
    ds_read_b128 v[228:231], v124 offset:40384
    v_exp_f32 v166, v166
    v_exp_f32 v167, v167
    v_exp_f32 v168, v168
    v_exp_f32 v169, v169
    v_smfmac_f32_32x32x32_bf16 v[88:103], v[224:227], v[160:167], v35
    v_exp_f32 v170, v170
    v_exp_f32 v171, v171
    v_exp_f32 v172, v172
    v_exp_f32 v173, v173
    v_mfma_f32_32x32x4_2b_bf16 v[192:223], v[142:143], v[140:141], v[192:223] cbsz:1 abid:1
    ds_read_b64 v[142:143], v39 offset:44352
    v_exp_f32 v174, v174
    v_exp_f32 v175, v175
    v_exp_f32 v176, v176
    v_exp_f32 v177, v177
    v_exp_f32 v178, v178
    v_exp_f32 v179, v179
    v_exp_f32 v180, v180
    v_exp_f32 v181, v181
    v_smfmac_f32_32x32x32_bf16 v[88:103], v[232:235], v[168:175], v35
    v_exp_f32 v182, v182
    v_exp_f32 v183, v183
    v_exp_f32 v184, v184
    v_exp_f32 v185, v185
    v_exp_f32 v186, v186
    v_smfmac_f32_32x32x32_bf16 v[104:119], v[224:227], v[176:183], v35
    s_waitcnt lgkmcnt(0)
    v_exp_f32 v187, v187
    v_exp_f32 v188, v188
    v_exp_f32 v189, v189
    v_exp_f32 v190, v190
    v_exp_f32 v191, v191
    v_mfma_f32_32x32x16_bf16 v[160:175], v[144:147], v[136:139], 0
    ds_read_b128 v[148:151], v2 offset:44608
    v_exp_f32 v192, v192
    v_exp_f32 v193, v193
    v_exp_f32 v194, v194
    v_smfmac_f32_32x32x32_bf16 v[104:119], v[232:235], v[184:191], v35
    ds_read_b128 v[232:235], v124 offset:43680
    v_exp_f32 v195, v195
    v_exp_f32 v196, v196
    v_exp_f32 v197, v197
    v_mfma_f32_32x32x16_bf16 v[176:191], v[144:147], v[120:123], 0
    ds_read_b128 v[224:227], v124 offset:43008
    v_exp_f32 v198, v198
    v_exp_f32 v199, v199
    v_exp_f32 v200, v200
    v_exp_f32 v201, v201
    v_smfmac_f32_32x32x32_bf16 v[88:103], v[228:231], v[192:199], v35
    v_exp_f32 v202, v202
    v_exp_f32 v203, v203
    v_exp_f32 v204, v204
    v_exp_f32 v205, v205
    v_mfma_f32_32x32x4_2b_bf16 v[160:191], v[142:143], v[140:141], v[160:191] cbsz:1 abid:0
    v_exp_f32 v206, v206
    v_exp_f32 v207, v207
    v_exp_f32 v208, v208
    v_exp_f32 v209, v209
    v_exp_f32 v210, v210
    v_exp_f32 v211, v211
    v_exp_f32 v212, v212
    v_exp_f32 v213, v213
    v_smfmac_f32_32x32x32_bf16 v[88:103], v[236:239], v[200:207], v35
    v_exp_f32 v214, v214
    v_exp_f32 v215, v215
    v_exp_f32 v216, v216
    v_exp_f32 v217, v217
    v_exp_f32 v218, v218
    v_smfmac_f32_32x32x32_bf16 v[104:119], v[228:231], v[208:215], v35
    s_waitcnt lgkmcnt(0)
    v_exp_f32 v219, v219
    v_exp_f32 v220, v220
    v_exp_f32 v221, v221
    v_exp_f32 v222, v222
    v_exp_f32 v223, v223
    v_mfma_f32_32x32x16_bf16 v[192:207], v[148:151], v[136:139], 0
    s_barrier
    ds_read_b128 v[144:147], v2 offset:47232
    v_exp_f32 v160, v160
    v_exp_f32 v161, v161
    v_exp_f32 v162, v162
    v_smfmac_f32_32x32x32_bf16 v[104:119], v[236:239], v[216:223], v35
    ds_read_b128 v[236:239], v124 offset:46304
    v_exp_f32 v163, v163
    v_exp_f32 v164, v164
    v_exp_f32 v165, v165
    v_mfma_f32_32x32x16_bf16 v[208:223], v[148:151], v[120:123], 0
    ds_read_b128 v[228:231], v124 offset:45632
    v_exp_f32 v166, v166
    v_exp_f32 v167, v167
    v_exp_f32 v168, v168
    v_exp_f32 v169, v169
    v_smfmac_f32_32x32x32_bf16 v[88:103], v[224:227], v[160:167], v35
    v_exp_f32 v170, v170
    v_exp_f32 v171, v171
    v_exp_f32 v172, v172
    v_exp_f32 v173, v173
    v_mfma_f32_32x32x4_2b_bf16 v[192:223], v[142:143], v[140:141], v[192:223] cbsz:1 abid:1
    ds_read_b64 v[142:143], v39 offset:49600
    v_exp_f32 v174, v174
    v_exp_f32 v175, v175
    v_exp_f32 v176, v176
    v_exp_f32 v177, v177
    v_exp_f32 v178, v178
    v_exp_f32 v179, v179
    v_exp_f32 v180, v180
    v_exp_f32 v181, v181
    v_smfmac_f32_32x32x32_bf16 v[88:103], v[232:235], v[168:175], v35
    v_exp_f32 v182, v182
    v_exp_f32 v183, v183
    v_exp_f32 v184, v184
    v_exp_f32 v185, v185
    v_exp_f32 v186, v186
    v_smfmac_f32_32x32x32_bf16 v[104:119], v[224:227], v[176:183], v35
    s_waitcnt lgkmcnt(0)
    v_exp_f32 v187, v187
    v_exp_f32 v188, v188
    v_exp_f32 v189, v189
    v_exp_f32 v190, v190
    v_exp_f32 v191, v191
    v_mfma_f32_32x32x16_bf16 v[160:175], v[144:147], v[136:139], 0
    ds_read_b128 v[148:151], v2 offset:49856
    v_exp_f32 v192, v192
    v_exp_f32 v193, v193
    v_exp_f32 v194, v194
    v_smfmac_f32_32x32x32_bf16 v[104:119], v[232:235], v[184:191], v35
    ds_read_b128 v[232:235], v124 offset:48928
    v_exp_f32 v195, v195
    v_exp_f32 v196, v196
    v_exp_f32 v197, v197
    v_mfma_f32_32x32x16_bf16 v[176:191], v[144:147], v[120:123], 0
    ds_read_b128 v[224:227], v124 offset:48256
    v_exp_f32 v198, v198
    v_exp_f32 v199, v199
    v_exp_f32 v200, v200
    v_exp_f32 v201, v201
    v_smfmac_f32_32x32x32_bf16 v[88:103], v[228:231], v[192:199], v35
    v_exp_f32 v202, v202
    v_exp_f32 v203, v203
    v_exp_f32 v204, v204
    v_exp_f32 v205, v205
    v_mfma_f32_32x32x4_2b_bf16 v[160:191], v[142:143], v[140:141], v[160:191] cbsz:1 abid:0
    v_exp_f32 v206, v206
    v_exp_f32 v207, v207
    v_exp_f32 v208, v208
    v_exp_f32 v209, v209
    v_exp_f32 v210, v210
    v_exp_f32 v211, v211
    v_exp_f32 v212, v212
    v_exp_f32 v213, v213
    v_smfmac_f32_32x32x32_bf16 v[88:103], v[236:239], v[200:207], v35
    v_exp_f32 v214, v214
    v_exp_f32 v215, v215
    v_exp_f32 v216, v216
    v_exp_f32 v217, v217
    v_exp_f32 v218, v218
    v_smfmac_f32_32x32x32_bf16 v[104:119], v[228:231], v[208:215], v35
    s_waitcnt lgkmcnt(0)
    v_exp_f32 v219, v219
    v_exp_f32 v220, v220
    v_exp_f32 v221, v221
    v_exp_f32 v222, v222
    v_exp_f32 v223, v223
    v_mfma_f32_32x32x16_bf16 v[192:207], v[148:151], v[136:139], 0
    ds_read_b128 v[144:147], v2 offset:52480
    v_exp_f32 v160, v160
    v_exp_f32 v161, v161
    v_exp_f32 v162, v162
    v_smfmac_f32_32x32x32_bf16 v[104:119], v[236:239], v[216:223], v35
    ds_read_b128 v[236:239], v124 offset:51552
    v_exp_f32 v163, v163
    v_exp_f32 v164, v164
    v_exp_f32 v165, v165
    v_mfma_f32_32x32x16_bf16 v[208:223], v[148:151], v[120:123], 0
    ds_read_b128 v[228:231], v124 offset:50880
    v_exp_f32 v166, v166
    v_exp_f32 v167, v167
    v_exp_f32 v168, v168
    v_exp_f32 v169, v169
    v_smfmac_f32_32x32x32_bf16 v[88:103], v[224:227], v[160:167], v35
    v_exp_f32 v170, v170
    v_exp_f32 v171, v171
    v_exp_f32 v172, v172
    v_exp_f32 v173, v173
    v_mfma_f32_32x32x4_2b_bf16 v[192:223], v[142:143], v[140:141], v[192:223] cbsz:1 abid:1
    ds_read_b64 v[142:143], v39 offset:54848
    v_exp_f32 v174, v174
    v_exp_f32 v175, v175
    v_exp_f32 v176, v176
    v_exp_f32 v177, v177
    v_exp_f32 v178, v178
    v_exp_f32 v179, v179
    v_exp_f32 v180, v180
    v_exp_f32 v181, v181
    v_smfmac_f32_32x32x32_bf16 v[88:103], v[232:235], v[168:175], v35
    v_exp_f32 v182, v182
    v_exp_f32 v183, v183
    v_exp_f32 v184, v184
    v_exp_f32 v185, v185
    v_exp_f32 v186, v186
    v_smfmac_f32_32x32x32_bf16 v[104:119], v[224:227], v[176:183], v35
    s_waitcnt lgkmcnt(0)
    v_exp_f32 v187, v187
    v_exp_f32 v188, v188
    v_exp_f32 v189, v189
    v_exp_f32 v190, v190
    v_exp_f32 v191, v191
    v_mfma_f32_32x32x16_bf16 v[160:175], v[144:147], v[136:139], 0
    ds_read_b128 v[148:151], v2 offset:55104
    v_exp_f32 v192, v192
    v_exp_f32 v193, v193
    v_exp_f32 v194, v194
    v_smfmac_f32_32x32x32_bf16 v[104:119], v[232:235], v[184:191], v35
    ds_read_b128 v[232:235], v124 offset:54176
    v_exp_f32 v195, v195
    v_exp_f32 v196, v196
    v_exp_f32 v197, v197
    v_mfma_f32_32x32x16_bf16 v[176:191], v[144:147], v[120:123], 0
    ds_read_b128 v[224:227], v124 offset:53504
    v_exp_f32 v198, v198
    v_exp_f32 v199, v199
    v_exp_f32 v200, v200
    v_exp_f32 v201, v201
    v_smfmac_f32_32x32x32_bf16 v[88:103], v[228:231], v[192:199], v35
    v_exp_f32 v202, v202
    v_exp_f32 v203, v203
    v_exp_f32 v204, v204
    v_exp_f32 v205, v205
    v_mfma_f32_32x32x4_2b_bf16 v[160:191], v[142:143], v[140:141], v[160:191] cbsz:1 abid:0
    v_exp_f32 v206, v206
    v_exp_f32 v207, v207
    v_exp_f32 v208, v208
    v_exp_f32 v209, v209
    v_exp_f32 v210, v210
    v_exp_f32 v211, v211
    v_exp_f32 v212, v212
    v_exp_f32 v213, v213
    v_smfmac_f32_32x32x32_bf16 v[88:103], v[236:239], v[200:207], v35
    v_exp_f32 v214, v214
    v_exp_f32 v215, v215
    v_exp_f32 v216, v216
    v_exp_f32 v217, v217
    v_exp_f32 v218, v218
    v_smfmac_f32_32x32x32_bf16 v[104:119], v[228:231], v[208:215], v35
    s_waitcnt lgkmcnt(0)
    v_exp_f32 v219, v219
    v_exp_f32 v220, v220
    v_exp_f32 v221, v221
    v_exp_f32 v222, v222
    v_exp_f32 v223, v223
    v_mfma_f32_32x32x16_bf16 v[192:207], v[148:151], v[136:139], 0
    ds_read_b128 v[144:147], v2 offset:57728
    v_exp_f32 v160, v160
    v_exp_f32 v161, v161
    v_exp_f32 v162, v162
    v_smfmac_f32_32x32x32_bf16 v[104:119], v[236:239], v[216:223], v35
    ds_read_b128 v[236:239], v124 offset:56800
    v_exp_f32 v163, v163
    v_exp_f32 v164, v164
    v_exp_f32 v165, v165
    v_mfma_f32_32x32x16_bf16 v[208:223], v[148:151], v[120:123], 0
    ds_read_b128 v[228:231], v124 offset:56128
    v_exp_f32 v166, v166
    v_exp_f32 v167, v167
    v_exp_f32 v168, v168
    v_exp_f32 v169, v169
    v_smfmac_f32_32x32x32_bf16 v[88:103], v[224:227], v[160:167], v35
    v_exp_f32 v170, v170
    v_exp_f32 v171, v171
    v_exp_f32 v172, v172
    v_exp_f32 v173, v173
    v_mfma_f32_32x32x4_2b_bf16 v[192:223], v[142:143], v[140:141], v[192:223] cbsz:1 abid:1
    ds_read_b64 v[142:143], v39 offset:60096
    v_exp_f32 v174, v174
    v_exp_f32 v175, v175
    v_exp_f32 v176, v176
    v_exp_f32 v177, v177
    v_exp_f32 v178, v178
    v_exp_f32 v179, v179
    v_exp_f32 v180, v180
    v_exp_f32 v181, v181
    v_smfmac_f32_32x32x32_bf16 v[88:103], v[232:235], v[168:175], v35
    v_exp_f32 v182, v182
    v_exp_f32 v183, v183
    v_exp_f32 v184, v184
    v_exp_f32 v185, v185
    v_exp_f32 v186, v186
    v_smfmac_f32_32x32x32_bf16 v[104:119], v[224:227], v[176:183], v35
    s_waitcnt lgkmcnt(0)
    v_exp_f32 v187, v187
    v_exp_f32 v188, v188
    v_exp_f32 v189, v189
    v_exp_f32 v190, v190
    v_exp_f32 v191, v191
    v_mfma_f32_32x32x16_bf16 v[160:175], v[144:147], v[136:139], 0
    ds_read_b128 v[148:151], v2 offset:60352
    v_exp_f32 v192, v192
    v_exp_f32 v193, v193
    v_exp_f32 v194, v194
    v_smfmac_f32_32x32x32_bf16 v[104:119], v[232:235], v[184:191], v35
    ds_read_b128 v[232:235], v124 offset:59424
    v_exp_f32 v195, v195
    v_exp_f32 v196, v196
    v_exp_f32 v197, v197
    v_mfma_f32_32x32x16_bf16 v[176:191], v[144:147], v[120:123], 0
    ds_read_b128 v[224:227], v124 offset:58752
    v_exp_f32 v198, v198
    v_exp_f32 v199, v199
    v_exp_f32 v200, v200
    v_exp_f32 v201, v201
    v_smfmac_f32_32x32x32_bf16 v[88:103], v[228:231], v[192:199], v35
    v_exp_f32 v202, v202
    v_exp_f32 v203, v203
    v_exp_f32 v204, v204
    v_exp_f32 v205, v205
    v_mfma_f32_32x32x4_2b_bf16 v[160:191], v[142:143], v[140:141], v[160:191] cbsz:1 abid:0
    v_exp_f32 v206, v206
    v_exp_f32 v207, v207
    v_exp_f32 v208, v208
    v_exp_f32 v209, v209
    v_exp_f32 v210, v210
    v_exp_f32 v211, v211
    v_exp_f32 v212, v212
    v_exp_f32 v213, v213
    v_smfmac_f32_32x32x32_bf16 v[88:103], v[236:239], v[200:207], v35
    v_exp_f32 v214, v214
    v_exp_f32 v215, v215
    v_exp_f32 v216, v216
    v_exp_f32 v217, v217
    v_exp_f32 v218, v218
    v_smfmac_f32_32x32x32_bf16 v[104:119], v[228:231], v[208:215], v35
    s_waitcnt lgkmcnt(0)
    v_exp_f32 v219, v219
    v_exp_f32 v220, v220
    v_exp_f32 v221, v221
    v_exp_f32 v222, v222
    v_exp_f32 v223, v223
    v_mfma_f32_32x32x16_bf16 v[192:207], v[148:151], v[136:139], 0
    v_exp_f32 v160, v160
    v_exp_f32 v161, v161
    v_exp_f32 v162, v162
    v_smfmac_f32_32x32x32_bf16 v[104:119], v[236:239], v[216:223], v35
    ds_read_b128 v[236:239], v124 offset:62048
    v_exp_f32 v163, v163
    v_exp_f32 v164, v164
    v_exp_f32 v165, v165
    v_mfma_f32_32x32x16_bf16 v[208:223], v[148:151], v[120:123], 0
    ds_read_b128 v[228:231], v124 offset:61376
    v_exp_f32 v166, v166
    v_exp_f32 v167, v167
    v_exp_f32 v168, v168
    v_exp_f32 v169, v169
    v_smfmac_f32_32x32x32_bf16 v[88:103], v[224:227], v[160:167], v35
    ds_read_b32 v131, v130
    v_exp_f32 v170, v170
    v_exp_f32 v171, v171
    v_exp_f32 v172, v172
    v_exp_f32 v173, v173
    v_mfma_f32_32x32x4_2b_bf16 v[192:223], v[142:143], v[140:141], v[192:223] cbsz:1 abid:1
    v_exp_f32 v174, v174
    v_exp_f32 v175, v175
    v_exp_f32 v176, v176
    v_exp_f32 v177, v177
    v_exp_f32 v178, v178
    v_exp_f32 v179, v179
    v_exp_f32 v180, v180
    v_exp_f32 v181, v181
    v_smfmac_f32_32x32x32_bf16 v[88:103], v[232:235], v[168:175], v35
    v_exp_f32 v182, v182
    v_exp_f32 v183, v183
    v_exp_f32 v184, v184
    v_exp_f32 v185, v185
    v_exp_f32 v186, v186
    v_smfmac_f32_32x32x32_bf16 v[104:119], v[224:227], v[176:183], v35
    s_waitcnt lgkmcnt(0)
    v_exp_f32 v187, v187
    v_exp_f32 v188, v188
    v_exp_f32 v189, v189
    v_exp_f32 v190, v190
    v_exp_f32 v191, v191
    v_exp_f32 v192, v192
    v_exp_f32 v193, v193
    v_exp_f32 v194, v194
    v_smfmac_f32_32x32x32_bf16 v[104:119], v[232:235], v[184:191], v35
    s_barrier
    v_exp_f32 v195, v195
    v_exp_f32 v196, v196
    v_exp_f32 v197, v197
    v_exp_f32 v198, v198
    v_exp_f32 v199, v199
    v_exp_f32 v200, v200
    v_exp_f32 v201, v201
    v_smfmac_f32_32x32x32_bf16 v[88:103], v[228:231], v[192:199], v35
    v_exp_f32 v202, v202
    v_exp_f32 v203, v203
    v_exp_f32 v204, v204
    v_exp_f32 v205, v205
    v_exp_f32 v206, v206
    v_exp_f32 v207, v207
    v_exp_f32 v208, v208
    v_exp_f32 v209, v209
    v_exp_f32 v210, v210
    v_exp_f32 v211, v211
    v_exp_f32 v212, v212
    v_exp_f32 v213, v213
    v_smfmac_f32_32x32x32_bf16 v[88:103], v[236:239], v[200:207], v35
    v_exp_f32 v214, v214
    v_exp_f32 v215, v215
    v_exp_f32 v216, v216
    v_exp_f32 v217, v217
    v_exp_f32 v218, v218
    v_smfmac_f32_32x32x32_bf16 v[104:119], v[228:231], v[208:215], v35
    s_waitcnt lgkmcnt(0)
    v_exp_f32 v219, v219
    v_exp_f32 v220, v220
    v_exp_f32 v221, v221
    v_exp_f32 v222, v222
    v_exp_f32 v223, v223
    v_readfirstlane_b32 s28, v131
    s_nop 0
    v_smfmac_f32_32x32x32_bf16 v[104:119], v[236:239], v[216:223], v35
L_att_fin:
    s_cmp_eq_u32 s28, 0
    s_cbranch_scc1 L_chain_safe
    s_mov_b32 s46, 393216
    s_mov_b32 exec_lo, 0
    v_mov_b32 v100, v96
    s_mov_b32 exec_lo, -1
    v_rcp_f32 v130, v100
    s_nop 0
    v_pk_mul_f32 v[88:89], v[88:89], v[130:131] op_sel_hi:[1,0]
    v_pk_mul_f32 v[90:91], v[90:91], v[130:131] op_sel_hi:[1,0]
    v_pk_mul_f32 v[92:93], v[92:93], v[130:131] op_sel_hi:[1,0]
    v_pk_mul_f32 v[94:95], v[94:95], v[130:131] op_sel_hi:[1,0]
    v_pk_mul_f32 v[96:97], v[96:97], v[130:131] op_sel_hi:[1,0]
    v_pk_mul_f32 v[98:99], v[98:99], v[130:131] op_sel_hi:[1,0]
    v_cvt_pk_bf16_f32 v240, v88, v89
    v_cvt_pk_bf16_f32 v241, v90, v91
    v_cvt_pk_bf16_f32 v242, v92, v93
    v_cvt_pk_bf16_f32 v243, v94, v95
    v_cvt_pk_bf16_f32 v244, v96, v97
    v_cvt_pk_bf16_f32 v245, v98, v99
    buffer_store_dwordx4 v[240:243], v41, s[4:7], 0 offen
    s_mov_b32 exec_hi, 0
    buffer_store_dwordx2 v[244:245], v42, s[4:7], 0 offen
    s_mov_b32 exec_hi, -1
    s_mov_b32 exec_lo, 0
    v_mov_b32 v116, v112
    s_mov_b32 exec_lo, -1
    v_rcp_f32 v130, v116
    s_nop 0
    v_pk_mul_f32 v[104:105], v[104:105], v[130:131] op_sel_hi:[1,0]
    v_pk_mul_f32 v[106:107], v[106:107], v[130:131] op_sel_hi:[1,0]
    v_pk_mul_f32 v[108:109], v[108:109], v[130:131] op_sel_hi:[1,0]
    v_pk_mul_f32 v[110:111], v[110:111], v[130:131] op_sel_hi:[1,0]
    v_pk_mul_f32 v[112:113], v[112:113], v[130:131] op_sel_hi:[1,0]
    v_pk_mul_f32 v[114:115], v[114:115], v[130:131] op_sel_hi:[1,0]
    v_cvt_pk_bf16_f32 v248, v104, v105
    v_cvt_pk_bf16_f32 v249, v106, v107
    v_cvt_pk_bf16_f32 v250, v108, v109
    v_cvt_pk_bf16_f32 v251, v110, v111
    v_cvt_pk_bf16_f32 v252, v112, v113
    v_cvt_pk_bf16_f32 v253, v114, v115
    buffer_store_dwordx4 v[248:251], v41, s[4:7], s46 offen
    s_mov_b32 exec_hi, 0
    buffer_store_dwordx2 v[252:253], v42, s[4:7], s46 offen
    s_mov_b32 exec_hi, -1
    v_pk_mul_f32 v[128:129], v[88:89], 0 op_sel_hi:[1,0]
    v_pk_fma_f32 v[128:129], v[90:91], 0, v[128:129] op_sel_hi:[1,0,1]
    v_pk_fma_f32 v[128:129], v[92:93], 0, v[128:129] op_sel_hi:[1,0,1]
    v_pk_fma_f32 v[128:129], v[94:95], 0, v[128:129] op_sel_hi:[1,0,1]
    v_pk_fma_f32 v[128:129], v[96:97], 0, v[128:129] op_sel_hi:[1,0,1]
    v_pk_fma_f32 v[128:129], v[98:99], 0, v[128:129] op_sel_hi:[1,0,1]
    v_add_f32 v128, v128, v129
    v_add_f32 v128, v128, v100
    v_cmp_nle_f32 vcc, 0x37800000, v128
    s_mov_b64 s[52:53], vcc
    v_cmp_nge_f32 vcc, 0x5f800000, v128
    s_or_b64 s[52:53], vcc, s[52:53]
    v_pk_mul_f32 v[128:129], v[104:105], 0 op_sel_hi:[1,0]
    v_pk_fma_f32 v[128:129], v[106:107], 0, v[128:129] op_sel_hi:[1,0,1]
    v_pk_fma_f32 v[128:129], v[108:109], 0, v[128:129] op_sel_hi:[1,0,1]
    v_pk_fma_f32 v[128:129], v[110:111], 0, v[128:129] op_sel_hi:[1,0,1]
    v_pk_fma_f32 v[128:129], v[112:113], 0, v[128:129] op_sel_hi:[1,0,1]
    v_pk_fma_f32 v[128:129], v[114:115], 0, v[128:129] op_sel_hi:[1,0,1]
    v_add_f32 v128, v128, v129
    v_add_f32 v128, v128, v116
    v_cmp_nle_f32 vcc, 0x37800000, v128
    s_or_b64 s[52:53], vcc, s[52:53]
    v_cmp_nge_f32 vcc, 0x5f800000, v128
    s_or_b64 s[52:53], vcc, s[52:53]
    s_lshl_b32 s44, s35, 7
    s_lshl_b32 s45, s25, 2
    s_add_u32 s44, s44, s45
    s_add_u32 s45, s27, 1
    v_lshlrev_b32 v128, 9, v1
    v_mov_b32 v129, s45
    s_and_b64 s[52:53], s[52:53], s[100:101]
    s_cbranch_scc1 L_slow
    ds_read_b128 v[156:159], v2 offset:63488
    ds_read_b128 v[160:163], v2 offset:64512
    ds_read_b128 v[164:167], v3 offset:0
    ds_read_b128 v[168:171], v3 offset:1024
    ds_read_b128 v[172:175], v3 offset:2048
    ds_read_b128 v[176:179], v3 offset:3072
    ds_read_b128 v[180:183], v3 offset:4096
    ds_read_b128 v[184:187], v3 offset:5120
    ds_read_b128 v[188:191], v3 offset:6144
    ds_read_b128 v[192:195], v3 offset:7168
    s_lshr_b32 s96, s31, 1
    s_lshl_b32 s96, s96, 7
    s_and_b32 s45, s31, 1
    s_lshl_b32 s45, s45, 2
    s_add_u32 s96, s96, s45
    s_lshl_b32 s45, s33, 3
    s_add_u32 s96, s96, s45
    s_add_u32 s96, s96, 8192
    s_lshr_b32 s46, s31, 1
    s_lshl_b32 s46, s46, 7
    s_add_u32 s45, s27, 1
    s_mul_i32 s60, s31, 49152
    s_add_u32 s60, s60, 3080192
    s_mov_b64 exec, 3
    s_waitcnt vmcnt(0)
    buffer_store_dword v129, v128, s[4:7], s44 offen
    s_mov_b64 exec, -1
Lpoll_19:
    buffer_load_dword v136, v46, s[4:7], s46 offen sc1
    s_waitcnt vmcnt(0)
    v_cmp_gt_u32 vcc, s45, v136
    s_cbranch_vccz Lpolld_20
    s_sub_u32 s29, s29, 1
    s_cbranch_scc0 Lpoll_19
    s_mov_b32 s29, 0
Lpolld_20:
    buffer_load_dwordx4 v[216:219], v2, s[4:7], s60 offen offset:0 sc1
    buffer_load_dwordx4 v[220:223], v2, s[4:7], s60 offen offset:1024 sc1
    buffer_load_dwordx4 v[224:227], v2, s[4:7], s60 offen offset:2048 sc1
    buffer_load_dwordx4 v[228:231], v2, s[4:7], s60 offen offset:3072 sc1
    s_add_u32 s60, s60, 4096
    buffer_load_dwordx4 v[232:235], v2, s[4:7], s60 offen offset:0 sc1
    buffer_load_dwordx4 v[236:239], v2, s[4:7], s60 offen offset:1024 sc1
    buffer_load_dwordx4 v[240:243], v2, s[4:7], s60 offen offset:2048 sc1
    s_waitcnt vmcnt(6) lgkmcnt(5)
    v_mfma_f32_16x16x32_bf16 v[8:11], v[156:159], v[216:219], v[8:11]
    ds_read_b128 v[196:199], v3 offset:8192
    buffer_load_dwordx4 v[244:247], v2, s[4:7], s60 offen offset:3072 sc1
    v_mfma_f32_16x16x32_bf16 v[12:15], v[160:163], v[216:219], v[12:15]
    ds_read_b128 v[200:203], v3 offset:9216
    v_mfma_f32_16x16x32_bf16 v[16:19], v[164:167], v[216:219], v[16:19]
    ds_read_b128 v[204:207], v3 offset:10240
    v_mfma_f32_16x16x32_bf16 v[20:23], v[168:171], v[216:219], v[20:23]
    ds_read_b128 v[208:211], v3 offset:11264
    v_mfma_f32_16x16x32_bf16 v[24:27], v[172:175], v[216:219], v[24:27]
    ds_read_b128 v[212:215], v3 offset:12288
    s_waitcnt vmcnt(6) lgkmcnt(5)
    v_mfma_f32_16x16x32_bf16 v[8:11], v[176:179], v[220:223], v[8:11]
    ds_read_b128 v[156:159], v3 offset:13312
    s_add_u32 s60, s60, 4096
    buffer_load_dwordx4 v[216:219], v2, s[4:7], s60 offen offset:0 sc1
    v_mfma_f32_16x16x32_bf16 v[12:15], v[180:183], v[220:223], v[12:15]
    ds_read_b128 v[160:163], v3 offset:14336
    v_mfma_f32_16x16x32_bf16 v[16:19], v[184:187], v[220:223], v[16:19]
    ds_read_b128 v[164:167], v3 offset:15360
    v_mfma_f32_16x16x32_bf16 v[20:23], v[188:191], v[220:223], v[20:23]
    ds_read_b128 v[168:171], v3 offset:16384
    v_mfma_f32_16x16x32_bf16 v[24:27], v[192:195], v[220:223], v[24:27]
    ds_read_b128 v[172:175], v3 offset:17408
    s_waitcnt vmcnt(6) lgkmcnt(5)
    v_mfma_f32_16x16x32_bf16 v[8:11], v[196:199], v[224:227], v[8:11]
    ds_read_b128 v[176:179], v3 offset:18432
    buffer_load_dwordx4 v[220:223], v2, s[4:7], s60 offen offset:1024 sc1
    v_mfma_f32_16x16x32_bf16 v[12:15], v[200:203], v[224:227], v[12:15]
    ds_read_b128 v[180:183], v3 offset:19456
    v_mfma_f32_16x16x32_bf16 v[16:19], v[204:207], v[224:227], v[16:19]
    ds_read_b128 v[184:187], v3 offset:20480
    v_mfma_f32_16x16x32_bf16 v[20:23], v[208:211], v[224:227], v[20:23]
    ds_read_b128 v[188:191], v3 offset:21504
    v_mfma_f32_16x16x32_bf16 v[24:27], v[212:215], v[224:227], v[24:27]
    ds_read_b128 v[192:195], v3 offset:22528
    s_waitcnt vmcnt(6) lgkmcnt(5)
    v_mfma_f32_16x16x32_bf16 v[8:11], v[156:159], v[228:231], v[8:11]
    ds_read_b128 v[196:199], v3 offset:23552
    buffer_load_dwordx4 v[224:227], v2, s[4:7], s60 offen offset:2048 sc1
    v_mfma_f32_16x16x32_bf16 v[12:15], v[160:163], v[228:231], v[12:15]
    ds_read_b128 v[200:203], v3 offset:24576
    v_mfma_f32_16x16x32_bf16 v[16:19], v[164:167], v[228:231], v[16:19]
    ds_read_b128 v[204:207], v3 offset:25600
    v_mfma_f32_16x16x32_bf16 v[20:23], v[168:171], v[228:231], v[20:23]
    ds_read_b128 v[208:211], v3 offset:26624
    v_mfma_f32_16x16x32_bf16 v[24:27], v[172:175], v[228:231], v[24:27]
    ds_read_b128 v[212:215], v3 offset:27648
    s_waitcnt vmcnt(6) lgkmcnt(5)
    v_mfma_f32_16x16x32_bf16 v[8:11], v[176:179], v[232:235], v[8:11]
    ds_read_b128 v[156:159], v3 offset:28672
    buffer_load_dwordx4 v[228:231], v2, s[4:7], s60 offen offset:3072 sc1
    v_mfma_f32_16x16x32_bf16 v[12:15], v[180:183], v[232:235], v[12:15]
    ds_read_b128 v[160:163], v3 offset:29696
    v_mfma_f32_16x16x32_bf16 v[16:19], v[184:187], v[232:235], v[16:19]
    ds_read_b128 v[164:167], v3 offset:30720
    v_mfma_f32_16x16x32_bf16 v[20:23], v[188:191], v[232:235], v[20:23]
    ds_read_b128 v[168:171], v3 offset:31744
    v_mfma_f32_16x16x32_bf16 v[24:27], v[192:195], v[232:235], v[24:27]
    ds_read_b128 v[172:175], v3 offset:32768
    s_waitcnt vmcnt(6) lgkmcnt(5)
    v_mfma_f32_16x16x32_bf16 v[8:11], v[196:199], v[236:239], v[8:11]
    ds_read_b128 v[176:179], v3 offset:33792
    s_add_u32 s60, s60, 4096
    buffer_load_dwordx4 v[232:235], v2, s[4:7], s60 offen offset:0 sc1
    v_mfma_f32_16x16x32_bf16 v[12:15], v[200:203], v[236:239], v[12:15]
    ds_read_b128 v[180:183], v3 offset:34816
    v_mfma_f32_16x16x32_bf16 v[16:19], v[204:207], v[236:239], v[16:19]
    ds_read_b128 v[184:187], v3 offset:35840
    v_mfma_f32_16x16x32_bf16 v[20:23], v[208:211], v[236:239], v[20:23]
    ds_read_b128 v[188:191], v3 offset:36864
    v_mfma_f32_16x16x32_bf16 v[24:27], v[212:215], v[236:239], v[24:27]
    ds_read_b128 v[192:195], v3 offset:37888
    s_waitcnt vmcnt(6) lgkmcnt(5)
    v_mfma_f32_16x16x32_bf16 v[8:11], v[156:159], v[240:243], v[8:11]
    ds_read_b128 v[196:199], v3 offset:38912
    buffer_load_dwordx4 v[236:239], v2, s[4:7], s60 offen offset:1024 sc1
    v_mfma_f32_16x16x32_bf16 v[12:15], v[160:163], v[240:243], v[12:15]
    ds_read_b128 v[200:203], v3 offset:39936
    v_mfma_f32_16x16x32_bf16 v[16:19], v[164:167], v[240:243], v[16:19]
    ds_read_b128 v[204:207], v3 offset:40960
    v_mfma_f32_16x16x32_bf16 v[20:23], v[168:171], v[240:243], v[20:23]
    ds_read_b128 v[208:211], v3 offset:41984
    v_mfma_f32_16x16x32_bf16 v[24:27], v[172:175], v[240:243], v[24:27]
    ds_read_b128 v[212:215], v3 offset:43008
    s_waitcnt vmcnt(6) lgkmcnt(5)
    v_mfma_f32_16x16x32_bf16 v[8:11], v[176:179], v[244:247], v[8:11]
    ds_read_b128 v[156:159], v3 offset:44032
    buffer_load_dwordx4 v[240:243], v2, s[4:7], s60 offen offset:2048 sc1
    v_mfma_f32_16x16x32_bf16 v[12:15], v[180:183], v[244:247], v[12:15]
    ds_read_b128 v[160:163], v3 offset:45056
    v_mfma_f32_16x16x32_bf16 v[16:19], v[184:187], v[244:247], v[16:19]
    ds_read_b128 v[164:167], v3 offset:46080
    v_mfma_f32_16x16x32_bf16 v[20:23], v[188:191], v[244:247], v[20:23]
    ds_read_b128 v[168:171], v3 offset:47104
    v_mfma_f32_16x16x32_bf16 v[24:27], v[192:195], v[244:247], v[24:27]
    ds_read_b128 v[172:175], v3 offset:48128
    s_waitcnt vmcnt(6) lgkmcnt(5)
    v_mfma_f32_16x16x32_bf16 v[8:11], v[196:199], v[216:219], v[8:11]
    ds_read_b128 v[176:179], v3 offset:49152
    buffer_load_dwordx4 v[244:247], v2, s[4:7], s60 offen offset:3072 sc1
    v_mfma_f32_16x16x32_bf16 v[12:15], v[200:203], v[216:219], v[12:15]
    ds_read_b128 v[180:183], v3 offset:50176
    v_mfma_f32_16x16x32_bf16 v[16:19], v[204:207], v[216:219], v[16:19]
    ds_read_b128 v[184:187], v3 offset:51200
    v_mfma_f32_16x16x32_bf16 v[20:23], v[208:211], v[216:219], v[20:23]
    ds_read_b128 v[188:191], v3 offset:52224
    v_mfma_f32_16x16x32_bf16 v[24:27], v[212:215], v[216:219], v[24:27]
    ds_read_b128 v[192:195], v3 offset:53248
    s_waitcnt vmcnt(6) lgkmcnt(5)
    v_mfma_f32_16x16x32_bf16 v[8:11], v[156:159], v[220:223], v[8:11]
    ds_read_b128 v[196:199], v3 offset:54272
    s_add_u32 s60, s60, 4096
    buffer_load_dwordx4 v[216:219], v2, s[4:7], s60 offen offset:0 sc1
    v_mfma_f32_16x16x32_bf16 v[12:15], v[160:163], v[220:223], v[12:15]
    ds_read_b128 v[200:203], v3 offset:55296
    v_mfma_f32_16x16x32_bf16 v[16:19], v[164:167], v[220:223], v[16:19]
    ds_read_b128 v[204:207], v3 offset:56320
    v_mfma_f32_16x16x32_bf16 v[20:23], v[168:171], v[220:223], v[20:23]
    ds_read_b128 v[208:211], v3 offset:57344
    v_mfma_f32_16x16x32_bf16 v[24:27], v[172:175], v[220:223], v[24:27]
    ds_read_b128 v[212:215], v3 offset:58368
    s_waitcnt vmcnt(6) lgkmcnt(5)
    v_mfma_f32_16x16x32_bf16 v[8:11], v[176:179], v[224:227], v[8:11]
    ds_read_b128 v[156:159], v3 offset:59392
    buffer_load_dwordx4 v[220:223], v2, s[4:7], s60 offen offset:1024 sc1
    v_mfma_f32_16x16x32_bf16 v[12:15], v[180:183], v[224:227], v[12:15]
    ds_read_b128 v[160:163], v3 offset:60416
    v_mfma_f32_16x16x32_bf16 v[16:19], v[184:187], v[224:227], v[16:19]
    ds_read_b128 v[164:167], v3 offset:61440
    v_mfma_f32_16x16x32_bf16 v[20:23], v[188:191], v[224:227], v[20:23]
    ds_read_b128 v[168:171], v3 offset:62464
    v_mfma_f32_16x16x32_bf16 v[24:27], v[192:195], v[224:227], v[24:27]
    ds_read_b128 v[172:175], v3 offset:63488
    s_waitcnt vmcnt(6) lgkmcnt(5)
    v_mfma_f32_16x16x32_bf16 v[8:11], v[196:199], v[228:231], v[8:11]
    ds_read_b128 v[176:179], v3 offset:64512
    buffer_load_dwordx4 v[224:227], v2, s[4:7], s60 offen offset:2048 sc1
    v_mfma_f32_16x16x32_bf16 v[12:15], v[200:203], v[228:231], v[12:15]
    ds_read_b128 v[180:183], v4 offset:0
    v_mfma_f32_16x16x32_bf16 v[16:19], v[204:207], v[228:231], v[16:19]
    ds_read_b128 v[184:187], v4 offset:1024
    v_mfma_f32_16x16x32_bf16 v[20:23], v[208:211], v[228:231], v[20:23]
    ds_read_b128 v[188:191], v4 offset:2048
    v_mfma_f32_16x16x32_bf16 v[24:27], v[212:215], v[228:231], v[24:27]
    ds_read_b128 v[192:195], v4 offset:3072
    s_waitcnt vmcnt(6) lgkmcnt(5)
    v_mfma_f32_16x16x32_bf16 v[8:11], v[156:159], v[232:235], v[8:11]
    ds_read_b128 v[196:199], v4 offset:4096
    buffer_load_dwordx4 v[228:231], v2, s[4:7], s60 offen offset:3072 sc1
    v_mfma_f32_16x16x32_bf16 v[12:15], v[160:163], v[232:235], v[12:15]
    ds_read_b128 v[200:203], v4 offset:5120
    v_mfma_f32_16x16x32_bf16 v[16:19], v[164:167], v[232:235], v[16:19]
    ds_read_b128 v[204:207], v4 offset:6144
    v_mfma_f32_16x16x32_bf16 v[20:23], v[168:171], v[232:235], v[20:23]
    ds_read_b128 v[208:211], v4 offset:7168
    v_mfma_f32_16x16x32_bf16 v[24:27], v[172:175], v[232:235], v[24:27]
    ds_read_b128 v[212:215], v4 offset:8192
    s_waitcnt vmcnt(6) lgkmcnt(5)
    v_mfma_f32_16x16x32_bf16 v[8:11], v[176:179], v[236:239], v[8:11]
    ds_read_b128 v[156:159], v4 offset:9216
    v_mfma_f32_16x16x32_bf16 v[12:15], v[180:183], v[236:239], v[12:15]
    ds_read_b128 v[160:163], v4 offset:10240
    v_mfma_f32_16x16x32_bf16 v[16:19], v[184:187], v[236:239], v[16:19]
    ds_read_b128 v[164:167], v4 offset:11264
    v_mfma_f32_16x16x32_bf16 v[20:23], v[188:191], v[236:239], v[20:23]
    ds_read_b128 v[168:171], v4 offset:12288
    v_mfma_f32_16x16x32_bf16 v[24:27], v[192:195], v[236:239], v[24:27]
    ds_read_b128 v[172:175], v4 offset:13312
    s_waitcnt vmcnt(5) lgkmcnt(5)
    v_mfma_f32_16x16x32_bf16 v[8:11], v[196:199], v[240:243], v[8:11]
    ds_read_b128 v[176:179], v4 offset:14336
    v_mfma_f32_16x16x32_bf16 v[12:15], v[200:203], v[240:243], v[12:15]
    ds_read_b128 v[180:183], v4 offset:15360
    v_mfma_f32_16x16x32_bf16 v[16:19], v[204:207], v[240:243], v[16:19]
    ds_read_b128 v[184:187], v4 offset:16384
    v_mfma_f32_16x16x32_bf16 v[20:23], v[208:211], v[240:243], v[20:23]
    ds_read_b128 v[188:191], v4 offset:17408
    v_mfma_f32_16x16x32_bf16 v[24:27], v[212:215], v[240:243], v[24:27]
    ds_read_b128 v[192:195], v4 offset:18432
    s_waitcnt vmcnt(4) lgkmcnt(5)
    v_mfma_f32_16x16x32_bf16 v[8:11], v[156:159], v[244:247], v[8:11]
    ds_read_b128 v[196:199], v4 offset:19456
    v_mfma_f32_16x16x32_bf16 v[12:15], v[160:163], v[244:247], v[12:15]
    ds_read_b128 v[200:203], v4 offset:20480
    v_mfma_f32_16x16x32_bf16 v[16:19], v[164:167], v[244:247], v[16:19]
    ds_read_b128 v[204:207], v4 offset:21504
    v_mfma_f32_16x16x32_bf16 v[20:23], v[168:171], v[244:247], v[20:23]
    ds_read_b128 v[208:211], v4 offset:22528
    v_mfma_f32_16x16x32_bf16 v[24:27], v[172:175], v[244:247], v[24:27]
    ds_read_b128 v[212:215], v4 offset:23552
    s_waitcnt vmcnt(3) lgkmcnt(5)
    v_mfma_f32_16x16x32_bf16 v[8:11], v[176:179], v[216:219], v[8:11]
    ds_read_b128 v[156:159], v4 offset:24576
    v_mfma_f32_16x16x32_bf16 v[12:15], v[180:183], v[216:219], v[12:15]
    ds_read_b128 v[160:163], v4 offset:25600
    v_mfma_f32_16x16x32_bf16 v[16:19], v[184:187], v[216:219], v[16:19]
    ds_read_b128 v[164:167], v4 offset:26624
    v_mfma_f32_16x16x32_bf16 v[20:23], v[188:191], v[216:219], v[20:23]
    ds_read_b128 v[168:171], v4 offset:27648
    v_mfma_f32_16x16x32_bf16 v[24:27], v[192:195], v[216:219], v[24:27]
    ds_read_b128 v[172:175], v4 offset:28672
    s_waitcnt vmcnt(2) lgkmcnt(5)
    v_mfma_f32_16x16x32_bf16 v[8:11], v[196:199], v[220:223], v[8:11]
    ds_read_b128 v[176:179], v4 offset:29696
    v_mfma_f32_16x16x32_bf16 v[12:15], v[200:203], v[220:223], v[12:15]
    ds_read_b128 v[180:183], v2 offset:0
    v_mfma_f32_16x16x32_bf16 v[16:19], v[204:207], v[220:223], v[16:19]
    ds_read_b128 v[184:187], v2 offset:1024
    v_mfma_f32_16x16x32_bf16 v[20:23], v[208:211], v[220:223], v[20:23]
    ds_read_b128 v[188:191], v2 offset:2048
    v_mfma_f32_16x16x32_bf16 v[24:27], v[212:215], v[220:223], v[24:27]
    ds_read_b128 v[192:195], v2 offset:3072
    s_waitcnt vmcnt(1) lgkmcnt(5)
    v_mfma_f32_16x16x32_bf16 v[8:11], v[156:159], v[224:227], v[8:11]
    v_mfma_f32_16x16x32_bf16 v[12:15], v[160:163], v[224:227], v[12:15]
    v_mfma_f32_16x16x32_bf16 v[16:19], v[164:167], v[224:227], v[16:19]
    v_mfma_f32_16x16x32_bf16 v[20:23], v[168:171], v[224:227], v[20:23]
    v_mfma_f32_16x16x32_bf16 v[24:27], v[172:175], v[224:227], v[24:27]
    s_waitcnt vmcnt(0) lgkmcnt(0)
    v_mfma_f32_16x16x32_bf16 v[8:11], v[176:179], v[228:231], v[8:11]
    v_mfma_f32_16x16x32_bf16 v[12:15], v[180:183], v[228:231], v[12:15]
    v_mfma_f32_16x16x32_bf16 v[16:19], v[184:187], v[228:231], v[16:19]
    v_mfma_f32_16x16x32_bf16 v[20:23], v[188:191], v[228:231], v[20:23]
    v_mfma_f32_16x16x32_bf16 v[24:27], v[192:195], v[228:231], v[24:27]
    s_add_u32 s45, s97, 1
    s_add_u32 s97, s97, 2
    s_nop 1
    v_cvt_pk_bf16_f32 v136, v8, v9
    v_cvt_pk_bf16_f32 v137, v10, v11
    v_cvt_pk_bf16_f32 v138, v12, v13
    v_cvt_pk_bf16_f32 v139, v14, v15
    buffer_store_dwordx4 v[136:139], v43, s[4:7], 0 offen
    v_cvt_pk_bf16_f32 v140, v16, v17
    v_cvt_pk_bf16_f32 v141, v18, v19
    v_cvt_pk_bf16_f32 v142, v20, v21
    v_cvt_pk_bf16_f32 v143, v22, v23
    buffer_store_dwordx4 v[140:143], v43, s[4:7], 0 offen offset:2048
    v_cvt_pk_bf16_f32 v144, v24, v25
    v_cvt_pk_bf16_f32 v145, v26, v27
    buffer_store_dwordx2 v[144:145], v44, s[4:7], 0 offen
    v_pk_add_f32 v[148:149], v[8:9], v[10:11]
    v_pk_mul_f32 v[150:151], v[8:9], v[8:9]
    v_pk_fma_f32 v[150:151], v[10:11], v[10:11], v[150:151]
    v_pk_add_f32 v[148:149], v[148:149], v[12:13]
    v_pk_fma_f32 v[150:151], v[12:13], v[12:13], v[150:151]
    v_pk_add_f32 v[148:149], v[148:149], v[14:15]
    v_pk_fma_f32 v[150:151], v[14:15], v[14:15], v[150:151]
    v_pk_add_f32 v[148:149], v[148:149], v[16:17]
    v_pk_fma_f32 v[150:151], v[16:17], v[16:17], v[150:151]
    v_pk_add_f32 v[148:149], v[148:149], v[18:19]
    v_pk_fma_f32 v[150:151], v[18:19], v[18:19], v[150:151]
    v_pk_add_f32 v[148:149], v[148:149], v[20:21]
    v_pk_fma_f32 v[150:151], v[20:21], v[20:21], v[150:151]
    v_pk_add_f32 v[148:149], v[148:149], v[22:23]
    v_pk_fma_f32 v[150:151], v[22:23], v[22:23], v[150:151]
    v_pk_add_f32 v[148:149], v[148:149], v[24:25]
    v_pk_fma_f32 v[150:151], v[24:25], v[24:25], v[150:151]
    v_pk_add_f32 v[148:149], v[148:149], v[26:27]
    v_pk_fma_f32 v[150:151], v[26:27], v[26:27], v[150:151]
    v_add_f32 v148, v148, v149
    v_add_f32 v150, v150, v151
    v_mov_b32 v152, 0
    v_mov_b32 v153, s45
    v_permlane32_swap_b32 v148, v150
    v_add_f32 v148, v148, v150
    v_mov_b32 v150, v148
    v_mov_b32 v154, s97
    s_nop 0
    v_permlane16_swap_b32 v148, v150
    v_add_f32 v148, v148, v150
    buffer_store_dword v148, v45, s[4:7], 0 offen
    s_barrier
    s_mov_b64 exec, 1
    s_waitcnt vmcnt(1)
    buffer_store_dword v153, v152, s[4:7], s96 offen
    s_mov_b64 exec, -1
    s_lshl_b32 s44, s32, 7
    s_lshl_b32 s45, s34, 2
    s_add_u32 s61, s44, s45
    s_add_u32 s61, s61, 16384
    s_add_u32 s98, s44, 8192
    s_sub_u32 s46, s97, 1
    s_mul_i32 s60, s32, 40960
    s_add_u32 s60, s60, 458752
    s_mul_i32 s59, s32, 98304
    s_lshl_b32 s45, s34, 10
    s_add_u32 s59, s59, s45
    s_add_u32 s59, s59, 3080192
    s_lshr_b32 s62, s31, 1
    s_lshl_b32 s62, s62, 7
    s_add_u32 s62, s62, 16384
    s_mul_i32 s58, s27, 3
    v_mov_b32 v206, s54
    v_mov_b32 v207, s54
    v_add_u32 v204, 49152, v2
    v_lshrrev_b32 v7, 4, v1
    v_lshlrev_b32 v205, 5, v7
    v_add_u32 v205, 162048, v205
    v_lshlrev_b32 v129, 9, v7
    v_lshl_add_u32 v129, v47, 2, v129
    v_mul_u32_u24 v7, 80, v7
    v_add_u32 v7, 162816, v7
    s_mov_b64 exec, 1
    s_waitcnt vmcnt(1)
    buffer_store_dword v154, v152, s[4:7], s96 offen
    s_mov_b64 exec, -1
    ds_read_b128 v[136:139], v2 offset:4096
    ds_read_b128 v[140:143], v2 offset:5120
    ds_read_b128 v[144:147], v2 offset:6144
    ds_read_b128 v[148:151], v2 offset:7168
    ds_read_b128 v[152:155], v2 offset:8192
    ds_read_b128 v[156:159], v2 offset:9216
Lpoll_21:
    buffer_load_dword v172, v47, s[4:7], s98 offen sc1
    s_waitcnt vmcnt(0)
    v_cmp_gt_u32 vcc, s46, v172
    s_cbranch_vccz Lpolld_22
    s_sub_u32 s29, s29, 1
    s_cbranch_scc0 Lpoll_21
    s_mov_b32 s29, 0
Lpolld_22:
    buffer_load_dwordx4 v[172:175], v129, s[4:7], s60 offen offset:0 sc1
    buffer_load_dwordx4 v[176:179], v129, s[4:7], s60 offen offset:256 sc1
    buffer_load_dwordx4 v[180:183], v129, s[4:7], s60 offen offset:2048 sc1
    buffer_load_dwordx4 v[184:187], v129, s[4:7], s60 offen offset:2304 sc1
    s_add_u32 s60, s60, 4096
    buffer_load_dwordx4 v[188:191], v129, s[4:7], s60 offen offset:0 sc1
    buffer_load_dwordx4 v[192:195], v129, s[4:7], s60 offen offset:256 sc1
    s_waitcnt vmcnt(4) lgkmcnt(3)
    v_mfma_f32_16x16x32_bf16 v[208:211], v[136:139], v[172:175], 0
    buffer_load_dwordx4 v[196:199], v129, s[4:7], s60 offen offset:2048 sc1
    v_mfma_f32_16x16x32_bf16 v[216:219], v[136:139], v[176:179], 0
    ds_read_b128 v[160:163], v2 offset:10240
    v_mfma_f32_16x16x32_bf16 v[212:215], v[140:143], v[172:175], 0
    v_mfma_f32_16x16x32_bf16 v[220:223], v[140:143], v[176:179], 0
    ds_read_b128 v[164:167], v2 offset:11264
    v_mfma_f32_16x16x32_bf16 v[224:227], v[144:147], v[172:175], 0
    v_mfma_f32_16x16x32_bf16 v[232:235], v[144:147], v[176:179], 0
    ds_read_b128 v[168:171], v2 offset:12288
    s_waitcnt lgkmcnt(3)
    v_mfma_f32_16x16x32_bf16 v[228:231], v[148:151], v[172:175], 0
    buffer_load_dwordx4 v[200:203], v129, s[4:7], s60 offen offset:2304 sc1
    v_mfma_f32_16x16x32_bf16 v[236:239], v[148:151], v[176:179], 0
    ds_read_b128 v[136:139], v2 offset:13312
    ds_read_b128 v[88:91], v7 offset:0
    v_mfma_f32_16x16x32_bf16 v[240:243], v[152:155], v[172:175], 0
    ds_read_b128 v[92:95], v7 offset:16
    v_mfma_f32_16x16x32_bf16 v[248:251], v[152:155], v[176:179], 0
    ds_read_b128 v[140:143], v2 offset:14336
    ds_read_b128 v[96:99], v7 offset:32
    v_mfma_f32_16x16x32_bf16 v[244:247], v[156:159], v[172:175], 0
    ds_read_b128 v[100:103], v7 offset:48
    v_mfma_f32_16x16x32_bf16 v[252:255], v[156:159], v[176:179], 0
    ds_read_b128 v[144:147], v2 offset:15360
    ds_read_b128 v[104:107], v7 offset:64
    buffer_load_dword v128, v47, s[4:7], s98 offen sc1
    s_waitcnt vmcnt(5) lgkmcnt(8)
    v_mfma_f32_16x16x32_bf16 v[208:211], v[160:163], v[180:183], v[208:211]
    s_add_u32 s60, s60, 4096
    buffer_load_dwordx4 v[172:175], v129, s[4:7], s60 offen offset:0 sc1
    v_mfma_f32_16x16x32_bf16 v[216:219], v[160:163], v[184:187], v[216:219]
    ds_read_b128 v[148:151], v2 offset:16384
    v_mfma_f32_16x16x32_bf16 v[212:215], v[164:167], v[180:183], v[212:215]
    v_mfma_f32_16x16x32_bf16 v[220:223], v[164:167], v[184:187], v[220:223]
    ds_read_b128 v[152:155], v2 offset:17408
    v_mfma_f32_16x16x32_bf16 v[224:227], v[168:171], v[180:183], v[224:227]
    v_mfma_f32_16x16x32_bf16 v[232:235], v[168:171], v[184:187], v[232:235]
    ds_read_b128 v[156:159], v2 offset:18432
    s_waitcnt lgkmcnt(4)
    v_mfma_f32_16x16x32_bf16 v[228:231], v[136:139], v[180:183], v[228:231]
    buffer_load_dwordx4 v[176:179], v129, s[4:7], s60 offen offset:256 sc1
    v_mfma_f32_16x16x32_bf16 v[236:239], v[136:139], v[184:187], v[236:239]
    ds_read_b128 v[160:163], v2 offset:19456
    v_mfma_f32_16x16x32_bf16 v[240:243], v[140:143], v[180:183], v[240:243]
    v_mfma_f32_16x16x32_bf16 v[248:251], v[140:143], v[184:187], v[248:251]
    ds_read_b128 v[164:167], v2 offset:20480
    v_mfma_f32_16x16x32_bf16 v[244:247], v[144:147], v[180:183], v[244:247]
    v_mfma_f32_16x16x32_bf16 v[252:255], v[144:147], v[184:187], v[252:255]
    ds_read_b128 v[168:171], v2 offset:21504
    s_waitcnt vmcnt(5) lgkmcnt(3)
    v_mfma_f32_16x16x32_bf16 v[208:211], v[148:151], v[188:191], v[208:211]
    buffer_load_dwordx4 v[180:183], v129, s[4:7], s60 offen offset:2048 sc1
    v_mfma_f32_16x16x32_bf16 v[216:219], v[148:151], v[192:195], v[216:219]
    ds_read_b128 v[136:139], v2 offset:22528
    v_mfma_f32_16x16x32_bf16 v[212:215], v[152:155], v[188:191], v[212:215]
    v_add_f32 v8, v8, v88
    v_mfma_f32_16x16x32_bf16 v[220:223], v[152:155], v[192:195], v[220:223]
    ds_read_b128 v[140:143], v2 offset:23552
    v_add_f32 v9, v9, v89
    v_mfma_f32_16x16x32_bf16 v[224:227], v[156:159], v[188:191], v[224:227]
    v_add_f32 v10, v10, v90
    v_mfma_f32_16x16x32_bf16 v[232:235], v[156:159], v[192:195], v[232:235]
    ds_read_b128 v[144:147], v2 offset:24576
    s_waitcnt lgkmcnt(3)
    v_mfma_f32_16x16x32_bf16 v[228:231], v[160:163], v[188:191], v[228:231]
    buffer_load_dwordx4 v[184:187], v129, s[4:7], s60 offen offset:2304 sc1
    v_mfma_f32_16x16x32_bf16 v[236:239], v[160:163], v[192:195], v[236:239]
    ds_read_b128 v[148:151], v2 offset:25600
    v_add_f32 v11, v11, v91
    v_mfma_f32_16x16x32_bf16 v[240:243], v[164:167], v[188:191], v[240:243]
    v_add_f32 v12, v12, v92
    v_mfma_f32_16x16x32_bf16 v[248:251], v[164:167], v[192:195], v[248:251]
    ds_read_b128 v[152:155], v2 offset:26624
    v_add_f32 v13, v13, v93
    v_mfma_f32_16x16x32_bf16 v[244:247], v[168:171], v[188:191], v[244:247]
    v_add_f32 v14, v14, v94
    v_mfma_f32_16x16x32_bf16 v[252:255], v[168:171], v[192:195], v[252:255]
    ds_read_b128 v[156:159], v2 offset:27648
    s_waitcnt vmcnt(5) lgkmcnt(3)
    s_waitcnt vmcnt(4)
    v_cmp_gt_u32 vcc, s97, v128
    s_cbranch_vccnz Lpc_23
Lpcd_24:
    v_mfma_f32_16x16x32_bf16 v[208:211], v[136:139], v[196:199], v[208:211]
    s_add_u32 s60, s60, 4096
    buffer_load_dwordx4 v[188:191], v129, s[4:7], s60 offen offset:0 sc1
    v_mfma_f32_16x16x32_bf16 v[216:219], v[136:139], v[200:203], v[216:219]
    ds_read_b128 v[160:163], v2 offset:28672
    v_add_f32 v15, v15, v95
    v_mfma_f32_16x16x32_bf16 v[212:215], v[140:143], v[196:199], v[212:215]
    v_add_f32 v16, v16, v96
    v_mfma_f32_16x16x32_bf16 v[220:223], v[140:143], v[200:203], v[220:223]
    ds_read_b128 v[164:167], v2 offset:29696
    v_add_f32 v17, v17, v97
    v_mfma_f32_16x16x32_bf16 v[224:227], v[144:147], v[196:199], v[224:227]
    v_add_f32 v18, v18, v98
    v_mfma_f32_16x16x32_bf16 v[232:235], v[144:147], v[200:203], v[232:235]
    ds_read_b128 v[168:171], v2 offset:30720
    s_lshl_b32 s49, s32, 11
    s_add_u32 s49, s49, 196608
    buffer_load_dwordx4 v[120:123], v2, s[4:7], s49 offen sc1
    buffer_load_dwordx4 v[124:127], v2, s[4:7], s49 offen offset:1024 sc1
    s_waitcnt lgkmcnt(3)
    v_mfma_f32_16x16x32_bf16 v[228:231], v[148:151], v[196:199], v[228:231]
    buffer_load_dwordx4 v[192:195], v129, s[4:7], s60 offen offset:256 sc1
    v_mfma_f32_16x16x32_bf16 v[236:239], v[148:151], v[200:203], v[236:239]
    ds_read_b128 v[136:139], v2 offset:31744
    v_add_f32 v19, v19, v99
    v_mfma_f32_16x16x32_bf16 v[240:243], v[152:155], v[196:199], v[240:243]
    v_add_f32 v20, v20, v100
    v_mfma_f32_16x16x32_bf16 v[248:251], v[152:155], v[200:203], v[248:251]
    ds_read_b128 v[140:143], v2 offset:32768
    v_add_f32 v21, v21, v101
    v_mfma_f32_16x16x32_bf16 v[244:247], v[156:159], v[196:199], v[244:247]
    v_add_f32 v22, v22, v102
    v_mfma_f32_16x16x32_bf16 v[252:255], v[156:159], v[200:203], v[252:255]
    ds_read_b128 v[144:147], v2 offset:33792
    s_waitcnt vmcnt(6) lgkmcnt(3)
    v_mfma_f32_16x16x32_bf16 v[208:211], v[160:163], v[172:175], v[208:211]
    buffer_load_dwordx4 v[196:199], v129, s[4:7], s60 offen offset:2048 sc1
    v_mfma_f32_16x16x32_bf16 v[216:219], v[160:163], v[176:179], v[216:219]
    ds_read_b128 v[148:151], v2 offset:34816
    v_add_f32 v23, v23, v103
    v_mfma_f32_16x16x32_bf16 v[212:215], v[164:167], v[172:175], v[212:215]
    v_add_f32 v24, v24, v104
    v_mfma_f32_16x16x32_bf16 v[220:223], v[164:167], v[176:179], v[220:223]
    ds_read_b128 v[152:155], v2 offset:35840
    v_add_f32 v25, v25, v105
    v_mfma_f32_16x16x32_bf16 v[224:227], v[168:171], v[172:175], v[224:227]
    v_add_f32 v26, v26, v106
    v_mfma_f32_16x16x32_bf16 v[232:235], v[168:171], v[176:179], v[232:235]
    ds_read_b128 v[156:159], v2 offset:36864
    s_waitcnt lgkmcnt(3)
    v_mfma_f32_16x16x32_bf16 v[228:231], v[136:139], v[172:175], v[228:231]
    buffer_load_dwordx4 v[200:203], v129, s[4:7], s60 offen offset:2304 sc1
    v_mfma_f32_16x16x32_bf16 v[236:239], v[136:139], v[176:179], v[236:239]
    ds_read_b128 v[160:163], v2 offset:37888
    v_add_f32 v27, v27, v107
    v_mfma_f32_16x16x32_bf16 v[240:243], v[140:143], v[172:175], v[240:243]
    v_mfma_f32_16x16x32_bf16 v[248:251], v[140:143], v[176:179], v[248:251]
    ds_read_b128 v[164:167], v2 offset:38912
    v_mfma_f32_16x16x32_bf16 v[244:247], v[144:147], v[172:175], v[244:247]
    v_mfma_f32_16x16x32_bf16 v[252:255], v[144:147], v[176:179], v[252:255]
    ds_read_b128 v[168:171], v2 offset:39936
    s_waitcnt vmcnt(6) lgkmcnt(3)
    v_mfma_f32_16x16x32_bf16 v[208:211], v[148:151], v[180:183], v[208:211]
    s_add_u32 s60, s60, 4096
    buffer_load_dwordx4 v[172:175], v129, s[4:7], s60 offen offset:0 sc1
    v_mfma_f32_16x16x32_bf16 v[216:219], v[148:151], v[184:187], v[216:219]
    ds_read_b128 v[136:139], v2 offset:40960
    v_mfma_f32_16x16x32_bf16 v[212:215], v[152:155], v[180:183], v[212:215]
    v_mfma_f32_16x16x32_bf16 v[220:223], v[152:155], v[184:187], v[220:223]
    ds_read_b128 v[140:143], v2 offset:41984
    v_mfma_f32_16x16x32_bf16 v[224:227], v[156:159], v[180:183], v[224:227]
    v_mfma_f32_16x16x32_bf16 v[232:235], v[156:159], v[184:187], v[232:235]
    ds_read_b128 v[144:147], v2 offset:43008
    s_waitcnt lgkmcnt(3)
    v_mfma_f32_16x16x32_bf16 v[228:231], v[160:163], v[180:183], v[228:231]
    buffer_load_dwordx4 v[176:179], v129, s[4:7], s60 offen offset:256 sc1
    v_mfma_f32_16x16x32_bf16 v[236:239], v[160:163], v[184:187], v[236:239]
    ds_read_b128 v[148:151], v2 offset:44032
    v_mfma_f32_16x16x32_bf16 v[240:243], v[164:167], v[180:183], v[240:243]
    v_mfma_f32_16x16x32_bf16 v[248:251], v[164:167], v[184:187], v[248:251]
    ds_read_b128 v[152:155], v2 offset:45056
    v_mfma_f32_16x16x32_bf16 v[244:247], v[168:171], v[180:183], v[244:247]
    v_mfma_f32_16x16x32_bf16 v[252:255], v[168:171], v[184:187], v[252:255]
    ds_read_b128 v[156:159], v2 offset:46080
    s_waitcnt vmcnt(4) lgkmcnt(3)
    v_mfma_f32_16x16x32_bf16 v[208:211], v[136:139], v[188:191], v[208:211]
    buffer_load_dwordx4 v[180:183], v129, s[4:7], s60 offen offset:2048 sc1
    v_mfma_f32_16x16x32_bf16 v[216:219], v[136:139], v[192:195], v[216:219]
    ds_read_b128 v[160:163], v2 offset:47104
    v_mfma_f32_16x16x32_bf16 v[212:215], v[140:143], v[188:191], v[212:215]
    v_add_f32 v134, v120, v122
    v_mfma_f32_16x16x32_bf16 v[220:223], v[140:143], v[192:195], v[220:223]
    ds_read_b128 v[164:167], v2 offset:48128
    v_add_f32 v135, v121, v123
    v_mfma_f32_16x16x32_bf16 v[224:227], v[144:147], v[188:191], v[224:227]
    v_add_f32 v124, v124, v126
    v_mfma_f32_16x16x32_bf16 v[232:235], v[144:147], v[192:195], v[232:235]
    ds_read_b128 v[168:171], v2 offset:49152
    s_waitcnt lgkmcnt(3)
    v_mfma_f32_16x16x32_bf16 v[228:231], v[148:151], v[188:191], v[228:231]
    buffer_load_dwordx4 v[184:187], v129, s[4:7], s60 offen offset:2304 sc1
    v_mfma_f32_16x16x32_bf16 v[236:239], v[148:151], v[192:195], v[236:239]
    ds_read_b128 v[136:139], v2 offset:50176
    v_add_f32 v125, v125, v127
    v_mfma_f32_16x16x32_bf16 v[240:243], v[152:155], v[188:191], v[240:243]
    v_add_f32 v134, v134, v124
    v_mfma_f32_16x16x32_bf16 v[248:251], v[152:155], v[192:195], v[248:251]
    ds_read_b128 v[140:143], v2 offset:51200
    v_add_f32 v135, v135, v125
    v_mfma_f32_16x16x32_bf16 v[244:247], v[156:159], v[188:191], v[244:247]
    v_mov_b32 v120, v134
    v_mfma_f32_16x16x32_bf16 v[252:255], v[156:159], v[192:195], v[252:255]
    ds_read_b128 v[144:147], v2 offset:52224
    s_waitcnt vmcnt(4) lgkmcnt(3)
    v_mfma_f32_16x16x32_bf16 v[208:211], v[160:163], v[196:199], v[208:211]
    s_add_u32 s60, s60, 4096
    buffer_load_dwordx4 v[188:191], v129, s[4:7], s60 offen offset:0 sc1
    v_mfma_f32_16x16x32_bf16 v[216:219], v[160:163], v[200:203], v[216:219]
    ds_read_b128 v[148:151], v2 offset:53248
    v_mov_b32 v121, v135
    v_mfma_f32_16x16x32_bf16 v[212:215], v[164:167], v[196:199], v[212:215]
    s_nop 1
    v_mfma_f32_16x16x32_bf16 v[220:223], v[164:167], v[200:203], v[220:223]
    ds_read_b128 v[152:155], v2 offset:54272
    v_permlane32_swap_b32 v134, v120
    v_mfma_f32_16x16x32_bf16 v[224:227], v[168:171], v[196:199], v[224:227]
    v_permlane32_swap_b32 v135, v121
    v_mfma_f32_16x16x32_bf16 v[232:235], v[168:171], v[200:203], v[232:235]
    ds_read_b128 v[156:159], v2 offset:55296
    s_waitcnt lgkmcnt(3)
    v_mfma_f32_16x16x32_bf16 v[228:231], v[136:139], v[196:199], v[228:231]
    buffer_load_dwordx4 v[192:195], v129, s[4:7], s60 offen offset:256 sc1
    v_mfma_f32_16x16x32_bf16 v[236:239], v[136:139], v[200:203], v[236:239]
    ds_read_b128 v[160:163], v2 offset:56320
    v_add_f32 v134, v134, v120
    v_mfma_f32_16x16x32_bf16 v[240:243], v[140:143], v[196:199], v[240:243]
    v_add_f32 v135, v135, v121
    v_mfma_f32_16x16x32_bf16 v[248:251], v[140:143], v[200:203], v[248:251]
    ds_read_b128 v[164:167], v2 offset:57344
    v_mul_f32 v134, 0x3acccccd, v134
    v_mfma_f32_16x16x32_bf16 v[244:247], v[144:147], v[196:199], v[244:247]
    v_mul_f32 v135, 0x3acccccd, v135
    v_mfma_f32_16x16x32_bf16 v[252:255], v[144:147], v[200:203], v[252:255]
    ds_read_b128 v[168:171], v2 offset:58368
    s_waitcnt vmcnt(4) lgkmcnt(3)
    s_barrier
    v_mfma_f32_16x16x32_bf16 v[208:211], v[148:151], v[172:175], v[208:211]
    buffer_load_dwordx4 v[196:199], v129, s[4:7], s60 offen offset:2048 sc1
    v_mfma_f32_16x16x32_bf16 v[216:219], v[148:151], v[176:179], v[216:219]
    ds_read_b128 v[136:139], v2 offset:59392
    v_fma_f32 v135, -v134, v134, v135
    v_mfma_f32_16x16x32_bf16 v[212:215], v[152:155], v[172:175], v[212:215]
    v_max_f32 v135, 0, v135
    v_mfma_f32_16x16x32_bf16 v[220:223], v[152:155], v[176:179], v[220:223]
    ds_read_b128 v[140:143], v2 offset:60416
    v_add_f32 v135, 0x3727c5ac, v135
    v_mfma_f32_16x16x32_bf16 v[224:227], v[156:159], v[172:175], v[224:227]
    v_rsq_f32 v132, v135
    v_mfma_f32_16x16x32_bf16 v[232:235], v[156:159], v[176:179], v[232:235]
    ds_read_b128 v[144:147], v2 offset:61440
    s_waitcnt lgkmcnt(3)
    v_mfma_f32_16x16x32_bf16 v[228:231], v[160:163], v[172:175], v[228:231]
    buffer_load_dwordx4 v[200:203], v129, s[4:7], s60 offen offset:2304 sc1
    v_mfma_f32_16x16x32_bf16 v[236:239], v[160:163], v[176:179], v[236:239]
    ds_read_b128 v[148:151], v2 offset:62464
    s_nop 0
    v_mfma_f32_16x16x32_bf16 v[240:243], v[164:167], v[172:175], v[240:243]
    v_mul_f32 v133, -1.0, v132
    v_mfma_f32_16x16x32_bf16 v[248:251], v[164:167], v[176:179], v[248:251]
    ds_read_b128 v[152:155], v2 offset:63488
    v_mul_f32 v133, v134, v133
    v_mfma_f32_16x16x32_bf16 v[244:247], v[168:171], v[172:175], v[244:247]
    v_mov_b32 v130, v132
    v_mfma_f32_16x16x32_bf16 v[252:255], v[168:171], v[176:179], v[252:255]
    ds_read_b128 v[156:159], v2 offset:64512
    s_waitcnt vmcnt(4) lgkmcnt(3)
    v_mfma_f32_16x16x32_bf16 v[208:211], v[136:139], v[180:183], v[208:211]
    s_add_u32 s60, s60, 4096
    buffer_load_dwordx4 v[172:175], v129, s[4:7], s60 offen offset:0 sc1
    v_mfma_f32_16x16x32_bf16 v[216:219], v[136:139], v[184:187], v[216:219]
    ds_read_b128 v[160:163], v3 offset:0
    v_mov_b32 v131, v133
    v_mfma_f32_16x16x32_bf16 v[212:215], v[140:143], v[180:183], v[212:215]
    s_nop 1
    v_mfma_f32_16x16x32_bf16 v[220:223], v[140:143], v[184:187], v[220:223]
    ds_read_b128 v[164:167], v3 offset:1024
    v_permlane16_swap_b32 v132, v130
    v_mfma_f32_16x16x32_bf16 v[224:227], v[144:147], v[180:183], v[224:227]
    v_permlane16_swap_b32 v133, v131
    v_mfma_f32_16x16x32_bf16 v[232:235], v[144:147], v[184:187], v[232:235]
    ds_read_b128 v[168:171], v3 offset:2048
    s_waitcnt lgkmcnt(3)
    v_mfma_f32_16x16x32_bf16 v[228:231], v[148:151], v[180:183], v[228:231]
    buffer_load_dwordx4 v[176:179], v129, s[4:7], s60 offen offset:256 sc1
    v_mfma_f32_16x16x32_bf16 v[236:239], v[148:151], v[184:187], v[236:239]
    ds_read_b128 v[136:139], v3 offset:3072
    ds_read_b128 v[120:123], v205 offset:384
    v_mfma_f32_16x16x32_bf16 v[240:243], v[152:155], v[180:183], v[240:243]
    ds_read_b128 v[124:127], v205 offset:0
    v_mfma_f32_16x16x32_bf16 v[248:251], v[152:155], v[184:187], v[248:251]
    ds_read_b128 v[140:143], v3 offset:4096
    v_mfma_f32_16x16x32_bf16 v[244:247], v[156:159], v[180:183], v[244:247]
    v_mfma_f32_16x16x32_bf16 v[252:255], v[156:159], v[184:187], v[252:255]
    ds_read_b128 v[144:147], v3 offset:5120
    s_waitcnt vmcnt(4) lgkmcnt(5)
    v_mfma_f32_16x16x32_bf16 v[208:211], v[160:163], v[188:191], v[208:211]
    buffer_load_dwordx4 v[180:183], v129, s[4:7], s60 offen offset:2048 sc1
    v_mfma_f32_16x16x32_bf16 v[216:219], v[160:163], v[192:195], v[216:219]
    ds_read_b128 v[148:151], v3 offset:6144
    v_mfma_f32_16x16x32_bf16 v[212:215], v[164:167], v[188:191], v[212:215]
    v_mfma_f32_16x16x32_bf16 v[220:223], v[164:167], v[192:195], v[220:223]
    ds_read_b128 v[152:155], v3 offset:7168
    v_mfma_f32_16x16x32_bf16 v[224:227], v[168:171], v[188:191], v[224:227]
    v_mfma_f32_16x16x32_bf16 v[232:235], v[168:171], v[192:195], v[232:235]
    ds_read_b128 v[156:159], v3 offset:8192
    s_waitcnt lgkmcnt(3)
    v_mfma_f32_16x16x32_bf16 v[228:231], v[136:139], v[188:191], v[228:231]
    buffer_load_dwordx4 v[184:187], v129, s[4:7], s60 offen offset:2304 sc1
    v_mfma_f32_16x16x32_bf16 v[236:239], v[136:139], v[192:195], v[236:239]
    ds_read_b128 v[160:163], v3 offset:9216
    v_mfma_f32_16x16x32_bf16 v[240:243], v[140:143], v[188:191], v[240:243]
    v_mfma_f32_16x16x32_bf16 v[248:251], v[140:143], v[192:195], v[248:251]
    ds_read_b128 v[164:167], v3 offset:10240
    v_mfma_f32_16x16x32_bf16 v[244:247], v[144:147], v[188:191], v[244:247]
    v_mfma_f32_16x16x32_bf16 v[252:255], v[144:147], v[192:195], v[252:255]
    ds_read_b128 v[168:171], v3 offset:11264
    s_waitcnt vmcnt(4) lgkmcnt(3)
    v_mfma_f32_16x16x32_bf16 v[208:211], v[148:151], v[196:199], v[208:211]
    s_add_u32 s60, s60, 4096
    buffer_load_dwordx4 v[188:191], v129, s[4:7], s60 offen offset:0 sc1
    v_mfma_f32_16x16x32_bf16 v[216:219], v[148:151], v[200:203], v[216:219]
    ds_read_b128 v[136:139], v3 offset:12288
    v_mfma_f32_16x16x32_bf16 v[212:215], v[152:155], v[196:199], v[212:215]
    v_fma_f32 v88, v124, v133, v120
    v_mfma_f32_16x16x32_bf16 v[220:223], v[152:155], v[200:203], v[220:223]
    ds_read_b128 v[140:143], v3 offset:13312
    v_fma_f32 v89, v125, v133, v121
    v_mfma_f32_16x16x32_bf16 v[224:227], v[156:159], v[196:199], v[224:227]
    v_fma_f32 v90, v126, v133, v122
    v_mfma_f32_16x16x32_bf16 v[232:235], v[156:159], v[200:203], v[232:235]
    ds_read_b128 v[144:147], v3 offset:14336
    v_fma_f32 v91, v127, v133, v123
    s_waitcnt lgkmcnt(3)
    v_mfma_f32_16x16x32_bf16 v[228:231], v[160:163], v[196:199], v[228:231]
    buffer_load_dwordx4 v[192:195], v129, s[4:7], s60 offen offset:256 sc1
    v_mfma_f32_16x16x32_bf16 v[236:239], v[160:163], v[200:203], v[236:239]
    ds_read_b128 v[148:151], v3 offset:15360
    v_fma_f32 v96, v124, v131, v120
    v_mfma_f32_16x16x32_bf16 v[240:243], v[164:167], v[196:199], v[240:243]
    v_fma_f32 v97, v125, v131, v121
    v_mfma_f32_16x16x32_bf16 v[248:251], v[164:167], v[200:203], v[248:251]
    ds_read_b128 v[152:155], v3 offset:16384
    v_fma_f32 v98, v126, v131, v122
    v_mfma_f32_16x16x32_bf16 v[244:247], v[168:171], v[196:199], v[244:247]
    v_fma_f32 v99, v127, v131, v123
    v_mfma_f32_16x16x32_bf16 v[252:255], v[168:171], v[200:203], v[252:255]
    ds_read_b128 v[156:159], v3 offset:17408
    s_waitcnt vmcnt(4) lgkmcnt(3)
    v_mfma_f32_16x16x32_bf16 v[208:211], v[136:139], v[172:175], v[208:211]
    buffer_load_dwordx4 v[196:199], v129, s[4:7], s60 offen offset:2048 sc1
    v_mfma_f32_16x16x32_bf16 v[216:219], v[136:139], v[176:179], v[216:219]
    ds_read_b128 v[160:163], v3 offset:18432
    ds_read_b128 v[120:123], v205 offset:400
    v_mfma_f32_16x16x32_bf16 v[212:215], v[140:143], v[172:175], v[212:215]
    ds_read_b128 v[124:127], v205 offset:16
    v_mfma_f32_16x16x32_bf16 v[220:223], v[140:143], v[176:179], v[220:223]
    ds_read_b128 v[164:167], v3 offset:19456
    v_mfma_f32_16x16x32_bf16 v[224:227], v[144:147], v[172:175], v[224:227]
    v_mfma_f32_16x16x32_bf16 v[232:235], v[144:147], v[176:179], v[232:235]
    ds_read_b128 v[168:171], v3 offset:20480
    s_waitcnt lgkmcnt(5)
    v_mfma_f32_16x16x32_bf16 v[228:231], v[148:151], v[172:175], v[228:231]
    buffer_load_dwordx4 v[200:203], v129, s[4:7], s60 offen offset:2304 sc1
    v_mfma_f32_16x16x32_bf16 v[236:239], v[148:151], v[176:179], v[236:239]
    ds_read_b128 v[136:139], v3 offset:21504
    v_mfma_f32_16x16x32_bf16 v[240:243], v[152:155], v[172:175], v[240:243]
    v_mfma_f32_16x16x32_bf16 v[248:251], v[152:155], v[176:179], v[248:251]
    ds_read_b128 v[140:143], v3 offset:22528
    v_mfma_f32_16x16x32_bf16 v[244:247], v[156:159], v[172:175], v[244:247]
    v_mfma_f32_16x16x32_bf16 v[252:255], v[156:159], v[176:179], v[252:255]
    ds_read_b128 v[144:147], v3 offset:23552
    s_waitcnt vmcnt(4) lgkmcnt(3)
    v_mfma_f32_16x16x32_bf16 v[208:211], v[160:163], v[180:183], v[208:211]
    s_add_u32 s60, s60, 4096
    buffer_load_dwordx4 v[172:175], v129, s[4:7], s60 offen offset:0 sc1
    v_mfma_f32_16x16x32_bf16 v[216:219], v[160:163], v[184:187], v[216:219]
    ds_read_b128 v[148:151], v3 offset:24576
    v_mfma_f32_16x16x32_bf16 v[212:215], v[164:167], v[180:183], v[212:215]
    v_mfma_f32_16x16x32_bf16 v[220:223], v[164:167], v[184:187], v[220:223]
    ds_read_b128 v[152:155], v3 offset:25600
    v_mfma_f32_16x16x32_bf16 v[224:227], v[168:171], v[180:183], v[224:227]
    v_mfma_f32_16x16x32_bf16 v[232:235], v[168:171], v[184:187], v[232:235]
    ds_read_b128 v[156:159], v3 offset:26624
    s_waitcnt lgkmcnt(3)
    v_mfma_f32_16x16x32_bf16 v[228:231], v[136:139], v[180:183], v[228:231]
    buffer_load_dwordx4 v[176:179], v129, s[4:7], s60 offen offset:256 sc1
    v_mfma_f32_16x16x32_bf16 v[236:239], v[136:139], v[184:187], v[236:239]
    ds_read_b128 v[160:163], v3 offset:27648
    v_mfma_f32_16x16x32_bf16 v[240:243], v[140:143], v[180:183], v[240:243]
    v_fma_f32 v92, v124, v133, v120
    v_mfma_f32_16x16x32_bf16 v[248:251], v[140:143], v[184:187], v[248:251]
    ds_read_b128 v[164:167], v3 offset:28672
    v_fma_f32 v93, v125, v133, v121
    v_mfma_f32_16x16x32_bf16 v[244:247], v[144:147], v[180:183], v[244:247]
    v_fma_f32 v94, v126, v133, v122
    v_mfma_f32_16x16x32_bf16 v[252:255], v[144:147], v[184:187], v[252:255]
    ds_read_b128 v[168:171], v3 offset:29696
    v_fma_f32 v95, v127, v133, v123
    s_waitcnt vmcnt(4) lgkmcnt(3)
    v_mfma_f32_16x16x32_bf16 v[208:211], v[148:151], v[188:191], v[208:211]
    buffer_load_dwordx4 v[180:183], v129, s[4:7], s60 offen offset:2048 sc1
    v_mfma_f32_16x16x32_bf16 v[216:219], v[148:151], v[192:195], v[216:219]
    ds_read_b128 v[136:139], v3 offset:30720
    v_fma_f32 v100, v124, v131, v120
    v_mfma_f32_16x16x32_bf16 v[212:215], v[152:155], v[188:191], v[212:215]
    v_fma_f32 v101, v125, v131, v121
    v_mfma_f32_16x16x32_bf16 v[220:223], v[152:155], v[192:195], v[220:223]
    ds_read_b128 v[140:143], v3 offset:31744
    v_fma_f32 v102, v126, v131, v122
    v_mfma_f32_16x16x32_bf16 v[224:227], v[156:159], v[188:191], v[224:227]
    v_fma_f32 v103, v127, v131, v123
    v_mfma_f32_16x16x32_bf16 v[232:235], v[156:159], v[192:195], v[232:235]
    ds_read_b128 v[144:147], v3 offset:32768
    s_waitcnt lgkmcnt(3)
    v_mfma_f32_16x16x32_bf16 v[228:231], v[160:163], v[188:191], v[228:231]
    buffer_load_dwordx4 v[184:187], v129, s[4:7], s60 offen offset:2304 sc1
    v_mfma_f32_16x16x32_bf16 v[236:239], v[160:163], v[192:195], v[236:239]
    ds_read_b128 v[148:151], v3 offset:33792
    ds_read_b128 v[120:123], v205 offset:512
    v_mfma_f32_16x16x32_bf16 v[240:243], v[164:167], v[188:191], v[240:243]
    ds_read_b128 v[124:127], v205 offset:128
    v_mfma_f32_16x16x32_bf16 v[248:251], v[164:167], v[192:195], v[248:251]
    ds_read_b128 v[152:155], v3 offset:34816
    v_mfma_f32_16x16x32_bf16 v[244:247], v[168:171], v[188:191], v[244:247]
    v_mfma_f32_16x16x32_bf16 v[252:255], v[168:171], v[192:195], v[252:255]
    ds_read_b128 v[156:159], v3 offset:35840
    s_waitcnt vmcnt(4) lgkmcnt(5)
    v_mfma_f32_16x16x32_bf16 v[208:211], v[136:139], v[196:199], v[208:211]
    s_add_u32 s60, s60, 4096
    buffer_load_dwordx4 v[188:191], v129, s[4:7], s60 offen offset:0 sc1
    v_mfma_f32_16x16x32_bf16 v[216:219], v[136:139], v[200:203], v[216:219]
    ds_read_b128 v[160:163], v3 offset:36864
    v_mfma_f32_16x16x32_bf16 v[212:215], v[140:143], v[196:199], v[212:215]
    v_mfma_f32_16x16x32_bf16 v[220:223], v[140:143], v[200:203], v[220:223]
    ds_read_b128 v[164:167], v3 offset:37888
    v_mfma_f32_16x16x32_bf16 v[224:227], v[144:147], v[196:199], v[224:227]
    v_mfma_f32_16x16x32_bf16 v[232:235], v[144:147], v[200:203], v[232:235]
    ds_read_b128 v[168:171], v3 offset:38912
    s_waitcnt lgkmcnt(3)
    s_barrier
    v_mfma_f32_16x16x32_bf16 v[228:231], v[148:151], v[196:199], v[228:231]
    buffer_load_dwordx4 v[192:195], v129, s[4:7], s60 offen offset:256 sc1
    v_mfma_f32_16x16x32_bf16 v[236:239], v[148:151], v[200:203], v[236:239]
    ds_read_b128 v[136:139], v3 offset:39936
    v_mfma_f32_16x16x32_bf16 v[240:243], v[152:155], v[196:199], v[240:243]
    v_mfma_f32_16x16x32_bf16 v[248:251], v[152:155], v[200:203], v[248:251]
    ds_read_b128 v[140:143], v3 offset:40960
    v_mfma_f32_16x16x32_bf16 v[244:247], v[156:159], v[196:199], v[244:247]
    v_mfma_f32_16x16x32_bf16 v[252:255], v[156:159], v[200:203], v[252:255]
    ds_read_b128 v[144:147], v3 offset:41984
    s_waitcnt vmcnt(4) lgkmcnt(3)
    v_mfma_f32_16x16x32_bf16 v[208:211], v[160:163], v[172:175], v[208:211]
    buffer_load_dwordx4 v[196:199], v129, s[4:7], s60 offen offset:2048 sc1
    v_mfma_f32_16x16x32_bf16 v[216:219], v[160:163], v[176:179], v[216:219]
    ds_read_b128 v[148:151], v3 offset:43008
    v_mfma_f32_16x16x32_bf16 v[212:215], v[164:167], v[172:175], v[212:215]
    v_fma_f32 v104, v124, v133, v120
    v_mfma_f32_16x16x32_bf16 v[220:223], v[164:167], v[176:179], v[220:223]
    ds_read_b128 v[152:155], v3 offset:44032
    v_fma_f32 v105, v125, v133, v121
    v_mfma_f32_16x16x32_bf16 v[224:227], v[168:171], v[172:175], v[224:227]
    v_fma_f32 v106, v126, v133, v122
    v_mfma_f32_16x16x32_bf16 v[232:235], v[168:171], v[176:179], v[232:235]
    ds_read_b128 v[156:159], v3 offset:45056
    v_fma_f32 v107, v127, v133, v123
    s_waitcnt lgkmcnt(3)
    v_mfma_f32_16x16x32_bf16 v[228:231], v[136:139], v[172:175], v[228:231]
    buffer_load_dwordx4 v[200:203], v129, s[4:7], s60 offen offset:2304 sc1
    v_mfma_f32_16x16x32_bf16 v[236:239], v[136:139], v[176:179], v[236:239]
    ds_read_b128 v[160:163], v3 offset:46080
    v_fma_f32 v112, v124, v131, v120
    v_mfma_f32_16x16x32_bf16 v[240:243], v[140:143], v[172:175], v[240:243]
    v_fma_f32 v113, v125, v131, v121
    v_mfma_f32_16x16x32_bf16 v[248:251], v[140:143], v[176:179], v[248:251]
    ds_read_b128 v[164:167], v3 offset:47104
    v_fma_f32 v114, v126, v131, v122
    v_mfma_f32_16x16x32_bf16 v[244:247], v[144:147], v[172:175], v[244:247]
    v_fma_f32 v115, v127, v131, v123
    v_mfma_f32_16x16x32_bf16 v[252:255], v[144:147], v[176:179], v[252:255]
    ds_read_b128 v[168:171], v3 offset:48128
    s_waitcnt vmcnt(4) lgkmcnt(3)
    v_mfma_f32_16x16x32_bf16 v[208:211], v[148:151], v[180:183], v[208:211]
    v_mfma_f32_16x16x32_bf16 v[216:219], v[148:151], v[184:187], v[216:219]
    ds_read_b128 v[136:139], v3 offset:49152
    ds_read_b128 v[120:123], v205 offset:528
    v_mfma_f32_16x16x32_bf16 v[212:215], v[152:155], v[180:183], v[212:215]
    ds_read_b128 v[124:127], v205 offset:144
    v_mfma_f32_16x16x32_bf16 v[220:223], v[152:155], v[184:187], v[220:223]
    ds_read_b128 v[140:143], v3 offset:50176
    v_mfma_f32_16x16x32_bf16 v[224:227], v[156:159], v[180:183], v[224:227]
    v_mfma_f32_16x16x32_bf16 v[232:235], v[156:159], v[184:187], v[232:235]
    ds_read_b128 v[144:147], v3 offset:51200
    s_waitcnt lgkmcnt(5)
    v_mfma_f32_16x16x32_bf16 v[228:231], v[160:163], v[180:183], v[228:231]
    v_mfma_f32_16x16x32_bf16 v[236:239], v[160:163], v[184:187], v[236:239]
    ds_read_b128 v[148:151], v3 offset:52224
    v_mfma_f32_16x16x32_bf16 v[240:243], v[164:167], v[180:183], v[240:243]
    v_mfma_f32_16x16x32_bf16 v[248:251], v[164:167], v[184:187], v[248:251]
    ds_read_b128 v[152:155], v3 offset:53248
    v_mfma_f32_16x16x32_bf16 v[244:247], v[168:171], v[180:183], v[244:247]
    v_mfma_f32_16x16x32_bf16 v[252:255], v[168:171], v[184:187], v[252:255]
    ds_read_b128 v[156:159], v3 offset:54272
    s_waitcnt vmcnt(2) lgkmcnt(3)
    v_mfma_f32_16x16x32_bf16 v[208:211], v[136:139], v[188:191], v[208:211]
    v_mfma_f32_16x16x32_bf16 v[216:219], v[136:139], v[192:195], v[216:219]
    ds_read_b128 v[160:163], v3 offset:55296
    v_mfma_f32_16x16x32_bf16 v[212:215], v[140:143], v[188:191], v[212:215]
    v_mfma_f32_16x16x32_bf16 v[220:223], v[140:143], v[192:195], v[220:223]
    ds_read_b128 v[164:167], v3 offset:56320
    v_mfma_f32_16x16x32_bf16 v[224:227], v[144:147], v[188:191], v[224:227]
    v_mfma_f32_16x16x32_bf16 v[232:235], v[144:147], v[192:195], v[232:235]
    ds_read_b128 v[168:171], v3 offset:57344
    s_waitcnt lgkmcnt(3)
    v_mfma_f32_16x16x32_bf16 v[228:231], v[148:151], v[188:191], v[228:231]
    v_mfma_f32_16x16x32_bf16 v[236:239], v[148:151], v[192:195], v[236:239]
    ds_read_b128 v[136:139], v3 offset:58368
    v_mfma_f32_16x16x32_bf16 v[240:243], v[152:155], v[188:191], v[240:243]
    v_fma_f32 v108, v124, v133, v120
    v_mfma_f32_16x16x32_bf16 v[248:251], v[152:155], v[192:195], v[248:251]
    ds_read_b128 v[140:143], v3 offset:59392
    v_fma_f32 v109, v125, v133, v121
    v_mfma_f32_16x16x32_bf16 v[244:247], v[156:159], v[188:191], v[244:247]
    v_fma_f32 v110, v126, v133, v122
    v_mfma_f32_16x16x32_bf16 v[252:255], v[156:159], v[192:195], v[252:255]
    ds_read_b128 v[144:147], v3 offset:60416
    v_fma_f32 v111, v127, v133, v123
    s_waitcnt vmcnt(0) lgkmcnt(3)
    v_mfma_f32_16x16x32_bf16 v[208:211], v[160:163], v[196:199], v[208:211]
    v_mfma_f32_16x16x32_bf16 v[216:219], v[160:163], v[200:203], v[216:219]
    v_fma_f32 v116, v124, v131, v120
    v_mfma_f32_16x16x32_bf16 v[212:215], v[164:167], v[196:199], v[212:215]
    v_fma_f32 v117, v125, v131, v121
    v_mfma_f32_16x16x32_bf16 v[220:223], v[164:167], v[200:203], v[220:223]
    v_fma_f32 v118, v126, v131, v122
    v_mfma_f32_16x16x32_bf16 v[224:227], v[168:171], v[196:199], v[224:227]
    v_fma_f32 v119, v127, v131, v123
    v_mfma_f32_16x16x32_bf16 v[232:235], v[168:171], v[200:203], v[232:235]
    s_waitcnt lgkmcnt(0)
    v_mfma_f32_16x16x32_bf16 v[228:231], v[136:139], v[196:199], v[228:231]
    v_mfma_f32_16x16x32_bf16 v[236:239], v[136:139], v[200:203], v[236:239]
    v_mfma_f32_16x16x32_bf16 v[240:243], v[140:143], v[196:199], v[240:243]
    v_mfma_f32_16x16x32_bf16 v[248:251], v[140:143], v[200:203], v[248:251]
    v_mfma_f32_16x16x32_bf16 v[244:247], v[144:147], v[196:199], v[244:247]
    v_mfma_f32_16x16x32_bf16 v[252:255], v[144:147], v[200:203], v[252:255]
    s_barrier
    ds_read_b128 v[136:139], v205 offset:256
    ds_read_b128 v[144:147], v205 offset:640
    ds_read_b128 v[140:143], v205 offset:272
    ds_read_b128 v[148:151], v205 offset:656
    s_and_b32 s44, s26, 1
    s_mul_i32 s45, s44, 5120
    v_add_u32 v196, s45, v2
    v_add_u32 v197, s45, v3
    v_add_u32 v198, s45, v4
    s_xor_b32 s45, s44, 1
    s_mul_i32 s45, s45, 156672
    v_add_u32 v199, s45, v2
    s_lshl_b32 s44, s44, 10
    s_add_u32 s44, s44, 3080192
    s_mul_i32 s60, s31, 49152
    s_add_u32 s60, s60, s44
    s_xor_b32 s45, s31, 1
    s_mul_i32 s98, s45, 49152
    s_add_u32 s98, s98, s44
    v_pk_fma_f32 v[208:209], v[208:209], v[132:133], v[88:89] op_sel_hi:[1,0,1]
    v_pk_fma_f32 v[210:211], v[210:211], v[132:133], v[90:91] op_sel_hi:[1,0,1]
    v_pk_fma_f32 v[212:213], v[212:213], v[132:133], v[92:93] op_sel_hi:[1,0,1]
    v_pk_fma_f32 v[214:215], v[214:215], v[132:133], v[94:95] op_sel_hi:[1,0,1]
    v_pk_mul_f32 v[168:169], v[208:209], v[208:209]
    v_pk_mul_f32 v[170:171], v[210:211], v[210:211]
    v_pk_mul_f32 v[172:173], v[212:213], v[212:213]
    v_pk_mul_f32 v[174:175], v[214:215], v[214:215]
    v_pk_fma_f32 v[168:169], v[168:169], s[56:57], v[206:207]
    v_pk_fma_f32 v[170:171], v[170:171], s[56:57], v[206:207]
    v_pk_fma_f32 v[172:173], v[172:173], s[56:57], v[206:207]
    v_pk_fma_f32 v[174:175], v[174:175], s[56:57], v[206:207]
    v_pk_mul_f32 v[176:177], v[168:169], v[208:209]
    v_pk_mul_f32 v[178:179], v[170:171], v[210:211]
    v_pk_mul_f32 v[180:181], v[172:173], v[212:213]
    v_pk_mul_f32 v[182:183], v[174:175], v[214:215]
    v_exp_f32 v176, v176
    v_exp_f32 v177, v177
    v_exp_f32 v178, v178
    v_exp_f32 v179, v179
    v_exp_f32 v180, v180
    v_exp_f32 v181, v181
    v_exp_f32 v182, v182
    v_exp_f32 v183, v183
    v_pk_add_f32 v[176:177], v[176:177], 1.0 op_sel_hi:[1,0]
    v_pk_add_f32 v[178:179], v[178:179], 1.0 op_sel_hi:[1,0]
    v_pk_add_f32 v[180:181], v[180:181], 1.0 op_sel_hi:[1,0]
    v_pk_add_f32 v[182:183], v[182:183], 1.0 op_sel_hi:[1,0]
    v_rcp_f32 v176, v176
    v_rcp_f32 v177, v177
    v_rcp_f32 v178, v178
    v_rcp_f32 v179, v179
    v_rcp_f32 v180, v180
    v_rcp_f32 v181, v181
    v_rcp_f32 v182, v182
    v_rcp_f32 v183, v183
    v_pk_mul_f32 v[208:209], v[208:209], v[176:177]
    v_pk_mul_f32 v[210:211], v[210:211], v[178:179]
    v_pk_mul_f32 v[212:213], v[212:213], v[180:181]
    v_pk_mul_f32 v[214:215], v[214:215], v[182:183]
    v_cvt_pk_bf16_f32 v184, v208, v209
    v_cvt_pk_bf16_f32 v185, v210, v211
    v_cvt_pk_bf16_f32 v186, v212, v213
    v_cvt_pk_bf16_f32 v187, v214, v215
    buffer_store_dwordx4 v[184:187], v2, s[4:7], s59 offen
    v_pk_fma_f32 v[216:217], v[216:217], v[130:131], v[96:97] op_sel_hi:[1,0,1]
    v_pk_fma_f32 v[218:219], v[218:219], v[130:131], v[98:99] op_sel_hi:[1,0,1]
    v_pk_fma_f32 v[220:221], v[220:221], v[130:131], v[100:101] op_sel_hi:[1,0,1]
    v_pk_fma_f32 v[222:223], v[222:223], v[130:131], v[102:103] op_sel_hi:[1,0,1]
    v_pk_mul_f32 v[168:169], v[216:217], v[216:217]
    v_pk_mul_f32 v[170:171], v[218:219], v[218:219]
    v_pk_mul_f32 v[172:173], v[220:221], v[220:221]
    v_pk_mul_f32 v[174:175], v[222:223], v[222:223]
    v_pk_fma_f32 v[168:169], v[168:169], s[56:57], v[206:207]
    v_pk_fma_f32 v[170:171], v[170:171], s[56:57], v[206:207]
    v_pk_fma_f32 v[172:173], v[172:173], s[56:57], v[206:207]
    v_pk_fma_f32 v[174:175], v[174:175], s[56:57], v[206:207]
    v_pk_mul_f32 v[176:177], v[168:169], v[216:217]
    v_pk_mul_f32 v[178:179], v[170:171], v[218:219]
    v_pk_mul_f32 v[180:181], v[172:173], v[220:221]
    v_pk_mul_f32 v[182:183], v[174:175], v[222:223]
    v_exp_f32 v176, v176
    v_exp_f32 v177, v177
    v_exp_f32 v178, v178
    v_exp_f32 v179, v179
    v_exp_f32 v180, v180
    v_exp_f32 v181, v181
    v_exp_f32 v182, v182
    v_exp_f32 v183, v183
    v_pk_add_f32 v[176:177], v[176:177], 1.0 op_sel_hi:[1,0]
    v_pk_add_f32 v[178:179], v[178:179], 1.0 op_sel_hi:[1,0]
    v_pk_add_f32 v[180:181], v[180:181], 1.0 op_sel_hi:[1,0]
    v_pk_add_f32 v[182:183], v[182:183], 1.0 op_sel_hi:[1,0]
    v_rcp_f32 v176, v176
    v_rcp_f32 v177, v177
    v_rcp_f32 v178, v178
    v_rcp_f32 v179, v179
    v_rcp_f32 v180, v180
    v_rcp_f32 v181, v181
    v_rcp_f32 v182, v182
    v_rcp_f32 v183, v183
    v_pk_mul_f32 v[216:217], v[216:217], v[176:177]
    v_pk_mul_f32 v[218:219], v[218:219], v[178:179]
    v_pk_mul_f32 v[220:221], v[220:221], v[180:181]
    v_pk_mul_f32 v[222:223], v[222:223], v[182:183]
    v_cvt_pk_bf16_f32 v188, v216, v217
    v_cvt_pk_bf16_f32 v189, v218, v219
    v_cvt_pk_bf16_f32 v190, v220, v221
    v_cvt_pk_bf16_f32 v191, v222, v223
    buffer_store_dwordx4 v[188:191], v204, s[4:7], s59 offen
    s_add_u32 s59, s59, 16384
    v_pk_fma_f32 v[224:225], v[224:225], v[132:133], v[104:105] op_sel_hi:[1,0,1]
    v_pk_fma_f32 v[226:227], v[226:227], v[132:133], v[106:107] op_sel_hi:[1,0,1]
    v_pk_fma_f32 v[228:229], v[228:229], v[132:133], v[108:109] op_sel_hi:[1,0,1]
    v_pk_fma_f32 v[230:231], v[230:231], v[132:133], v[110:111] op_sel_hi:[1,0,1]
    v_pk_mul_f32 v[168:169], v[224:225], v[224:225]
    v_pk_mul_f32 v[170:171], v[226:227], v[226:227]
    v_pk_mul_f32 v[172:173], v[228:229], v[228:229]
    v_pk_mul_f32 v[174:175], v[230:231], v[230:231]
    v_pk_fma_f32 v[168:169], v[168:169], s[56:57], v[206:207]
    v_pk_fma_f32 v[170:171], v[170:171], s[56:57], v[206:207]
    v_pk_fma_f32 v[172:173], v[172:173], s[56:57], v[206:207]
    v_pk_fma_f32 v[174:175], v[174:175], s[56:57], v[206:207]
    v_pk_mul_f32 v[176:177], v[168:169], v[224:225]
    v_pk_mul_f32 v[178:179], v[170:171], v[226:227]
    v_pk_mul_f32 v[180:181], v[172:173], v[228:229]
    v_pk_mul_f32 v[182:183], v[174:175], v[230:231]
    v_exp_f32 v176, v176
    v_exp_f32 v177, v177
    v_exp_f32 v178, v178
    v_exp_f32 v179, v179
    v_exp_f32 v180, v180
    v_exp_f32 v181, v181
    v_exp_f32 v182, v182
    v_exp_f32 v183, v183
    v_pk_add_f32 v[176:177], v[176:177], 1.0 op_sel_hi:[1,0]
    v_pk_add_f32 v[178:179], v[178:179], 1.0 op_sel_hi:[1,0]
    v_pk_add_f32 v[180:181], v[180:181], 1.0 op_sel_hi:[1,0]
    v_pk_add_f32 v[182:183], v[182:183], 1.0 op_sel_hi:[1,0]
    v_rcp_f32 v176, v176
    v_rcp_f32 v177, v177
    v_rcp_f32 v178, v178
    v_rcp_f32 v179, v179
    v_rcp_f32 v180, v180
    v_rcp_f32 v181, v181
    v_rcp_f32 v182, v182
    v_rcp_f32 v183, v183
    v_pk_mul_f32 v[224:225], v[224:225], v[176:177]
    v_pk_mul_f32 v[226:227], v[226:227], v[178:179]
    v_pk_mul_f32 v[228:229], v[228:229], v[180:181]
    v_pk_mul_f32 v[230:231], v[230:231], v[182:183]
    v_cvt_pk_bf16_f32 v184, v224, v225
    v_cvt_pk_bf16_f32 v185, v226, v227
    v_cvt_pk_bf16_f32 v186, v228, v229
    v_cvt_pk_bf16_f32 v187, v230, v231
    buffer_store_dwordx4 v[184:187], v2, s[4:7], s59 offen
    v_pk_fma_f32 v[232:233], v[232:233], v[130:131], v[112:113] op_sel_hi:[1,0,1]
    v_pk_fma_f32 v[234:235], v[234:235], v[130:131], v[114:115] op_sel_hi:[1,0,1]
    v_pk_fma_f32 v[236:237], v[236:237], v[130:131], v[116:117] op_sel_hi:[1,0,1]
    v_pk_fma_f32 v[238:239], v[238:239], v[130:131], v[118:119] op_sel_hi:[1,0,1]
    v_pk_mul_f32 v[168:169], v[232:233], v[232:233]
    v_pk_mul_f32 v[170:171], v[234:235], v[234:235]
    v_pk_mul_f32 v[172:173], v[236:237], v[236:237]
    v_pk_mul_f32 v[174:175], v[238:239], v[238:239]
    v_pk_fma_f32 v[168:169], v[168:169], s[56:57], v[206:207]
    v_pk_fma_f32 v[170:171], v[170:171], s[56:57], v[206:207]
    v_pk_fma_f32 v[172:173], v[172:173], s[56:57], v[206:207]
    v_pk_fma_f32 v[174:175], v[174:175], s[56:57], v[206:207]
    v_pk_mul_f32 v[176:177], v[168:169], v[232:233]
    v_pk_mul_f32 v[178:179], v[170:171], v[234:235]
    v_pk_mul_f32 v[180:181], v[172:173], v[236:237]
    v_pk_mul_f32 v[182:183], v[174:175], v[238:239]
    v_exp_f32 v176, v176
    v_exp_f32 v177, v177
    v_exp_f32 v178, v178
    v_exp_f32 v179, v179
    v_exp_f32 v180, v180
    v_exp_f32 v181, v181
    v_exp_f32 v182, v182
    v_exp_f32 v183, v183
    s_waitcnt vmcnt(1)
    s_add_u32 s58, s58, 1
    v_mov_b32 v192, 0
    v_mov_b32 v193, s58
    s_mov_b64 exec, 1
    buffer_store_dword v193, v192, s[4:7], s61 offen
    s_mov_b64 exec, -1
    v_pk_add_f32 v[176:177], v[176:177], 1.0 op_sel_hi:[1,0]
    v_pk_add_f32 v[178:179], v[178:179], 1.0 op_sel_hi:[1,0]
    v_pk_add_f32 v[180:181], v[180:181], 1.0 op_sel_hi:[1,0]
    v_pk_add_f32 v[182:183], v[182:183], 1.0 op_sel_hi:[1,0]
    v_rcp_f32 v176, v176
    v_rcp_f32 v177, v177
    v_rcp_f32 v178, v178
    v_rcp_f32 v179, v179
    v_rcp_f32 v180, v180
    v_rcp_f32 v181, v181
    v_rcp_f32 v182, v182
    v_rcp_f32 v183, v183
    v_pk_mul_f32 v[232:233], v[232:233], v[176:177]
    v_pk_mul_f32 v[234:235], v[234:235], v[178:179]
    v_pk_mul_f32 v[236:237], v[236:237], v[180:181]
    v_pk_mul_f32 v[238:239], v[238:239], v[182:183]
    v_cvt_pk_bf16_f32 v188, v232, v233
    v_cvt_pk_bf16_f32 v189, v234, v235
    v_cvt_pk_bf16_f32 v190, v236, v237
    v_cvt_pk_bf16_f32 v191, v238, v239
    buffer_store_dwordx4 v[188:191], v204, s[4:7], s59 offen
    s_add_u32 s59, s59, 16384
    s_waitcnt lgkmcnt(0)
    v_pk_fma_f32 v[152:153], v[136:137], v[132:133], v[144:145] op_sel:[0,1,0] op_sel_hi:[1,1,1]
    v_pk_fma_f32 v[154:155], v[138:139], v[132:133], v[146:147] op_sel:[0,1,0] op_sel_hi:[1,1,1]
    v_pk_fma_f32 v[156:157], v[140:141], v[132:133], v[148:149] op_sel:[0,1,0] op_sel_hi:[1,1,1]
    v_pk_fma_f32 v[158:159], v[142:143], v[132:133], v[150:151] op_sel:[0,1,0] op_sel_hi:[1,1,1]
    v_pk_fma_f32 v[240:241], v[240:241], v[132:133], v[152:153] op_sel_hi:[1,0,1]
    v_pk_fma_f32 v[242:243], v[242:243], v[132:133], v[154:155] op_sel_hi:[1,0,1]
    v_pk_fma_f32 v[244:245], v[244:245], v[132:133], v[156:157] op_sel_hi:[1,0,1]
    v_pk_fma_f32 v[246:247], v[246:247], v[132:133], v[158:159] op_sel_hi:[1,0,1]
    v_pk_mul_f32 v[168:169], v[240:241], v[240:241]
    v_pk_mul_f32 v[170:171], v[242:243], v[242:243]
    v_pk_mul_f32 v[172:173], v[244:245], v[244:245]
    v_pk_mul_f32 v[174:175], v[246:247], v[246:247]
    v_pk_fma_f32 v[168:169], v[168:169], s[56:57], v[206:207]
    v_pk_fma_f32 v[170:171], v[170:171], s[56:57], v[206:207]
    v_pk_fma_f32 v[172:173], v[172:173], s[56:57], v[206:207]
    v_pk_fma_f32 v[174:175], v[174:175], s[56:57], v[206:207]
    v_pk_mul_f32 v[176:177], v[168:169], v[240:241]
    v_pk_mul_f32 v[178:179], v[170:171], v[242:243]
    v_pk_mul_f32 v[180:181], v[172:173], v[244:245]
    v_pk_mul_f32 v[182:183], v[174:175], v[246:247]
    v_exp_f32 v176, v176
    v_exp_f32 v177, v177
    v_exp_f32 v178, v178
    v_exp_f32 v179, v179
    v_exp_f32 v180, v180
    v_exp_f32 v181, v181
    v_exp_f32 v182, v182
    v_exp_f32 v183, v183
    v_pk_add_f32 v[176:177], v[176:177], 1.0 op_sel_hi:[1,0]
    v_pk_add_f32 v[178:179], v[178:179], 1.0 op_sel_hi:[1,0]
    v_pk_add_f32 v[180:181], v[180:181], 1.0 op_sel_hi:[1,0]
    v_pk_add_f32 v[182:183], v[182:183], 1.0 op_sel_hi:[1,0]
    v_rcp_f32 v176, v176
    v_rcp_f32 v177, v177
    v_rcp_f32 v178, v178
    v_rcp_f32 v179, v179
    v_rcp_f32 v180, v180
    v_rcp_f32 v181, v181
    v_rcp_f32 v182, v182
    v_rcp_f32 v183, v183
    buffer_load_dword v194, v47, s[4:7], s62 offen sc1
    v_pk_mul_f32 v[240:241], v[240:241], v[176:177]
    v_pk_mul_f32 v[242:243], v[242:243], v[178:179]
    v_pk_mul_f32 v[244:245], v[244:245], v[180:181]
    v_pk_mul_f32 v[246:247], v[246:247], v[182:183]
    v_cvt_pk_bf16_f32 v184, v240, v241
    v_cvt_pk_bf16_f32 v185, v242, v243
    v_cvt_pk_bf16_f32 v186, v244, v245
    v_cvt_pk_bf16_f32 v187, v246, v247
    buffer_store_dwordx4 v[184:187], v2, s[4:7], s59 offen
    v_pk_fma_f32 v[152:153], v[136:137], v[130:131], v[144:145] op_sel:[0,1,0] op_sel_hi:[1,1,1]
    v_pk_fma_f32 v[154:155], v[138:139], v[130:131], v[146:147] op_sel:[0,1,0] op_sel_hi:[1,1,1]
    v_pk_fma_f32 v[156:157], v[140:141], v[130:131], v[148:149] op_sel:[0,1,0] op_sel_hi:[1,1,1]
    v_pk_fma_f32 v[158:159], v[142:143], v[130:131], v[150:151] op_sel:[0,1,0] op_sel_hi:[1,1,1]
    v_pk_fma_f32 v[248:249], v[248:249], v[130:131], v[152:153] op_sel_hi:[1,0,1]
    v_pk_fma_f32 v[250:251], v[250:251], v[130:131], v[154:155] op_sel_hi:[1,0,1]
    v_pk_fma_f32 v[252:253], v[252:253], v[130:131], v[156:157] op_sel_hi:[1,0,1]
    v_pk_fma_f32 v[254:255], v[254:255], v[130:131], v[158:159] op_sel_hi:[1,0,1]
    v_pk_mul_f32 v[168:169], v[248:249], v[248:249]
    v_pk_mul_f32 v[170:171], v[250:251], v[250:251]
    v_pk_mul_f32 v[172:173], v[252:253], v[252:253]
    v_pk_mul_f32 v[174:175], v[254:255], v[254:255]
    v_pk_fma_f32 v[168:169], v[168:169], s[56:57], v[206:207]
    v_pk_fma_f32 v[170:171], v[170:171], s[56:57], v[206:207]
    v_pk_fma_f32 v[172:173], v[172:173], s[56:57], v[206:207]
    v_pk_fma_f32 v[174:175], v[174:175], s[56:57], v[206:207]
    v_pk_mul_f32 v[176:177], v[168:169], v[248:249]
    v_pk_mul_f32 v[178:179], v[170:171], v[250:251]
    v_pk_mul_f32 v[180:181], v[172:173], v[252:253]
    v_pk_mul_f32 v[182:183], v[174:175], v[254:255]
    v_exp_f32 v176, v176
    v_exp_f32 v177, v177
    v_exp_f32 v178, v178
    v_exp_f32 v179, v179
    v_exp_f32 v180, v180
    v_exp_f32 v181, v181
    v_exp_f32 v182, v182
    v_exp_f32 v183, v183
    s_waitcnt vmcnt(2)
    s_add_u32 s58, s58, 1
    v_mov_b32 v192, 0
    v_mov_b32 v193, s58
    s_mov_b64 exec, 1
    buffer_store_dword v193, v192, s[4:7], s61 offen
    s_mov_b64 exec, -1
    s_sub_u32 s45, s58, 1
    s_waitcnt vmcnt(2)
    v_cmp_gt_u32 vcc, s45, v194
    s_cbranch_vccnz Lpc_27
Lpcd_28:
    buffer_load_dwordx4 v[208:211], v2, s[4:7], s60 offen offset:0 sc1
    buffer_load_dwordx4 v[212:215], v2, s[4:7], s98 offen offset:0 sc1
    buffer_load_dwordx4 v[216:219], v2, s[4:7], s60 offen offset:2048 sc1
    buffer_load_dwordx4 v[220:223], v2, s[4:7], s98 offen offset:2048 sc1
    s_add_u32 s60, s60, 4096
    buffer_load_dwordx4 v[224:227], v2, s[4:7], s60 offen offset:0 sc1
    s_add_u32 s98, s98, 4096
    buffer_load_dwordx4 v[228:231], v2, s[4:7], s98 offen offset:0 sc1
    buffer_load_dwordx4 v[232:235], v2, s[4:7], s60 offen offset:2048 sc1
    buffer_load_dwordx4 v[236:239], v2, s[4:7], s98 offen offset:2048 sc1
    ds_read_b128 v[88:91], v197 offset:61440
    ds_read_b128 v[92:95], v197 offset:62464
    ds_read_b128 v[96:99], v197 offset:63488
    ds_read_b128 v[100:103], v197 offset:64512
    ds_read_b128 v[104:107], v198 offset:0
    ds_read_b128 v[108:111], v198 offset:6144
    ds_read_b128 v[112:115], v198 offset:7168
    ds_read_b128 v[116:119], v198 offset:8192
    ds_read_b128 v[120:123], v198 offset:9216
    ds_read_b128 v[124:127], v198 offset:10240
    v_pk_add_f32 v[176:177], v[176:177], 1.0 op_sel_hi:[1,0]
    v_pk_add_f32 v[178:179], v[178:179], 1.0 op_sel_hi:[1,0]
    v_pk_add_f32 v[180:181], v[180:181], 1.0 op_sel_hi:[1,0]
    v_pk_add_f32 v[182:183], v[182:183], 1.0 op_sel_hi:[1,0]
    v_rcp_f32 v176, v176
    v_rcp_f32 v177, v177
    v_rcp_f32 v178, v178
    v_rcp_f32 v179, v179
    v_rcp_f32 v180, v180
    v_rcp_f32 v181, v181
    v_rcp_f32 v182, v182
    v_rcp_f32 v183, v183
    v_pk_mul_f32 v[248:249], v[248:249], v[176:177]
    v_pk_mul_f32 v[250:251], v[250:251], v[178:179]
    v_pk_mul_f32 v[252:253], v[252:253], v[180:181]
    v_pk_mul_f32 v[254:255], v[254:255], v[182:183]
    v_cvt_pk_bf16_f32 v188, v248, v249
    v_cvt_pk_bf16_f32 v189, v250, v251
    v_cvt_pk_bf16_f32 v190, v252, v253
    v_cvt_pk_bf16_f32 v191, v254, v255
    buffer_store_dwordx4 v[188:191], v204, s[4:7], s59 offen
    s_waitcnt vmcnt(7) lgkmcnt(5)
    v_mfma_f32_16x16x32_bf16 v[8:11], v[88:91], v[208:211], v[8:11]
    s_add_u32 s60, s60, 4096
    buffer_load_dwordx4 v[240:243], v2, s[4:7], s60 offen offset:0 sc1
    v_mfma_f32_16x16x32_bf16 v[148:151], v[88:91], v[212:215], 0
    ds_read_b128 v[128:131], v198 offset:16384
    v_mfma_f32_16x16x32_bf16 v[12:15], v[92:95], v[208:211], v[12:15]
    v_mfma_f32_16x16x32_bf16 v[152:155], v[92:95], v[212:215], 0
    ds_read_b128 v[132:135], v198 offset:17408
    v_mfma_f32_16x16x32_bf16 v[16:19], v[96:99], v[208:211], v[16:19]
    s_add_u32 s98, s98, 4096
    buffer_load_dwordx4 v[244:247], v2, s[4:7], s98 offen offset:0 sc1
    v_mfma_f32_16x16x32_bf16 v[156:159], v[96:99], v[212:215], 0
    ds_read_b128 v[136:139], v198 offset:18432
    v_mfma_f32_16x16x32_bf16 v[20:23], v[100:103], v[208:211], v[20:23]
    v_mfma_f32_16x16x32_bf16 v[160:163], v[100:103], v[212:215], 0
    ds_read_b128 v[140:143], v198 offset:19456
    v_mfma_f32_16x16x32_bf16 v[24:27], v[104:107], v[208:211], v[24:27]
    v_mfma_f32_16x16x32_bf16 v[164:167], v[104:107], v[212:215], 0
    ds_read_b128 v[144:147], v198 offset:20480
    s_waitcnt vmcnt(7) lgkmcnt(5)
    v_mfma_f32_16x16x32_bf16 v[8:11], v[108:111], v[216:219], v[8:11]
    buffer_load_dwordx4 v[208:211], v2, s[4:7], s60 offen offset:2048 sc1
    v_mfma_f32_16x16x32_bf16 v[148:151], v[108:111], v[220:223], v[148:151]
    ds_read_b128 v[88:91], v199 offset:1024
    v_mfma_f32_16x16x32_bf16 v[12:15], v[112:115], v[216:219], v[12:15]
    v_mfma_f32_16x16x32_bf16 v[152:155], v[112:115], v[220:223], v[152:155]
    ds_read_b128 v[92:95], v199 offset:2048
    v_mfma_f32_16x16x32_bf16 v[16:19], v[116:119], v[216:219], v[16:19]
    buffer_load_dwordx4 v[212:215], v2, s[4:7], s98 offen offset:2048 sc1
    v_mfma_f32_16x16x32_bf16 v[156:159], v[116:119], v[220:223], v[156:159]
    ds_read_b128 v[96:99], v199 offset:3072
    v_mfma_f32_16x16x32_bf16 v[20:23], v[120:123], v[216:219], v[20:23]
    v_mfma_f32_16x16x32_bf16 v[160:163], v[120:123], v[220:223], v[160:163]
    ds_read_b128 v[100:103], v199 offset:4096
    v_mfma_f32_16x16x32_bf16 v[24:27], v[124:127], v[216:219], v[24:27]
    v_mfma_f32_16x16x32_bf16 v[164:167], v[124:127], v[220:223], v[164:167]
    ds_read_b128 v[104:107], v196 offset:0
    s_waitcnt vmcnt(4)
    s_add_u32 s58, s58, 1
    v_mov_b32 v192, 0
    v_mov_b32 v193, s58
    s_mov_b64 exec, 1
    buffer_store_dword v193, v192, s[4:7], s61 offen
    s_mov_b64 exec, -1
    buffer_load_dword v194, v47, s[4:7], s62 offen sc1
    s_waitcnt lgkmcnt(5)
    v_mfma_f32_16x16x32_bf16 v[8:11], v[128:131], v[224:227], v[8:11]
    s_add_u32 s60, s60, 4096
    buffer_load_dwordx4 v[216:219], v2, s[4:7], s60 offen offset:0 sc1
    v_mfma_f32_16x16x32_bf16 v[148:151], v[128:131], v[228:231], v[148:151]
    ds_read_b128 v[108:111], v196 offset:6144
    v_mfma_f32_16x16x32_bf16 v[12:15], v[132:135], v[224:227], v[12:15]
    v_mfma_f32_16x16x32_bf16 v[152:155], v[132:135], v[228:231], v[152:155]
    ds_read_b128 v[112:115], v196 offset:7168
    v_mfma_f32_16x16x32_bf16 v[16:19], v[136:139], v[224:227], v[16:19]
    s_add_u32 s98, s98, 4096
    buffer_load_dwordx4 v[220:223], v2, s[4:7], s98 offen offset:0 sc1
    v_mfma_f32_16x16x32_bf16 v[156:159], v[136:139], v[228:231], v[156:159]
    ds_read_b128 v[116:119], v196 offset:8192
    v_mfma_f32_16x16x32_bf16 v[20:23], v[140:143], v[224:227], v[20:23]
    v_mfma_f32_16x16x32_bf16 v[160:163], v[140:143], v[228:231], v[160:163]
    ds_read_b128 v[120:123], v196 offset:9216
    v_mfma_f32_16x16x32_bf16 v[24:27], v[144:147], v[224:227], v[24:27]
    v_mfma_f32_16x16x32_bf16 v[164:167], v[144:147], v[228:231], v[164:167]
    ds_read_b128 v[124:127], v196 offset:10240
    s_waitcnt lgkmcnt(5)
    s_barrier
    v_mfma_f32_16x16x32_bf16 v[8:11], v[88:91], v[232:235], v[8:11]
    buffer_load_dwordx4 v[224:227], v2, s[4:7], s60 offen offset:2048 sc1
    v_mfma_f32_16x16x32_bf16 v[148:151], v[88:91], v[236:239], v[148:151]
    ds_read_b128 v[128:131], v196 offset:16384
    v_mfma_f32_16x16x32_bf16 v[12:15], v[92:95], v[232:235], v[12:15]
    v_mfma_f32_16x16x32_bf16 v[152:155], v[92:95], v[236:239], v[152:155]
    ds_read_b128 v[132:135], v196 offset:17408
    v_mfma_f32_16x16x32_bf16 v[16:19], v[96:99], v[232:235], v[16:19]
    buffer_load_dwordx4 v[228:231], v2, s[4:7], s98 offen offset:2048 sc1
    v_mfma_f32_16x16x32_bf16 v[156:159], v[96:99], v[236:239], v[156:159]
    ds_read_b128 v[136:139], v196 offset:18432
    v_mfma_f32_16x16x32_bf16 v[20:23], v[100:103], v[232:235], v[20:23]
    v_mfma_f32_16x16x32_bf16 v[160:163], v[100:103], v[236:239], v[160:163]
    ds_read_b128 v[140:143], v196 offset:19456
    v_mfma_f32_16x16x32_bf16 v[24:27], v[104:107], v[232:235], v[24:27]
    v_mfma_f32_16x16x32_bf16 v[164:167], v[104:107], v[236:239], v[164:167]
    ds_read_b128 v[144:147], v196 offset:20480
    s_waitcnt vmcnt(8) lgkmcnt(5)
    s_waitcnt vmcnt(4)
    s_sub_u32 s45, s58, 1
    v_cmp_gt_u32 vcc, s45, v194
    s_cbranch_vccnz Lpc_31
Lpcd_32:
    v_mfma_f32_16x16x32_bf16 v[8:11], v[108:111], v[240:243], v[8:11]
    s_add_u32 s60, s60, 4096
    buffer_load_dwordx4 v[232:235], v2, s[4:7], s60 offen offset:0 sc1
    v_mfma_f32_16x16x32_bf16 v[148:151], v[108:111], v[244:247], v[148:151]
    ds_read_b128 v[88:91], v196 offset:26624
    v_mfma_f32_16x16x32_bf16 v[12:15], v[112:115], v[240:243], v[12:15]
    v_mfma_f32_16x16x32_bf16 v[152:155], v[112:115], v[244:247], v[152:155]
    ds_read_b128 v[92:95], v196 offset:27648
    v_mfma_f32_16x16x32_bf16 v[16:19], v[116:119], v[240:243], v[16:19]
    s_add_u32 s98, s98, 4096
    buffer_load_dwordx4 v[236:239], v2, s[4:7], s98 offen offset:0 sc1
    v_mfma_f32_16x16x32_bf16 v[156:159], v[116:119], v[244:247], v[156:159]
    ds_read_b128 v[96:99], v196 offset:28672
    v_mfma_f32_16x16x32_bf16 v[20:23], v[120:123], v[240:243], v[20:23]
    v_mfma_f32_16x16x32_bf16 v[160:163], v[120:123], v[244:247], v[160:163]
    ds_read_b128 v[100:103], v196 offset:29696
    v_mfma_f32_16x16x32_bf16 v[24:27], v[124:127], v[240:243], v[24:27]
    v_mfma_f32_16x16x32_bf16 v[164:167], v[124:127], v[244:247], v[164:167]
    ds_read_b128 v[104:107], v196 offset:30720
    s_waitcnt lgkmcnt(5)
    v_mfma_f32_16x16x32_bf16 v[8:11], v[128:131], v[208:211], v[8:11]
    buffer_load_dwordx4 v[240:243], v2, s[4:7], s60 offen offset:2048 sc1
    v_mfma_f32_16x16x32_bf16 v[148:151], v[128:131], v[212:215], v[148:151]
    ds_read_b128 v[108:111], v196 offset:36864
    v_mfma_f32_16x16x32_bf16 v[12:15], v[132:135], v[208:211], v[12:15]
    v_mfma_f32_16x16x32_bf16 v[152:155], v[132:135], v[212:215], v[152:155]
    ds_read_b128 v[112:115], v196 offset:37888
    v_mfma_f32_16x16x32_bf16 v[16:19], v[136:139], v[208:211], v[16:19]
    buffer_load_dwordx4 v[244:247], v2, s[4:7], s98 offen offset:2048 sc1
    v_mfma_f32_16x16x32_bf16 v[156:159], v[136:139], v[212:215], v[156:159]
    ds_read_b128 v[116:119], v196 offset:38912
    v_mfma_f32_16x16x32_bf16 v[20:23], v[140:143], v[208:211], v[20:23]
    v_mfma_f32_16x16x32_bf16 v[160:163], v[140:143], v[212:215], v[160:163]
    ds_read_b128 v[120:123], v196 offset:39936
    v_mfma_f32_16x16x32_bf16 v[24:27], v[144:147], v[208:211], v[24:27]
    v_mfma_f32_16x16x32_bf16 v[164:167], v[144:147], v[212:215], v[164:167]
    ds_read_b128 v[124:127], v196 offset:40960
    s_waitcnt vmcnt(6) lgkmcnt(5)
    v_mfma_f32_16x16x32_bf16 v[8:11], v[88:91], v[216:219], v[8:11]
    s_add_u32 s60, s60, 4096
    buffer_load_dwordx4 v[208:211], v2, s[4:7], s60 offen offset:0 sc1
    v_mfma_f32_16x16x32_bf16 v[148:151], v[88:91], v[220:223], v[148:151]
    ds_read_b128 v[128:131], v196 offset:47104
    v_mfma_f32_16x16x32_bf16 v[12:15], v[92:95], v[216:219], v[12:15]
    v_mfma_f32_16x16x32_bf16 v[152:155], v[92:95], v[220:223], v[152:155]
    ds_read_b128 v[132:135], v196 offset:48128
    v_mfma_f32_16x16x32_bf16 v[16:19], v[96:99], v[216:219], v[16:19]
    s_add_u32 s98, s98, 4096
    buffer_load_dwordx4 v[212:215], v2, s[4:7], s98 offen offset:0 sc1
    v_mfma_f32_16x16x32_bf16 v[156:159], v[96:99], v[220:223], v[156:159]
    ds_read_b128 v[136:139], v196 offset:49152
    v_mfma_f32_16x16x32_bf16 v[20:23], v[100:103], v[216:219], v[20:23]
    v_mfma_f32_16x16x32_bf16 v[160:163], v[100:103], v[220:223], v[160:163]
    ds_read_b128 v[140:143], v196 offset:50176
    v_mfma_f32_16x16x32_bf16 v[24:27], v[104:107], v[216:219], v[24:27]
    v_mfma_f32_16x16x32_bf16 v[164:167], v[104:107], v[220:223], v[164:167]
    ds_read_b128 v[144:147], v196 offset:51200
    s_waitcnt vmcnt(6) lgkmcnt(5)
    v_mfma_f32_16x16x32_bf16 v[8:11], v[108:111], v[224:227], v[8:11]
    buffer_load_dwordx4 v[216:219], v2, s[4:7], s60 offen offset:2048 sc1
    v_mfma_f32_16x16x32_bf16 v[148:151], v[108:111], v[228:231], v[148:151]
    ds_read_b128 v[88:91], v196 offset:57344
    v_mfma_f32_16x16x32_bf16 v[12:15], v[112:115], v[224:227], v[12:15]
    v_mfma_f32_16x16x32_bf16 v[152:155], v[112:115], v[228:231], v[152:155]
    ds_read_b128 v[92:95], v196 offset:58368
    v_mfma_f32_16x16x32_bf16 v[16:19], v[116:119], v[224:227], v[16:19]
    buffer_load_dwordx4 v[220:223], v2, s[4:7], s98 offen offset:2048 sc1
    v_mfma_f32_16x16x32_bf16 v[156:159], v[116:119], v[228:231], v[156:159]
    ds_read_b128 v[96:99], v196 offset:59392
    v_mfma_f32_16x16x32_bf16 v[20:23], v[120:123], v[224:227], v[20:23]
    v_mfma_f32_16x16x32_bf16 v[160:163], v[120:123], v[228:231], v[160:163]
    ds_read_b128 v[100:103], v196 offset:60416
    v_mfma_f32_16x16x32_bf16 v[24:27], v[124:127], v[224:227], v[24:27]
    v_mfma_f32_16x16x32_bf16 v[164:167], v[124:127], v[228:231], v[164:167]
    ds_read_b128 v[104:107], v196 offset:61440
    s_waitcnt vmcnt(6) lgkmcnt(5)
    s_barrier
    v_mfma_f32_16x16x32_bf16 v[8:11], v[128:131], v[232:235], v[8:11]
    s_add_u32 s60, s60, 4096
    buffer_load_dwordx4 v[224:227], v2, s[4:7], s60 offen offset:0 sc1
    v_mfma_f32_16x16x32_bf16 v[148:151], v[128:131], v[236:239], v[148:151]
    ds_read_b128 v[108:111], v197 offset:2048
    v_mfma_f32_16x16x32_bf16 v[12:15], v[132:135], v[232:235], v[12:15]
    v_mfma_f32_16x16x32_bf16 v[152:155], v[132:135], v[236:239], v[152:155]
    ds_read_b128 v[112:115], v197 offset:3072
    v_mfma_f32_16x16x32_bf16 v[16:19], v[136:139], v[232:235], v[16:19]
    s_add_u32 s98, s98, 4096
    buffer_load_dwordx4 v[228:231], v2, s[4:7], s98 offen offset:0 sc1
    v_mfma_f32_16x16x32_bf16 v[156:159], v[136:139], v[236:239], v[156:159]
    ds_read_b128 v[116:119], v197 offset:4096
    v_mfma_f32_16x16x32_bf16 v[20:23], v[140:143], v[232:235], v[20:23]
    v_mfma_f32_16x16x32_bf16 v[160:163], v[140:143], v[236:239], v[160:163]
    ds_read_b128 v[120:123], v197 offset:5120
    v_mfma_f32_16x16x32_bf16 v[24:27], v[144:147], v[232:235], v[24:27]
    v_mfma_f32_16x16x32_bf16 v[164:167], v[144:147], v[236:239], v[164:167]
    ds_read_b128 v[124:127], v197 offset:6144
    s_waitcnt vmcnt(6) lgkmcnt(5)
    v_mfma_f32_16x16x32_bf16 v[8:11], v[88:91], v[240:243], v[8:11]
    buffer_load_dwordx4 v[232:235], v2, s[4:7], s60 offen offset:2048 sc1
    v_mfma_f32_16x16x32_bf16 v[148:151], v[88:91], v[244:247], v[148:151]
    ds_read_b128 v[128:131], v197 offset:12288
    v_mfma_f32_16x16x32_bf16 v[12:15], v[92:95], v[240:243], v[12:15]
    v_mfma_f32_16x16x32_bf16 v[152:155], v[92:95], v[244:247], v[152:155]
    ds_read_b128 v[132:135], v197 offset:13312
    v_mfma_f32_16x16x32_bf16 v[16:19], v[96:99], v[240:243], v[16:19]
    buffer_load_dwordx4 v[236:239], v2, s[4:7], s98 offen offset:2048 sc1
    v_mfma_f32_16x16x32_bf16 v[156:159], v[96:99], v[244:247], v[156:159]
    ds_read_b128 v[136:139], v197 offset:14336
    v_mfma_f32_16x16x32_bf16 v[20:23], v[100:103], v[240:243], v[20:23]
    v_mfma_f32_16x16x32_bf16 v[160:163], v[100:103], v[244:247], v[160:163]
    ds_read_b128 v[140:143], v197 offset:15360
    v_mfma_f32_16x16x32_bf16 v[24:27], v[104:107], v[240:243], v[24:27]
    v_mfma_f32_16x16x32_bf16 v[164:167], v[104:107], v[244:247], v[164:167]
    ds_read_b128 v[144:147], v197 offset:16384
    buffer_load_dword v194, v47, s[4:7], s62 offen sc1
    s_waitcnt vmcnt(7) lgkmcnt(5)
    v_mfma_f32_16x16x32_bf16 v[8:11], v[108:111], v[208:211], v[8:11]
    s_add_u32 s60, s60, 4096
    buffer_load_dwordx4 v[240:243], v2, s[4:7], s60 offen offset:0 sc1
    v_mfma_f32_16x16x32_bf16 v[148:151], v[108:111], v[212:215], v[148:151]
    ds_read_b128 v[88:91], v197 offset:22528
    v_mfma_f32_16x16x32_bf16 v[12:15], v[112:115], v[208:211], v[12:15]
    v_mfma_f32_16x16x32_bf16 v[152:155], v[112:115], v[212:215], v[152:155]
    ds_read_b128 v[92:95], v197 offset:23552
    v_mfma_f32_16x16x32_bf16 v[16:19], v[116:119], v[208:211], v[16:19]
    s_add_u32 s98, s98, 4096
    buffer_load_dwordx4 v[244:247], v2, s[4:7], s98 offen offset:0 sc1
    v_mfma_f32_16x16x32_bf16 v[156:159], v[116:119], v[212:215], v[156:159]
    ds_read_b128 v[96:99], v197 offset:24576
    v_mfma_f32_16x16x32_bf16 v[20:23], v[120:123], v[208:211], v[20:23]
    v_mfma_f32_16x16x32_bf16 v[160:163], v[120:123], v[212:215], v[160:163]
    ds_read_b128 v[100:103], v197 offset:25600
    v_mfma_f32_16x16x32_bf16 v[24:27], v[124:127], v[208:211], v[24:27]
    v_mfma_f32_16x16x32_bf16 v[164:167], v[124:127], v[212:215], v[164:167]
    ds_read_b128 v[104:107], v197 offset:26624
    s_waitcnt vmcnt(7) lgkmcnt(5)
    v_mfma_f32_16x16x32_bf16 v[8:11], v[128:131], v[216:219], v[8:11]
    buffer_load_dwordx4 v[208:211], v2, s[4:7], s60 offen offset:2048 sc1
    v_mfma_f32_16x16x32_bf16 v[148:151], v[128:131], v[220:223], v[148:151]
    ds_read_b128 v[108:111], v197 offset:32768
    v_mfma_f32_16x16x32_bf16 v[12:15], v[132:135], v[216:219], v[12:15]
    v_mfma_f32_16x16x32_bf16 v[152:155], v[132:135], v[220:223], v[152:155]
    ds_read_b128 v[112:115], v197 offset:33792
    v_mfma_f32_16x16x32_bf16 v[16:19], v[136:139], v[216:219], v[16:19]
    buffer_load_dwordx4 v[212:215], v2, s[4:7], s98 offen offset:2048 sc1
    v_mfma_f32_16x16x32_bf16 v[156:159], v[136:139], v[220:223], v[156:159]
    ds_read_b128 v[116:119], v197 offset:34816
    v_mfma_f32_16x16x32_bf16 v[20:23], v[140:143], v[216:219], v[20:23]
    v_mfma_f32_16x16x32_bf16 v[160:163], v[140:143], v[220:223], v[160:163]
    ds_read_b128 v[120:123], v197 offset:35840
    v_mfma_f32_16x16x32_bf16 v[24:27], v[144:147], v[216:219], v[24:27]
    v_mfma_f32_16x16x32_bf16 v[164:167], v[144:147], v[220:223], v[164:167]
    ds_read_b128 v[124:127], v197 offset:36864
    s_waitcnt vmcnt(7) lgkmcnt(5)
    s_waitcnt vmcnt(4)
    v_cmp_gt_u32 vcc, s58, v194
    s_cbranch_vccnz Lpc_35
Lpcd_36:
    v_mfma_f32_16x16x32_bf16 v[8:11], v[88:91], v[224:227], v[8:11]
    s_add_u32 s60, s60, 4096
    buffer_load_dwordx4 v[216:219], v2, s[4:7], s60 offen offset:0 sc1
    v_mfma_f32_16x16x32_bf16 v[148:151], v[88:91], v[228:231], v[148:151]
    ds_read_b128 v[128:131], v197 offset:43008
    v_mfma_f32_16x16x32_bf16 v[12:15], v[92:95], v[224:227], v[12:15]
    v_mfma_f32_16x16x32_bf16 v[152:155], v[92:95], v[228:231], v[152:155]
    ds_read_b128 v[132:135], v197 offset:44032
    v_mfma_f32_16x16x32_bf16 v[16:19], v[96:99], v[224:227], v[16:19]
    s_add_u32 s98, s98, 4096
    buffer_load_dwordx4 v[220:223], v2, s[4:7], s98 offen offset:0 sc1
    v_mfma_f32_16x16x32_bf16 v[156:159], v[96:99], v[228:231], v[156:159]
    ds_read_b128 v[136:139], v197 offset:45056
    v_mfma_f32_16x16x32_bf16 v[20:23], v[100:103], v[224:227], v[20:23]
    v_mfma_f32_16x16x32_bf16 v[160:163], v[100:103], v[228:231], v[160:163]
    ds_read_b128 v[140:143], v197 offset:46080
    v_mfma_f32_16x16x32_bf16 v[24:27], v[104:107], v[224:227], v[24:27]
    v_mfma_f32_16x16x32_bf16 v[164:167], v[104:107], v[228:231], v[164:167]
    ds_read_b128 v[144:147], v197 offset:47104
    s_waitcnt lgkmcnt(5)
    s_barrier
    v_mfma_f32_16x16x32_bf16 v[8:11], v[108:111], v[232:235], v[8:11]
    buffer_load_dwordx4 v[224:227], v2, s[4:7], s60 offen offset:2048 sc1
    v_mfma_f32_16x16x32_bf16 v[148:151], v[108:111], v[236:239], v[148:151]
    ds_read_b128 v[88:91], v197 offset:53248
    v_mfma_f32_16x16x32_bf16 v[12:15], v[112:115], v[232:235], v[12:15]
    v_mfma_f32_16x16x32_bf16 v[152:155], v[112:115], v[236:239], v[152:155]
    ds_read_b128 v[92:95], v197 offset:54272
    v_mfma_f32_16x16x32_bf16 v[16:19], v[116:119], v[232:235], v[16:19]
    buffer_load_dwordx4 v[228:231], v2, s[4:7], s98 offen offset:2048 sc1
    v_mfma_f32_16x16x32_bf16 v[156:159], v[116:119], v[236:239], v[156:159]
    ds_read_b128 v[96:99], v197 offset:55296
    v_mfma_f32_16x16x32_bf16 v[20:23], v[120:123], v[232:235], v[20:23]
    v_mfma_f32_16x16x32_bf16 v[160:163], v[120:123], v[236:239], v[160:163]
    ds_read_b128 v[100:103], v197 offset:56320
    v_mfma_f32_16x16x32_bf16 v[24:27], v[124:127], v[232:235], v[24:27]
    v_mfma_f32_16x16x32_bf16 v[164:167], v[124:127], v[236:239], v[164:167]
    ds_read_b128 v[104:107], v197 offset:57344
    s_waitcnt vmcnt(6) lgkmcnt(5)
    v_mfma_f32_16x16x32_bf16 v[8:11], v[128:131], v[240:243], v[8:11]
    s_add_u32 s60, s60, 4096
    buffer_load_dwordx4 v[232:235], v2, s[4:7], s60 offen offset:0 sc1
    v_mfma_f32_16x16x32_bf16 v[148:151], v[128:131], v[244:247], v[148:151]
    ds_read_b128 v[108:111], v197 offset:63488
    v_mfma_f32_16x16x32_bf16 v[12:15], v[132:135], v[240:243], v[12:15]
    v_mfma_f32_16x16x32_bf16 v[152:155], v[132:135], v[244:247], v[152:155]
    ds_read_b128 v[112:115], v197 offset:64512
    v_mfma_f32_16x16x32_bf16 v[16:19], v[136:139], v[240:243], v[16:19]
    s_add_u32 s98, s98, 4096
    buffer_load_dwordx4 v[236:239], v2, s[4:7], s98 offen offset:0 sc1
    v_mfma_f32_16x16x32_bf16 v[156:159], v[136:139], v[244:247], v[156:159]
    ds_read_b128 v[116:119], v198 offset:0
    v_mfma_f32_16x16x32_bf16 v[20:23], v[140:143], v[240:243], v[20:23]
    v_mfma_f32_16x16x32_bf16 v[160:163], v[140:143], v[244:247], v[160:163]
    ds_read_b128 v[120:123], v198 offset:1024
    v_mfma_f32_16x16x32_bf16 v[24:27], v[144:147], v[240:243], v[24:27]
    v_mfma_f32_16x16x32_bf16 v[164:167], v[144:147], v[244:247], v[164:167]
    ds_read_b128 v[124:127], v198 offset:2048
    s_waitcnt vmcnt(6) lgkmcnt(5)
    v_mfma_f32_16x16x32_bf16 v[8:11], v[88:91], v[208:211], v[8:11]
    buffer_load_dwordx4 v[240:243], v2, s[4:7], s60 offen offset:2048 sc1
    v_mfma_f32_16x16x32_bf16 v[148:151], v[88:91], v[212:215], v[148:151]
    ds_read_b128 v[128:131], v198 offset:8192
    v_mfma_f32_16x16x32_bf16 v[12:15], v[92:95], v[208:211], v[12:15]
    v_mfma_f32_16x16x32_bf16 v[152:155], v[92:95], v[212:215], v[152:155]
    ds_read_b128 v[132:135], v198 offset:9216
    v_mfma_f32_16x16x32_bf16 v[16:19], v[96:99], v[208:211], v[16:19]
    buffer_load_dwordx4 v[244:247], v2, s[4:7], s98 offen offset:2048 sc1
    v_mfma_f32_16x16x32_bf16 v[156:159], v[96:99], v[212:215], v[156:159]
    ds_read_b128 v[136:139], v198 offset:10240
    v_mfma_f32_16x16x32_bf16 v[20:23], v[100:103], v[208:211], v[20:23]
    v_mfma_f32_16x16x32_bf16 v[160:163], v[100:103], v[212:215], v[160:163]
    ds_read_b128 v[140:143], v198 offset:11264
    v_mfma_f32_16x16x32_bf16 v[24:27], v[104:107], v[208:211], v[24:27]
    v_mfma_f32_16x16x32_bf16 v[164:167], v[104:107], v[212:215], v[164:167]
    ds_read_b128 v[144:147], v198 offset:12288
    s_waitcnt vmcnt(6) lgkmcnt(5)
    v_mfma_f32_16x16x32_bf16 v[8:11], v[108:111], v[216:219], v[8:11]
    s_add_u32 s60, s60, 4096
    buffer_load_dwordx4 v[208:211], v2, s[4:7], s60 offen offset:0 sc1
    v_mfma_f32_16x16x32_bf16 v[148:151], v[108:111], v[220:223], v[148:151]
    ds_read_b128 v[88:91], v198 offset:18432
    v_mfma_f32_16x16x32_bf16 v[12:15], v[112:115], v[216:219], v[12:15]
    v_mfma_f32_16x16x32_bf16 v[152:155], v[112:115], v[220:223], v[152:155]
    ds_read_b128 v[92:95], v198 offset:19456
    v_mfma_f32_16x16x32_bf16 v[16:19], v[116:119], v[216:219], v[16:19]
    s_add_u32 s98, s98, 4096
    buffer_load_dwordx4 v[212:215], v2, s[4:7], s98 offen offset:0 sc1
    v_mfma_f32_16x16x32_bf16 v[156:159], v[116:119], v[220:223], v[156:159]
    ds_read_b128 v[96:99], v198 offset:20480
    v_mfma_f32_16x16x32_bf16 v[20:23], v[120:123], v[216:219], v[20:23]
    v_mfma_f32_16x16x32_bf16 v[160:163], v[120:123], v[220:223], v[160:163]
    ds_read_b128 v[100:103], v198 offset:21504
    v_mfma_f32_16x16x32_bf16 v[24:27], v[124:127], v[216:219], v[24:27]
    v_mfma_f32_16x16x32_bf16 v[164:167], v[124:127], v[220:223], v[164:167]
    ds_read_b128 v[104:107], v198 offset:22528
    s_mul_i32 s44, s26, 5120
    s_add_u32 s44, s44, 67584
    v_add_u32 v200, s44, v2
    s_xor_b32 s44, s26, 1
    s_mul_i32 s44, s44, 5120
    s_add_u32 s44, s44, 67584
    v_add_u32 v201, s44, v2
    s_waitcnt vmcnt(6) lgkmcnt(5)
    v_mfma_f32_16x16x32_bf16 v[8:11], v[128:131], v[224:227], v[8:11]
    buffer_load_dwordx4 v[216:219], v2, s[4:7], s60 offen offset:2048 sc1
    v_mfma_f32_16x16x32_bf16 v[148:151], v[128:131], v[228:231], v[148:151]
    ds_read_b128 v[108:111], v199 offset:3072
    v_mfma_f32_16x16x32_bf16 v[12:15], v[132:135], v[224:227], v[12:15]
    v_mfma_f32_16x16x32_bf16 v[152:155], v[132:135], v[228:231], v[152:155]
    ds_read_b128 v[112:115], v199 offset:4096
    v_mfma_f32_16x16x32_bf16 v[16:19], v[136:139], v[224:227], v[16:19]
    buffer_load_dwordx4 v[220:223], v2, s[4:7], s98 offen offset:2048 sc1
    v_mfma_f32_16x16x32_bf16 v[156:159], v[136:139], v[228:231], v[156:159]
    ds_read_b128 v[116:119], v196 offset:0
    v_mfma_f32_16x16x32_bf16 v[20:23], v[140:143], v[224:227], v[20:23]
    v_mfma_f32_16x16x32_bf16 v[160:163], v[140:143], v[228:231], v[160:163]
    ds_read_b128 v[120:123], v196 offset:1024
    v_mfma_f32_16x16x32_bf16 v[24:27], v[144:147], v[224:227], v[24:27]
    v_mfma_f32_16x16x32_bf16 v[164:167], v[144:147], v[228:231], v[164:167]
    ds_read_b128 v[124:127], v196 offset:2048
    s_waitcnt vmcnt(6) lgkmcnt(5)
    v_mfma_f32_16x16x32_bf16 v[8:11], v[88:91], v[232:235], v[8:11]
    s_add_u32 s60, s60, 4096
    buffer_load_dwordx4 v[224:227], v2, s[4:7], s60 offen offset:0 sc1
    v_mfma_f32_16x16x32_bf16 v[148:151], v[88:91], v[236:239], v[148:151]
    ds_read_b128 v[128:131], v196 offset:8192
    v_mfma_f32_16x16x32_bf16 v[12:15], v[92:95], v[232:235], v[12:15]
    v_mfma_f32_16x16x32_bf16 v[152:155], v[92:95], v[236:239], v[152:155]
    ds_read_b128 v[132:135], v196 offset:9216
    v_mfma_f32_16x16x32_bf16 v[16:19], v[96:99], v[232:235], v[16:19]
    s_add_u32 s98, s98, 4096
    buffer_load_dwordx4 v[228:231], v2, s[4:7], s98 offen offset:0 sc1
    v_mfma_f32_16x16x32_bf16 v[156:159], v[96:99], v[236:239], v[156:159]
    ds_read_b128 v[136:139], v196 offset:10240
    v_mfma_f32_16x16x32_bf16 v[20:23], v[100:103], v[232:235], v[20:23]
    v_mfma_f32_16x16x32_bf16 v[160:163], v[100:103], v[236:239], v[160:163]
    ds_read_b128 v[140:143], v196 offset:11264
    v_mfma_f32_16x16x32_bf16 v[24:27], v[104:107], v[232:235], v[24:27]
    v_mfma_f32_16x16x32_bf16 v[164:167], v[104:107], v[236:239], v[164:167]
    ds_read_b128 v[144:147], v196 offset:12288
    s_waitcnt vmcnt(6) lgkmcnt(5)
    v_mfma_f32_16x16x32_bf16 v[8:11], v[108:111], v[240:243], v[8:11]
    buffer_load_dwordx4 v[232:235], v2, s[4:7], s60 offen offset:2048 sc1
    v_mfma_f32_16x16x32_bf16 v[148:151], v[108:111], v[244:247], v[148:151]
    ds_read_b128 v[88:91], v196 offset:18432
    v_mfma_f32_16x16x32_bf16 v[12:15], v[112:115], v[240:243], v[12:15]
    v_mfma_f32_16x16x32_bf16 v[152:155], v[112:115], v[244:247], v[152:155]
    ds_read_b128 v[92:95], v196 offset:19456
    v_mfma_f32_16x16x32_bf16 v[16:19], v[116:119], v[240:243], v[16:19]
    buffer_load_dwordx4 v[236:239], v2, s[4:7], s98 offen offset:2048 sc1
    v_mfma_f32_16x16x32_bf16 v[156:159], v[116:119], v[244:247], v[156:159]
    ds_read_b128 v[96:99], v196 offset:20480
    v_mfma_f32_16x16x32_bf16 v[20:23], v[120:123], v[240:243], v[20:23]
    v_mfma_f32_16x16x32_bf16 v[160:163], v[120:123], v[244:247], v[160:163]
    ds_read_b128 v[100:103], v196 offset:21504
    v_mfma_f32_16x16x32_bf16 v[24:27], v[124:127], v[240:243], v[24:27]
    v_mfma_f32_16x16x32_bf16 v[164:167], v[124:127], v[244:247], v[164:167]
    ds_read_b128 v[104:107], v196 offset:22528
    s_waitcnt vmcnt(6) lgkmcnt(5)
    v_mfma_f32_16x16x32_bf16 v[8:11], v[128:131], v[208:211], v[8:11]
    s_mul_i32 s46, s26, 3072
    v_mfma_f32_16x16x32_bf16 v[148:151], v[128:131], v[212:215], v[148:151]
    ds_read_b128 v[108:111], v196 offset:28672
    s_add_u32 s46, s46, 88064
    v_mfma_f32_16x16x32_bf16 v[12:15], v[132:135], v[208:211], v[12:15]
    v_mul_u32_u24 v168, 40, v47
    v_mfma_f32_16x16x32_bf16 v[152:155], v[132:135], v[212:215], v[152:155]
    ds_read_b128 v[112:115], v196 offset:29696
    v_add_u32 v168, s46, v168
    v_mfma_f32_16x16x32_bf16 v[16:19], v[136:139], v[208:211], v[16:19]
    v_lshrrev_b32 v170, 4, v1
    v_mfma_f32_16x16x32_bf16 v[156:159], v[136:139], v[212:215], v[156:159]
    ds_read_b128 v[116:119], v196 offset:30720
    v_lshl_add_u32 v169, v170, 3, v168
    v_mfma_f32_16x16x32_bf16 v[20:23], v[140:143], v[208:211], v[20:23]
    v_lshl_add_u32 v168, v170, 4, v168
    v_mfma_f32_16x16x32_bf16 v[160:163], v[140:143], v[212:215], v[160:163]
    ds_read_b128 v[120:123], v196 offset:31744
    v_add_u32 v170, s46, v2
    v_mfma_f32_16x16x32_bf16 v[24:27], v[144:147], v[208:211], v[24:27]
    s_mul_i32 s46, s31, 20480
    v_mfma_f32_16x16x32_bf16 v[164:167], v[144:147], v[212:215], v[164:167]
    ds_read_b128 v[124:127], v196 offset:32768
    s_mul_i32 s47, s33, 160
    s_waitcnt vmcnt(4) lgkmcnt(5)
    v_mfma_f32_16x16x32_bf16 v[8:11], v[88:91], v[216:219], v[8:11]
    s_add_u32 s46, s46, s47
    v_mfma_f32_16x16x32_bf16 v[148:151], v[88:91], v[220:223], v[148:151]
    ds_read_b128 v[128:131], v196 offset:38912
    v_add_u32 v171, 0, v1
    v_mfma_f32_16x16x32_bf16 v[12:15], v[92:95], v[216:219], v[12:15]
    v_mul_u32_u24 v174, 6554, v171
    v_mfma_f32_16x16x32_bf16 v[152:155], v[92:95], v[220:223], v[152:155]
    ds_read_b128 v[132:135], v196 offset:39936
    v_lshrrev_b32 v174, 16, v174
    v_mfma_f32_16x16x32_bf16 v[16:19], v[96:99], v[216:219], v[16:19]
    v_mul_u32_u24 v174, 1120, v174
    v_mfma_f32_16x16x32_bf16 v[156:159], v[96:99], v[220:223], v[156:159]
    ds_read_b128 v[136:139], v196 offset:40960
    v_lshl_add_u32 v171, v171, 4, v174
    v_mfma_f32_16x16x32_bf16 v[20:23], v[100:103], v[216:219], v[20:23]
    v_add_u32 v172, 64, v1
    v_mfma_f32_16x16x32_bf16 v[160:163], v[100:103], v[220:223], v[160:163]
    ds_read_b128 v[140:143], v196 offset:41984
    v_mul_u32_u24 v174, 6554, v172
    v_mfma_f32_16x16x32_bf16 v[24:27], v[104:107], v[216:219], v[24:27]
    v_lshrrev_b32 v174, 16, v174
    v_mfma_f32_16x16x32_bf16 v[164:167], v[104:107], v[220:223], v[164:167]
    ds_read_b128 v[144:147], v196 offset:43008
    v_mul_u32_u24 v174, 1120, v174
    s_waitcnt vmcnt(2) lgkmcnt(5)
    v_mfma_f32_16x16x32_bf16 v[8:11], v[108:111], v[224:227], v[8:11]
    v_lshl_add_u32 v172, v172, 4, v174
    v_mfma_f32_16x16x32_bf16 v[148:151], v[108:111], v[228:231], v[148:151]
    v_add_u32 v173, 128, v1
    v_mfma_f32_16x16x32_bf16 v[12:15], v[112:115], v[224:227], v[12:15]
    v_mul_u32_u24 v174, 6554, v173
    v_mfma_f32_16x16x32_bf16 v[152:155], v[112:115], v[228:231], v[152:155]
    v_lshrrev_b32 v174, 16, v174
    v_mfma_f32_16x16x32_bf16 v[16:19], v[116:119], v[224:227], v[16:19]
    v_mul_u32_u24 v174, 1120, v174
    v_mfma_f32_16x16x32_bf16 v[156:159], v[116:119], v[228:231], v[156:159]
    v_lshl_add_u32 v173, v173, 4, v174
    v_mfma_f32_16x16x32_bf16 v[20:23], v[120:123], v[224:227], v[20:23]
    v_mfma_f32_16x16x32_bf16 v[160:163], v[120:123], v[228:231], v[160:163]
    v_mfma_f32_16x16x32_bf16 v[24:27], v[124:127], v[224:227], v[24:27]
    v_mfma_f32_16x16x32_bf16 v[164:167], v[124:127], v[228:231], v[164:167]
    s_waitcnt vmcnt(0) lgkmcnt(0)
    v_mfma_f32_16x16x32_bf16 v[148:151], v[128:131], v[236:239], v[148:151]
    v_mfma_f32_16x16x32_bf16 v[152:155], v[132:135], v[236:239], v[152:155]
    v_mfma_f32_16x16x32_bf16 v[156:159], v[136:139], v[236:239], v[156:159]
    v_mfma_f32_16x16x32_bf16 v[160:163], v[140:143], v[236:239], v[160:163]
    v_mfma_f32_16x16x32_bf16 v[164:167], v[144:147], v[236:239], v[164:167]
    v_mfma_f32_16x16x32_bf16 v[8:11], v[128:131], v[232:235], v[8:11]
    v_mfma_f32_16x16x32_bf16 v[12:15], v[132:135], v[232:235], v[12:15]
    v_mfma_f32_16x16x32_bf16 v[16:19], v[136:139], v[232:235], v[16:19]
    v_mfma_f32_16x16x32_bf16 v[20:23], v[140:143], v[232:235], v[20:23]
    v_mfma_f32_16x16x32_bf16 v[24:27], v[144:147], v[232:235], v[24:27]
    ds_write_b128 v200, v[148:151] offset:0
    ds_write_b128 v200, v[152:155] offset:1024
    ds_write_b128 v200, v[156:159] offset:2048
    ds_write_b128 v200, v[160:163] offset:3072
    ds_write_b128 v200, v[164:167] offset:4096
    s_waitcnt lgkmcnt(0)
    s_barrier
    ds_read_b128 v[148:151], v201 offset:0
    ds_read_b128 v[152:155], v201 offset:1024
    ds_read_b128 v[156:159], v201 offset:2048
    ds_read_b128 v[160:163], v201 offset:3072
    ds_read_b128 v[164:167], v201 offset:4096
    s_waitcnt lgkmcnt(4)
    v_pk_add_f32 v[8:9], v[8:9], v[148:149]
    v_pk_add_f32 v[10:11], v[10:11], v[150:151]
    s_waitcnt lgkmcnt(3)
    v_pk_add_f32 v[12:13], v[12:13], v[152:153]
    v_pk_add_f32 v[14:15], v[14:15], v[154:155]
    s_waitcnt lgkmcnt(2)
    v_pk_add_f32 v[16:17], v[16:17], v[156:157]
    v_pk_add_f32 v[18:19], v[18:19], v[158:159]
    s_waitcnt lgkmcnt(1)
    v_pk_add_f32 v[20:21], v[20:21], v[160:161]
    v_pk_add_f32 v[22:23], v[22:23], v[162:163]
    s_waitcnt lgkmcnt(0)
    v_pk_add_f32 v[24:25], v[24:25], v[164:165]
    v_pk_add_f32 v[26:27], v[26:27], v[166:167]
    s_cmp_lg_u32 s27, 0
    s_cbranch_scc1 L_final
    s_add_u32 s45, s97, 1
    s_add_u32 s97, s97, 2
    s_nop 1
    v_cvt_pk_bf16_f32 v136, v8, v9
    v_cvt_pk_bf16_f32 v137, v10, v11
    v_cvt_pk_bf16_f32 v138, v12, v13
    v_cvt_pk_bf16_f32 v139, v14, v15
    buffer_store_dwordx4 v[136:139], v43, s[4:7], 0 offen
    v_cvt_pk_bf16_f32 v140, v16, v17
    v_cvt_pk_bf16_f32 v141, v18, v19
    v_cvt_pk_bf16_f32 v142, v20, v21
    v_cvt_pk_bf16_f32 v143, v22, v23
    buffer_store_dwordx4 v[140:143], v43, s[4:7], 0 offen offset:2048
    v_cvt_pk_bf16_f32 v144, v24, v25
    v_cvt_pk_bf16_f32 v145, v26, v27
    buffer_store_dwordx2 v[144:145], v44, s[4:7], 0 offen
    v_pk_add_f32 v[148:149], v[8:9], v[10:11]
    v_pk_mul_f32 v[150:151], v[8:9], v[8:9]
    v_pk_fma_f32 v[150:151], v[10:11], v[10:11], v[150:151]
    v_pk_add_f32 v[148:149], v[148:149], v[12:13]
    v_pk_fma_f32 v[150:151], v[12:13], v[12:13], v[150:151]
    v_pk_add_f32 v[148:149], v[148:149], v[14:15]
    v_pk_fma_f32 v[150:151], v[14:15], v[14:15], v[150:151]
    v_pk_add_f32 v[148:149], v[148:149], v[16:17]
    v_pk_fma_f32 v[150:151], v[16:17], v[16:17], v[150:151]
    v_pk_add_f32 v[148:149], v[148:149], v[18:19]
    v_pk_fma_f32 v[150:151], v[18:19], v[18:19], v[150:151]
    v_pk_add_f32 v[148:149], v[148:149], v[20:21]
    v_pk_fma_f32 v[150:151], v[20:21], v[20:21], v[150:151]
    v_pk_add_f32 v[148:149], v[148:149], v[22:23]
    v_pk_fma_f32 v[150:151], v[22:23], v[22:23], v[150:151]
    v_pk_add_f32 v[148:149], v[148:149], v[24:25]
    v_pk_fma_f32 v[150:151], v[24:25], v[24:25], v[150:151]
    v_pk_add_f32 v[148:149], v[148:149], v[26:27]
    v_pk_fma_f32 v[150:151], v[26:27], v[26:27], v[150:151]
    v_add_f32 v148, v148, v149
    v_add_f32 v150, v150, v151
    v_mov_b32 v152, 0
    v_mov_b32 v153, s45
    v_permlane32_swap_b32 v148, v150
    v_add_f32 v148, v148, v150
    v_mov_b32 v150, v148
    v_mov_b32 v154, s97
    s_nop 0
    v_permlane16_swap_b32 v148, v150
    v_add_f32 v148, v148, v150
    buffer_store_dword v148, v45, s[4:7], 0 offen
    s_barrier
    s_mov_b64 exec, 1
    s_waitcnt vmcnt(1)
    buffer_store_dword v153, v152, s[4:7], s96 offen
    s_mov_b64 exec, -1
    s_lshl_b32 s44, s37, 1
    s_add_u32 s44, s44, 71680
    v_add_u32 v7, s44, v2
    ds_write_b128 v7, v[48:51] offset:0
    ds_write_b128 v7, v[52:55] offset:1024
    ds_write_b128 v7, v[56:59] offset:16384
    ds_write_b128 v7, v[60:63] offset:17408
    ds_write_b128 v7, v[64:67] offset:32768
    ds_write_b128 v7, v[68:71] offset:33792
    v_add_u32 v7, 49152, v7
    ds_write_b128 v7, v[72:75] offset:0
    ds_write_b128 v7, v[76:79] offset:1024
    ds_write_b128 v7, v[80:83] offset:16384
    ds_write_b128 v7, v[84:87] offset:17408
    s_mov_b64 exec, 1
    s_waitcnt vmcnt(1)
    buffer_store_dword v154, v152, s[4:7], s96 offen
    s_mov_b64 exec, -1
    s_setprio 0
    s_branch L_p1b
L_final:
    v_cvt_pk_bf16_f32 v140, v8, v9
    v_cvt_pk_bf16_f32 v141, v10, v11
    v_cvt_pk_bf16_f32 v142, v12, v13
    v_cvt_pk_bf16_f32 v143, v14, v15
    ds_write_b128 v168, v[140:143]
    v_cvt_pk_bf16_f32 v144, v16, v17
    v_cvt_pk_bf16_f32 v145, v18, v19
    v_cvt_pk_bf16_f32 v146, v20, v21
    v_cvt_pk_bf16_f32 v147, v22, v23
    ds_write_b128 v168, v[144:147] offset:64
    v_cvt_pk_bf16_f32 v148, v24, v25
    v_cvt_pk_bf16_f32 v149, v26, v27
    ds_write_b64 v169, v[148:149] offset:128
    ds_read_b128 v[152:155], v170 offset:0
    ds_read_b128 v[156:159], v170 offset:1024
    ds_read_b128 v[160:163], v170 offset:2048
    s_waitcnt lgkmcnt(2)
    buffer_store_dwordx4 v[152:155], v171, s[16:19], s46 offen
    s_waitcnt lgkmcnt(1)
    buffer_store_dwordx4 v[156:159], v172, s[16:19], s46 offen
    s_waitcnt lgkmcnt(0)
    s_mov_b32 exec_hi, 0
    buffer_store_dwordx4 v[160:163], v173, s[16:19], s46 offen
    s_mov_b32 exec_hi, -1
    s_endpgm
L_att_helper:
    s_setprio 3
    ds_write_b128 v128, v[136:139]
    s_mov_b32 exec_hi, 0
    ds_write_b64 v129, v[140:141] offset:1024
    s_mov_b32 exec_hi, -1
    ds_read_b128 v[212:215], v7 offset:20992
    ds_read_b128 v[216:219], v7 offset:22016
    ds_read_b128 v[220:223], v7 offset:23040
    s_waitcnt lgkmcnt(3)
    s_barrier
    s_mov_b32 exec_lo, 2
    s_mov_b32 exec_hi, 2
    buffer_load_dword v9, v8, s[4:7], s91 offen sc1
    s_mov_b64 exec, -1
    s_waitcnt lgkmcnt(2)
    buffer_store_dwordx4 v[212:215], v2, s[4:7], s46 offen offset:0 sc1
    s_waitcnt lgkmcnt(1)
    buffer_store_dwordx4 v[216:219], v2, s[4:7], s46 offen offset:1024 sc1
    s_waitcnt lgkmcnt(0)
    s_mov_b32 exec_hi, 0xff
    buffer_store_dwordx4 v[220:223], v2, s[4:7], s46 offen offset:2048 sc1
    s_mov_b32 exec_hi, -1
    s_waitcnt vmcnt(3)
    s_add_u32 s45, s27, 1
    v_cmp_le_u32 vcc, s45, v9
    s_pack_ll_b32_b16 s63, vcc_lo, vcc_hi
    s_andn2_b32 s44, 0x20002, s63
    s_cbranch_scc1 Lah_59
    s_bfe_u32 s44, s99, 0x30004
    s_lshl_b32 s44, s44, 3
    s_xor_b32 s44, s44, s35
    s_mul_i32 s44, s44, 2688
    s_add_u32 s44, s44, s38
    s_sub_u32 s45, s44, 10752
    s_add_u32 m0, s90, 31488
    s_nop 0
    buffer_load_dwordx4 v2, s[4:7], s45 offen offset:0 sc1 lds
    buffer_load_dwordx4 v2, s[4:7], s45 offen offset:1024 sc1 lds
    s_mov_b32 exec_hi, 15
    buffer_load_dwordx4 v2, s[4:7], s45 offen offset:2048 sc1 lds
    s_mov_b32 exec_hi, -1
    s_add_u32 m0, s90, 41984
    s_nop 0
    buffer_load_dwordx4 v2, s[4:7], s44 offen offset:0 sc1 lds
    buffer_load_dwordx4 v2, s[4:7], s44 offen offset:1024 sc1 lds
    s_mov_b32 exec_hi, 15
    buffer_load_dwordx4 v2, s[4:7], s44 offen offset:2048 sc1 lds
    s_mov_b32 exec_hi, -1
    s_waitcnt vmcnt(6)
    s_mov_b64 exec, 1
    buffer_store_dword v127, v126, s[4:7], s47 offen sc1
    s_mov_b64 exec, -1
    s_branch Lah_60
Lah_59:
    s_andn2_b32 s44, 2, s63
    s_cbranch_scc1 Lah_66
    s_bfe_u32 s44, s99, 0x30004
    s_lshl_b32 s44, s44, 3
    s_xor_b32 s44, s44, s35
    s_mul_i32 s44, s44, 2688
    s_add_u32 s44, s44, s38
    s_sub_u32 s45, s44, 10752
    s_add_u32 m0, s90, 31488
    s_nop 0
    buffer_load_dwordx4 v2, s[4:7], s45 offen offset:0 sc1 lds
    buffer_load_dwordx4 v2, s[4:7], s45 offen offset:1024 sc1 lds
    s_mov_b32 exec_hi, 15
    buffer_load_dwordx4 v2, s[4:7], s45 offen offset:2048 sc1 lds
    s_mov_b32 exec_hi, -1
    s_waitcnt vmcnt(3)
    s_mov_b64 exec, 1
    buffer_store_dword v127, v126, s[4:7], s47 offen sc1
    s_mov_b64 exec, -1
    s_branch Lah_60
Lah_66:
    s_waitcnt vmcnt(0)
    s_mov_b64 exec, 1
    buffer_store_dword v127, v126, s[4:7], s47 offen sc1
    s_mov_b64 exec, -1
    s_andn2_b32 s44, 2, s63
    s_cbranch_scc1 Lneed_67
Lneedd_68:
    s_bfe_u32 s44, s99, 0x30004
    s_lshl_b32 s44, s44, 3
    s_xor_b32 s44, s44, s35
    s_mul_i32 s44, s44, 2688
    s_add_u32 s44, s44, s38
    s_sub_u32 s45, s44, 10752
    s_add_u32 m0, s90, 31488
    s_nop 0
    buffer_load_dwordx4 v2, s[4:7], s45 offen offset:0 sc1 lds
    buffer_load_dwordx4 v2, s[4:7], s45 offen offset:1024 sc1 lds
    s_mov_b32 exec_hi, 15
    buffer_load_dwordx4 v2, s[4:7], s45 offen offset:2048 sc1 lds
    s_mov_b32 exec_hi, -1
    s_andn2_b32 s44, 0x20000, s63
    s_cbranch_scc1 Lah_60
    s_bfe_u32 s44, s99, 0x30004
    s_lshl_b32 s44, s44, 3
    s_xor_b32 s44, s44, s35
    s_mul_i32 s44, s44, 2688
    s_add_u32 s44, s44, s38
    s_sub_u32 s45, s44, 10752
    s_add_u32 m0, s90, 41984
    s_nop 0
    buffer_load_dwordx4 v2, s[4:7], s44 offen offset:0 sc1 lds
    buffer_load_dwordx4 v2, s[4:7], s44 offen offset:1024 sc1 lds
    s_mov_b32 exec_hi, 15
    buffer_load_dwordx4 v2, s[4:7], s44 offen offset:2048 sc1 lds
    s_mov_b32 exec_hi, -1
Lah_60:
    s_and_b32 s3, s63, 0x20000
    s_mov_b32 exec_lo, 6
    s_mov_b32 exec_hi, 6
    buffer_load_dword v9, v8, s[4:7], s91 offen sc1
    s_mov_b64 exec, -1
    s_cmp_ge_u32 s40, 864
    s_cbranch_scc1 L_rd_n
    s_mul_i32 s93, s36, 6
    s_add_u32 s93, s93, 73728
    v_add_u32 v160, s93, v2
    ds_write_b128 v160, v[88:91] offset:0
    ds_write_b128 v160, v[92:95] offset:1024
    ds_write_b128 v160, v[96:99] offset:2048
    ds_write_b128 v160, v[100:103] offset:3072
    ds_write_b128 v160, v[104:107] offset:4096
    ds_write_b128 v160, v[108:111] offset:5120
    s_cmp_lt_u32 s40, 384
    s_cbranch_scc1 L_rd_a
    s_cmp_lt_u32 s40, 704
    s_cbranch_scc1 L_rd_b
L_rd_a:
    v_lshrrev_b32 v160, 4, v1
    v_bfe_u32 v161, v1, 2, 2
    v_lshl_add_u32 v160, v160, 3, v161
    v_mul_u32_u24 v160, 160, v160
    v_add_u32 v160, s93, v160
    v_and_b32 v162, 3, v1
    v_lshl_add_u32 v161, v162, 3, v160
    v_lshl_add_u32 v160, v162, 4, v160
    ds_read_b64_tr_b16 v[168:169], v160 offset:0
    ds_read_b64_tr_b16 v[170:171], v160 offset:640
    ds_read_b64_tr_b16 v[172:173], v160 offset:8
    ds_read_b64_tr_b16 v[174:175], v160 offset:648
    ds_read_b64_tr_b16 v[176:177], v160 offset:64
    ds_read_b64_tr_b16 v[178:179], v160 offset:704
    ds_read_b64_tr_b16 v[180:181], v160 offset:72
    ds_read_b64_tr_b16 v[182:183], v160 offset:712
    ds_read_b64_tr_b16 v[184:185], v161 offset:128
    ds_read_b64_tr_b16 v[186:187], v161 offset:768
    s_add_u32 s44, s94, 4096
    s_waitcnt lgkmcnt(0)
    buffer_store_dwordx4 v[168:171], v2, s[4:7], s94 offen offset:0 sc1
    buffer_store_dwordx4 v[172:175], v2, s[4:7], s94 offen offset:1024 sc1
    buffer_store_dwordx4 v[176:179], v2, s[4:7], s94 offen offset:2048 sc1
    buffer_store_dwordx4 v[180:183], v2, s[4:7], s94 offen offset:3072 sc1
    buffer_store_dwordx4 v[184:187], v2, s[4:7], s44 offen sc1
    s_waitcnt vmcnt(5)
    s_branch L_rd_e
L_rd_b:
    v_lshrrev_b32 v160, 4, v1
    v_bfe_u32 v161, v1, 2, 2
    v_lshl_add_u32 v160, v160, 3, v161
    v_mul_u32_u24 v160, 192, v160
    v_add_u32 v160, s93, v160
    v_and_b32 v162, 3, v1
    v_lshl_add_u32 v160, v162, 4, v160
    ds_read_b64_tr_b16 v[168:169], v160 offset:0
    ds_read_b64_tr_b16 v[170:171], v160 offset:768
    ds_read_b64_tr_b16 v[172:173], v160 offset:8
    ds_read_b64_tr_b16 v[174:175], v160 offset:776
    ds_read_b64_tr_b16 v[176:177], v160 offset:64
    ds_read_b64_tr_b16 v[178:179], v160 offset:832
    ds_read_b64_tr_b16 v[180:181], v160 offset:72
    ds_read_b64_tr_b16 v[182:183], v160 offset:840
    ds_read_b64_tr_b16 v[184:185], v160 offset:128
    ds_read_b64_tr_b16 v[186:187], v160 offset:896
    ds_read_b64_tr_b16 v[188:189], v160 offset:136
    ds_read_b64_tr_b16 v[190:191], v160 offset:904
    v_mov_b32 v192, 0
    v_mov_b32 v193, 0
    v_mov_b32 v194, 0
    v_mov_b32 v195, 0
    v_mov_b32 v196, 0
    v_mov_b32 v197, 0
    v_lshlrev_b32 v162, 2, v162
    v_lshl_add_u32 v162, v161, 5, v162
    v_lshl_add_u32 v162, v5, 4, v162
    s_add_u32 s44, s94, 4096
    s_waitcnt lgkmcnt(0)
    buffer_store_dwordx4 v[168:171], v2, s[4:7], s94 offen offset:0 sc1
    buffer_store_dwordx4 v[172:175], v2, s[4:7], s94 offen offset:1024 sc1
    buffer_store_dwordx4 v[176:179], v2, s[4:7], s94 offen offset:2048 sc1
    buffer_store_dwordx4 v[180:183], v2, s[4:7], s94 offen offset:3072 sc1
    buffer_store_dwordx4 v[184:187], v2, s[4:7], s44 offen offset:0 sc1
    buffer_store_dwordx4 v[188:191], v2, s[4:7], s44 offen offset:1024 sc1
    v_dot2c_f32_bf16 v192, s39, v168
    v_dot2c_f32_bf16 v193, s39, v172
    v_dot2c_f32_bf16 v194, s39, v176
    v_dot2c_f32_bf16 v195, s39, v180
    v_dot2c_f32_bf16 v196, s39, v184
    v_dot2c_f32_bf16 v197, s39, v188
    v_dot2c_f32_bf16 v192, s39, v169
    v_dot2c_f32_bf16 v193, s39, v173
    v_dot2c_f32_bf16 v194, s39, v177
    v_dot2c_f32_bf16 v195, s39, v181
    v_dot2c_f32_bf16 v196, s39, v185
    v_dot2c_f32_bf16 v197, s39, v189
    v_dot2c_f32_bf16 v192, s39, v170
    v_dot2c_f32_bf16 v193, s39, v174
    v_dot2c_f32_bf16 v194, s39, v178
    v_dot2c_f32_bf16 v195, s39, v182
    v_dot2c_f32_bf16 v196, s39, v186
    v_dot2c_f32_bf16 v197, s39, v190
    v_dot2c_f32_bf16 v192, s39, v171
    v_dot2c_f32_bf16 v193, s39, v175
    v_dot2c_f32_bf16 v194, s39, v179
    v_dot2c_f32_bf16 v195, s39, v183
    v_dot2c_f32_bf16 v196, s39, v187
    v_dot2c_f32_bf16 v197, s39, v191
    s_nop 2
    v_permlane32_swap_b32 v192, v193
    v_permlane32_swap_b32 v194, v195
    v_permlane32_swap_b32 v196, v197
    v_add_f32 v192, v192, v193
    v_add_f32 v194, v194, v195
    v_add_f32 v196, v196, v197
    v_mov_b32 v193, v192
    v_mov_b32 v195, v194
    v_mov_b32 v197, v196
    s_nop 1
    v_permlane16_swap_b32 v192, v193
    v_permlane16_swap_b32 v194, v195
    v_permlane16_swap_b32 v196, v197
    v_add_f32 v192, v192, v193
    v_add_f32 v194, v194, v195
    v_add_f32 v196, v196, v197
    buffer_store_dword v192, v162, s[4:7], s95 offen offset:0 sc1
    buffer_store_dword v194, v162, s[4:7], s95 offen offset:128 sc1
    buffer_store_dword v196, v162, s[4:7], s95 offen offset:256 sc1
    s_waitcnt vmcnt(9)
    s_branch L_rd_e
L_rd_n:
    s_waitcnt vmcnt(0)
L_rd_e:
    s_or_b32 s40, s40, 1024
    s_barrier
    s_add_u32 s45, s27, 1
    v_cmp_le_u32 vcc, s45, v9
    s_pack_ll_b32_b16 s63, vcc_lo, vcc_hi
    s_cmp_lg_u32 s3, 0
    s_cbranch_scc1 Lah_61
    s_andn2_b32 s44, 131072, s63
    s_cbranch_scc1 Lneed_69
Lneedd_70:
    s_bfe_u32 s44, s99, 0x30004
    s_lshl_b32 s44, s44, 3
    s_xor_b32 s44, s44, s35
    s_mul_i32 s44, s44, 2688
    s_add_u32 s44, s44, s38
    s_sub_u32 s45, s44, 10752
    s_add_u32 m0, s90, 41984
    s_nop 0
    buffer_load_dwordx4 v2, s[4:7], s44 offen offset:0 sc1 lds
    buffer_load_dwordx4 v2, s[4:7], s44 offen offset:1024 sc1 lds
    s_mov_b32 exec_hi, 15
    buffer_load_dwordx4 v2, s[4:7], s44 offen offset:2048 sc1 lds
    s_mov_b32 exec_hi, -1
Lah_61:
    s_andn2_b32 s3, 0x40004, s63
    s_cbranch_scc1 Lah_62
    s_bfe_u32 s44, s99, 0x30008
    s_lshl_b32 s44, s44, 3
    s_xor_b32 s44, s44, s35
    s_mul_i32 s44, s44, 2688
    s_add_u32 s44, s44, s38
    s_sub_u32 s45, s44, 10752
    s_add_u32 m0, s90, 4294956800
    s_nop 0
    buffer_load_dwordx4 v2, s[4:7], s45 offen offset:0 sc1 lds
    buffer_load_dwordx4 v2, s[4:7], s45 offen offset:1024 sc1 lds
    s_mov_b32 exec_hi, 15
    buffer_load_dwordx4 v2, s[4:7], s45 offen offset:2048 sc1 lds
    s_mov_b32 exec_hi, -1
    s_add_u32 m0, s90, 0
    s_nop 0
    buffer_load_dwordx4 v2, s[4:7], s44 offen offset:0 sc1 lds
    buffer_load_dwordx4 v2, s[4:7], s44 offen offset:1024 sc1 lds
    s_mov_b32 exec_hi, 15
    buffer_load_dwordx4 v2, s[4:7], s44 offen offset:2048 sc1 lds
    s_mov_b32 exec_hi, -1
    s_waitcnt vmcnt(6)
    s_branch Lah_63
Lah_62:
    s_waitcnt vmcnt(0)
Lah_63:
    s_cmp_lg_u32 s27, 0
    s_cbranch_scc1 Lah_64
    v_mov_b32 v10, 163460
    v_mov_b32 v11, 1
    s_mov_b64 exec, 1
    ds_add_rtn_u32 v12, v10, v11
    s_mov_b64 exec, -1
    s_waitcnt lgkmcnt(0)
    v_readfirstlane_b32 s44, v12
    s_and_b32 s44, s44, 3
    s_cmp_lg_u32 s44, 3
    s_cbranch_scc1 Lah_64
    s_lshl_b32 s44, s24, 7
    s_add_u32 s44, s44, s92
    s_add_u32 s44, s44, 4
    s_add_u32 s45, s30, 16
    v_mov_b32 v10, 0
    v_mov_b32 v11, s45
    s_mov_b64 exec, 1
    buffer_store_dword v11, v10, s[4:7], s44 offen sc1
    s_mov_b64 exec, -1
Lah_64:
    s_setprio 3
    s_barrier
    s_cmp_eq_u32 s3, 0
    s_cbranch_scc1 Lah_65
    s_andn2_b32 s44, 262148, s63
    s_cbranch_scc1 Lneed_71
Lneedd_72:
    s_bfe_u32 s44, s99, 0x30008
    s_lshl_b32 s44, s44, 3
    s_xor_b32 s44, s44, s35
    s_mul_i32 s44, s44, 2688
    s_add_u32 s44, s44, s38
    s_sub_u32 s45, s44, 10752
    s_add_u32 m0, s90, 4294956800
    s_nop 0
    buffer_load_dwordx4 v2, s[4:7], s45 offen offset:0 sc1 lds
    buffer_load_dwordx4 v2, s[4:7], s45 offen offset:1024 sc1 lds
    s_mov_b32 exec_hi, 15
    buffer_load_dwordx4 v2, s[4:7], s45 offen offset:2048 sc1 lds
    s_mov_b32 exec_hi, -1
    s_add_u32 m0, s90, 0
    s_nop 0
    buffer_load_dwordx4 v2, s[4:7], s44 offen offset:0 sc1 lds
    buffer_load_dwordx4 v2, s[4:7], s44 offen offset:1024 sc1 lds
    s_mov_b32 exec_hi, 15
    buffer_load_dwordx4 v2, s[4:7], s44 offen offset:2048 sc1 lds
    s_mov_b32 exec_hi, -1
Lah_65:
    s_mov_b32 exec_lo, 248
    s_mov_b32 exec_hi, 248
    buffer_load_dword v9, v8, s[4:7], s91 offen sc1
    s_mov_b64 exec, -1
    s_waitcnt vmcnt(0)
    s_add_u32 s45, s27, 1
    v_cmp_le_u32 vcc, s45, v9
    s_pack_ll_b32_b16 s63, vcc_lo, vcc_hi
    v_lshlrev_b32 v16, 7, v1
    s_lshr_b32 s44, s36, 10
    s_lshr_b32 s59, s25, 3
    s_lshl2_add_u32 s59, s59, s44
    s_lshl_b32 s60, s24, 5
    s_add_u32 s60, s60, s25
    s_lshl2_add_u32 s60, s60, s44
    s_barrier
    s_andn2_b32 s44, 524296, s63
    s_cbranch_scc1 Lneed_73
Lneedd_74:
    s_bfe_u32 s44, s99, 0x3000c
    s_lshl_b32 s44, s44, 3
    s_xor_b32 s44, s44, s35
    s_mul_i32 s44, s44, 2688
    s_add_u32 s44, s44, s38
    s_sub_u32 s45, s44, 10752
    s_add_u32 m0, s90, 10496
    s_nop 0
    buffer_load_dwordx4 v2, s[4:7], s45 offen offset:0 sc1 lds
    buffer_load_dwordx4 v2, s[4:7], s45 offen offset:1024 sc1 lds
    s_mov_b32 exec_hi, 15
    buffer_load_dwordx4 v2, s[4:7], s45 offen offset:2048 sc1 lds
    s_mov_b32 exec_hi, -1
    s_add_u32 m0, s90, 20992
    s_nop 0
    buffer_load_dwordx4 v2, s[4:7], s44 offen offset:0 sc1 lds
    buffer_load_dwordx4 v2, s[4:7], s44 offen offset:1024 sc1 lds
    s_mov_b32 exec_hi, 15
    buffer_load_dwordx4 v2, s[4:7], s44 offen offset:2048 sc1 lds
    s_mov_b32 exec_hi, -1
    s_cmp_lg_u32 s27, 0
    s_cbranch_scc1 Lrp_79
    s_lshr_b32 s46, s36, 2
    s_add_u32 s46, s46, 32772
    v_lshlrev_b32 v14, 8, v46
    v_lshl_add_u32 v14, v5, 7, v14
Lrp_80:
    buffer_load_dword v15, v14, s[4:7], s46 offen sc1
    s_waitcnt vmcnt(0)
    v_cmp_gt_u32 vcc, 16, v15
    s_cbranch_vccz Lrp_81
    s_mov_b64 exec, vcc
    s_sleep 8
    s_sub_u32 s29, s29, 1
    s_cbranch_scc0 Lrp_80
    s_mov_b32 s29, 0
Lrp_81:
    s_mov_b64 exec, -1
    s_lshr_b32 s44, s24, 1
    s_lshl_b32 s44, s44, 10
    s_cmp_lg_u32 s44, s36
    s_cbranch_scc1 Lrp_76
    s_add_u32 s44, s30, 16
    v_cmp_eq_u32 vcc, s44, v15
    s_bitcmp1_b32 s24, 0
    s_cselect_b32 s44, vcc_hi, vcc_lo
    s_add_u32 s44, s44, 1
    s_cselect_b32 s44, 1, 0
    v_mov_b32 v10, 163328
    v_mov_b32 v11, s44
    ds_write_b32 v10, v11
Lrp_76:
    v_mov_b32 v10, 163464
    v_mov_b32 v11, 1
    s_mov_b64 exec, 1
    ds_add_rtn_u32 v12, v10, v11
    s_mov_b64 exec, -1
    s_waitcnt lgkmcnt(0)
    v_readfirstlane_b32 s44, v12
    s_and_b32 s44, s44, 3
    s_cmp_lg_u32 s44, 3
    s_cbranch_scc1 Lrp_77
    s_branch Lrp_78
Lrp_77:
    ds_read_b32 v12, v10
    s_waitcnt lgkmcnt(0)
    v_readfirstlane_b32 s44, v12
    s_cmp_eq_u32 s44, 4
    s_cbranch_scc1 Lrp_78
    s_sleep 1
    s_sub_u32 s29, s29, 1
    s_cbranch_scc0 Lrp_77
    s_mov_b32 s29, 0
Lrp_78:
    s_cmp_ge_u32 s26, 6
    s_cbranch_scc1 Ltab_82
    s_lshr_b32 s44, s36, 4
    v_add_u32 v136, s44, v1
    v_min_u32 v136, 95, v136
    s_mul_i32 s44, s34, 192
    v_lshl_add_u32 v137, v136, 1, s44
    global_load_ushort v138, v137, s[74:75]
    v_lshlrev_b32 v136, 2, v136
    s_mul_i32 s44, s34, 7680
    s_add_u32 s44, s44, 327680
    s_add_u32 s45, s44, 3840
    buffer_load_dword v140, v136, s[4:7], s44 offen offset:0 sc1
    buffer_load_dword v141, v136, s[4:7], s44 offen offset:384 sc1
    buffer_load_dword v142, v136, s[4:7], s44 offen offset:768 sc1
    buffer_load_dword v143, v136, s[4:7], s44 offen offset:1152 sc1
    buffer_load_dword v144, v136, s[4:7], s44 offen offset:1536 sc1
    buffer_load_dword v145, v136, s[4:7], s44 offen offset:1920 sc1
    buffer_load_dword v146, v136, s[4:7], s44 offen offset:2304 sc1
    buffer_load_dword v147, v136, s[4:7], s44 offen offset:2688 sc1
    buffer_load_dword v148, v136, s[4:7], s44 offen offset:3072 sc1
    buffer_load_dword v149, v136, s[4:7], s44 offen offset:3456 sc1
    buffer_load_dword v150, v136, s[4:7], s45 offen offset:0 sc1
    buffer_load_dword v151, v136, s[4:7], s45 offen offset:384 sc1
    buffer_load_dword v152, v136, s[4:7], s45 offen offset:768 sc1
    buffer_load_dword v153, v136, s[4:7], s45 offen offset:1152 sc1
    buffer_load_dword v154, v136, s[4:7], s45 offen offset:1536 sc1
    buffer_load_dword v155, v136, s[4:7], s45 offen offset:1920 sc1
    buffer_load_dword v156, v136, s[4:7], s45 offen offset:2304 sc1
    buffer_load_dword v157, v136, s[4:7], s45 offen offset:2688 sc1
    buffer_load_dword v158, v136, s[4:7], s45 offen offset:3072 sc1
    buffer_load_dword v159, v136, s[4:7], s45 offen offset:3456 sc1
    v_add_u32 v136, 162048, v136
    s_waitcnt vmcnt(0)
    v_add_f32 v140, v140, v141
    v_add_f32 v140, v140, v142
    v_add_f32 v140, v140, v143
    v_add_f32 v140, v140, v144
    v_add_f32 v140, v140, v145
    v_add_f32 v140, v140, v146
    v_add_f32 v140, v140, v147
    v_add_f32 v140, v140, v148
    v_add_f32 v140, v140, v149
    v_add_f32 v140, v140, v150
    v_add_f32 v140, v140, v151
    v_add_f32 v140, v140, v152
    v_add_f32 v140, v140, v153
    v_add_f32 v140, v140, v154
    v_add_f32 v140, v140, v155
    v_add_f32 v140, v140, v156
    v_add_f32 v140, v140, v157
    v_add_f32 v140, v140, v158
    v_add_f32 v140, v140, v159
    v_lshlrev_b32 v138, 16, v138
    ds_write_b32 v136, v140
    ds_write_b32 v136, v138 offset:384
Ltab_82:
    s_cmp_lt_u32 s26, 6
    s_cbranch_scc1 Ltab_83
    s_lshr_b32 s44, s36, 4
    s_and_b32 s44, s44, 64
    v_add_u32 v136, s44, v1
    v_min_u32 v136, 79, v136
    s_mul_i32 s44, s33, 160
    v_lshl_add_u32 v137, v136, 1, s44
    global_load_ushort v138, v137, s[78:79]
    v_cmp_lt_u32 vcc, 63, v136
    v_bfe_u32 v137, v136, 3, 2
    v_bfe_u32 v140, v136, 2, 2
    v_cndmask_b32 v137, v137, v140, vcc
    v_and_b32 v140, 7, v136
    v_and_b32 v141, 3, v136
    v_cndmask_b32 v140, v140, v141, vcc
    v_lshrrev_b32 v136, 5, v136
    v_lshl_add_u32 v136, v136, 3, v140
    v_mad_u32_u24 v136, v137, 20, v136
    v_lshlrev_b32 v136, 2, v136
    v_add_u32 v136, 162816, v136
    s_waitcnt vmcnt(0)
    v_lshlrev_b32 v138, 16, v138
    ds_write_b32 v136, v138
Ltab_83:
Lrp_79:
    s_add_u32 s44, s42, s36
    s_add_u32 s44, s44, 36864
    buffer_load_dwordx4 v[88:91], v2, s[4:7], s44 offen sc1
    s_add_u32 s44, s42, s36
    s_add_u32 s44, s44, 40960
    buffer_load_dwordx4 v[92:95], v2, s[4:7], s44 offen sc1
    s_add_u32 s44, s42, s36
    s_add_u32 s44, s44, 45056
    buffer_load_dwordx4 v[96:99], v2, s[4:7], s44 offen sc1
    s_add_u32 s44, s42, s36
    s_add_u32 s44, s44, 49152
    buffer_load_dwordx4 v[100:103], v2, s[4:7], s44 offen sc1
    s_add_u32 s44, s42, s36
    s_add_u32 s44, s44, 53248
    buffer_load_dwordx4 v[104:107], v2, s[4:7], s44 offen sc1
    s_add_u32 s44, s42, s36
    s_add_u32 s44, s44, 57344
    buffer_load_dwordx4 v[108:111], v2, s[4:7], s44 offen sc1
    s_waitcnt vmcnt(6)
    s_waitcnt lgkmcnt(0)
    s_barrier
    s_andn2_b32 s44, 1048592, s63
    s_cbranch_scc1 Lneed_84
Lneedd_85:
    s_bfe_u32 s44, s99, 0x30010
    s_lshl_b32 s44, s44, 3
    s_xor_b32 s44, s44, s35
    s_mul_i32 s44, s44, 2688
    s_add_u32 s44, s44, s38
    s_sub_u32 s45, s44, 10752
    s_add_u32 m0, s90, 31488
    s_nop 0
    buffer_load_dwordx4 v2, s[4:7], s45 offen offset:0 sc1 lds
    buffer_load_dwordx4 v2, s[4:7], s45 offen offset:1024 sc1 lds
    s_mov_b32 exec_hi, 15
    buffer_load_dwordx4 v2, s[4:7], s45 offen offset:2048 sc1 lds
    s_mov_b32 exec_hi, -1
    s_add_u32 m0, s90, 41984
    s_nop 0
    buffer_load_dwordx4 v2, s[4:7], s44 offen offset:0 sc1 lds
    buffer_load_dwordx4 v2, s[4:7], s44 offen offset:1024 sc1 lds
    s_mov_b32 exec_hi, 15
    buffer_load_dwordx4 v2, s[4:7], s44 offen offset:2048 sc1 lds
    s_mov_b32 exec_hi, -1
    s_add_u32 s44, s42, s36
    s_add_u32 s44, s44, 61440
    buffer_load_dwordx4 v[112:115], v2, s[4:7], s44 offen sc1
    s_waitcnt vmcnt(12)
    s_add_u32 s44, s42, s36
    s_add_u32 s44, s44, 65536
    buffer_load_dwordx4 v[116:119], v2, s[4:7], s44 offen sc1
    s_waitcnt vmcnt(12)
    s_add_u32 s44, s42, s36
    s_add_u32 s44, s44, 69632
    buffer_load_dwordx4 v[120:123], v2, s[4:7], s44 offen sc1
    s_waitcnt vmcnt(12)
    s_add_u32 s44, s42, s36
    s_add_u32 s44, s44, 73728
    buffer_load_dwordx4 v[124:127], v2, s[4:7], s44 offen sc1
    s_waitcnt vmcnt(12)
    s_add_u32 s44, s42, s36
    s_add_u32 s44, s44, 77824
    buffer_load_dwordx4 v[128:131], v2, s[4:7], s44 offen sc1
    s_waitcnt vmcnt(12)
    s_add_u32 s44, s42, s36
    s_add_u32 s44, s44, 81920
    buffer_load_dwordx4 v[132:135], v2, s[4:7], s44 offen sc1
    s_waitcnt vmcnt(12)
    s_add_u32 s44, s42, s36
    s_add_u32 s44, s44, 86016
    buffer_load_dwordx4 v[136:139], v2, s[4:7], s44 offen sc1
    s_waitcnt vmcnt(12)
    s_add_u32 m0, s36, 63488
    s_add_u32 s50, s36, s41
    s_add_u32 s50, s50, 0
    buffer_load_dwordx4 v2, s[4:7], s50 offen sc1  lds
    s_waitcnt vmcnt(12)
    s_add_u32 m0, s36, 67584
    s_add_u32 s50, s36, s41
    s_add_u32 s50, s50, 4096
    buffer_load_dwordx4 v2, s[4:7], s50 offen sc1  lds
    s_waitcnt vmcnt(12)
    s_add_u32 m0, s36, 71680
    s_add_u32 s50, s36, s41
    s_add_u32 s50, s50, 8192
    buffer_load_dwordx4 v2, s[4:7], s50 offen sc1  lds
    s_waitcnt vmcnt(12)
    s_add_u32 m0, s36, 75776
    s_add_u32 s50, s36, s41
    s_add_u32 s50, s50, 12288
    buffer_load_dwordx4 v2, s[4:7], s50 offen sc1  lds
    s_waitcnt vmcnt(12)
    s_add_u32 m0, s36, 79872
    s_add_u32 s50, s36, s41
    s_add_u32 s50, s50, 16384
    buffer_load_dwordx4 v2, s[4:7], s50 offen sc1  lds
    s_waitcnt vmcnt(12)
    s_add_u32 m0, s36, 83968
    s_add_u32 s50, s36, s41
    s_add_u32 s50, s50, 20480
    buffer_load_dwordx4 v2, s[4:7], s50 offen sc1  lds
    s_waitcnt vmcnt(12)
    s_add_u32 m0, s36, 88064
    s_add_u32 s50, s36, s41
    s_add_u32 s50, s50, 24576
    buffer_load_dwordx4 v2, s[4:7], s50 offen sc1  lds
    s_waitcnt vmcnt(12)
    s_add_u32 m0, s36, 92160
    s_add_u32 s50, s36, s41
    s_add_u32 s50, s50, 28672
    buffer_load_dwordx4 v2, s[4:7], s50 offen sc1  lds
    s_waitcnt vmcnt(12)
    s_barrier
    s_andn2_b32 s44, 2097184, s63
    s_cbranch_scc1 Lneed_86
Lneedd_87:
    s_bfe_u32 s44, s99, 0x30014
    s_lshl_b32 s44, s44, 3
    s_xor_b32 s44, s44, s35
    s_mul_i32 s44, s44, 2688
    s_add_u32 s44, s44, s38
    s_sub_u32 s45, s44, 10752
    s_add_u32 m0, s90, 4294956800
    s_nop 0
    buffer_load_dwordx4 v2, s[4:7], s45 offen offset:0 sc1 lds
    buffer_load_dwordx4 v2, s[4:7], s45 offen offset:1024 sc1 lds
    s_mov_b32 exec_hi, 15
    buffer_load_dwordx4 v2, s[4:7], s45 offen offset:2048 sc1 lds
    s_mov_b32 exec_hi, -1
    s_add_u32 m0, s90, 0
    s_nop 0
    buffer_load_dwordx4 v2, s[4:7], s44 offen offset:0 sc1 lds
    buffer_load_dwordx4 v2, s[4:7], s44 offen offset:1024 sc1 lds
    s_mov_b32 exec_hi, 15
    buffer_load_dwordx4 v2, s[4:7], s44 offen offset:2048 sc1 lds
    s_mov_b32 exec_hi, -1
    s_add_u32 s44, s42, s36
    s_add_u32 s44, s44, 90112
    buffer_load_dwordx4 v[140:143], v2, s[4:7], s44 offen sc1
    s_waitcnt vmcnt(12)
    s_add_u32 s44, s42, s36
    s_add_u32 s44, s44, 94208
    buffer_load_dwordx4 v[144:147], v2, s[4:7], s44 offen sc1
    s_waitcnt vmcnt(12)
    s_add_u32 s44, s42, s36
    s_add_u32 s44, s44, 98304
    buffer_load_dwordx4 v[148:151], v2, s[4:7], s44 offen sc1
    s_waitcnt vmcnt(12)
    s_add_u32 s44, s42, s36
    s_add_u32 s44, s44, 102400
    buffer_load_dwordx4 v[152:155], v2, s[4:7], s44 offen sc1
    s_waitcnt vmcnt(12)
    s_add_u32 s44, s42, s36
    s_add_u32 s44, s44, 106496
    buffer_load_dwordx4 v[156:159], v2, s[4:7], s44 offen sc1
    s_waitcnt vmcnt(12)
    s_add_u32 s44, s42, s36
    s_add_u32 s44, s44, 110592
    buffer_load_dwordx4 v[160:163], v2, s[4:7], s44 offen sc1
    s_waitcnt vmcnt(12)
    s_add_u32 s44, s42, s36
    s_add_u32 s44, s44, 114688
    buffer_load_dwordx4 v[164:167], v2, s[4:7], s44 offen sc1
    s_waitcnt vmcnt(12)
    s_add_u32 s44, s42, s36
    s_add_u32 s44, s44, 118784
    buffer_load_dwordx4 v[168:171], v2, s[4:7], s44 offen sc1
    s_waitcnt vmcnt(12)
    s_add_u32 m0, s36, 96256
    s_add_u32 s50, s36, s41
    s_add_u32 s50, s50, 32768
    buffer_load_dwordx4 v2, s[4:7], s50 offen sc1  lds
    s_waitcnt vmcnt(12)
    s_add_u32 m0, s36, 100352
    s_add_u32 s50, s36, s41
    s_add_u32 s50, s50, 36864
    buffer_load_dwordx4 v2, s[4:7], s50 offen sc1  lds
    s_waitcnt vmcnt(12)
    s_add_u32 m0, s36, 104448
    s_add_u32 s50, s36, s41
    s_add_u32 s50, s50, 40960
    buffer_load_dwordx4 v2, s[4:7], s50 offen sc1  lds
    s_waitcnt vmcnt(12)
    s_add_u32 m0, s36, 108544
    s_add_u32 s50, s36, s41
    s_add_u32 s50, s50, 45056
    buffer_load_dwordx4 v2, s[4:7], s50 offen sc1  lds
    s_waitcnt vmcnt(12)
    s_add_u32 m0, s36, 112640
    s_add_u32 s50, s36, s41
    s_add_u32 s50, s50, 49152
    buffer_load_dwordx4 v2, s[4:7], s50 offen sc1  lds
    s_waitcnt vmcnt(12)
    s_add_u32 m0, s36, 116736
    s_add_u32 s50, s36, s41
    s_add_u32 s50, s50, 53248
    buffer_load_dwordx4 v2, s[4:7], s50 offen sc1  lds
    s_waitcnt vmcnt(12)
    s_add_u32 m0, s36, 120832
    s_add_u32 s50, s36, s41
    s_add_u32 s50, s50, 57344
    buffer_load_dwordx4 v2, s[4:7], s50 offen sc1  lds
    s_waitcnt vmcnt(12)
    s_add_u32 m0, s36, 124928
    s_add_u32 s50, s36, s41
    s_add_u32 s50, s50, 61440
    buffer_load_dwordx4 v2, s[4:7], s50 offen sc1  lds
    s_waitcnt vmcnt(12)
    s_add_u32 m0, s36, 129024
    s_add_u32 s50, s36, s41
    s_add_u32 s50, s50, 65536
    buffer_load_dwordx4 v2, s[4:7], s50 offen sc1  lds
    s_waitcnt vmcnt(12)
    s_add_u32 m0, s36, 133120
    s_add_u32 s50, s36, s41
    s_add_u32 s50, s50, 69632
    buffer_load_dwordx4 v2, s[4:7], s50 offen sc1  lds
    s_waitcnt vmcnt(12)
    s_barrier
    s_andn2_b32 s44, 4194368, s63
    s_cbranch_scc1 Lneed_88
Lneedd_89:
    s_bfe_u32 s44, s99, 0x30018
    s_lshl_b32 s44, s44, 3
    s_xor_b32 s44, s44, s35
    s_mul_i32 s44, s44, 2688
    s_add_u32 s44, s44, s38
    s_sub_u32 s45, s44, 10752
    s_add_u32 m0, s90, 10496
    s_nop 0
    buffer_load_dwordx4 v2, s[4:7], s45 offen offset:0 sc1 lds
    buffer_load_dwordx4 v2, s[4:7], s45 offen offset:1024 sc1 lds
    s_mov_b32 exec_hi, 15
    buffer_load_dwordx4 v2, s[4:7], s45 offen offset:2048 sc1 lds
    s_mov_b32 exec_hi, -1
    s_add_u32 m0, s90, 20992
    s_nop 0
    buffer_load_dwordx4 v2, s[4:7], s44 offen offset:0 sc1 lds
    buffer_load_dwordx4 v2, s[4:7], s44 offen offset:1024 sc1 lds
    s_mov_b32 exec_hi, 15
    buffer_load_dwordx4 v2, s[4:7], s44 offen offset:2048 sc1 lds
    s_mov_b32 exec_hi, -1
    s_add_u32 m0, s36, 137216
    s_add_u32 s50, s36, s41
    s_add_u32 s50, s50, 73728
    buffer_load_dwordx4 v2, s[4:7], s50 offen sc1  lds
    s_waitcnt vmcnt(12)
    s_add_u32 m0, s36, 141312
    s_add_u32 s50, s36, s41
    s_add_u32 s50, s50, 77824
    buffer_load_dwordx4 v2, s[4:7], s50 offen sc1  lds
    s_waitcnt vmcnt(12)
    s_add_u32 m0, s36, 145408
    s_add_u32 s50, s36, s41
    s_add_u32 s50, s50, 81920
    buffer_load_dwordx4 v2, s[4:7], s50 offen sc1  lds
    s_waitcnt vmcnt(12)
    s_add_u32 m0, s36, 149504
    s_add_u32 s50, s36, s41
    s_add_u32 s50, s50, 86016
    buffer_load_dwordx4 v2, s[4:7], s50 offen sc1  lds
    s_waitcnt vmcnt(12)
    s_add_u32 m0, s36, 153600
    s_add_u32 s50, s36, s41
    s_add_u32 s50, s50, 90112
    buffer_load_dwordx4 v2, s[4:7], s50 offen sc1  lds
    s_waitcnt vmcnt(12)
    s_add_u32 m0, s36, 157696
    s_add_u32 s50, s36, s41
    s_add_u32 s50, s50, 94208
    buffer_load_dwordx4 v2, s[4:7], s50 offen sc1  lds
    s_waitcnt vmcnt(12)
    s_add_u32 s44, s43, s36
    s_add_u32 s44, s44, 159744
    buffer_load_dwordx4 v[172:175], v2, s[4:7], s44 offen sc1
    s_waitcnt vmcnt(12)
    s_add_u32 s44, s43, s36
    s_add_u32 s44, s44, 163840
    buffer_load_dwordx4 v[176:179], v2, s[4:7], s44 offen sc1
    s_waitcnt vmcnt(12)
    s_add_u32 s44, s43, s36
    s_add_u32 s44, s44, 167936
    buffer_load_dwordx4 v[180:183], v2, s[4:7], s44 offen sc1
    s_waitcnt vmcnt(12)
    s_add_u32 s44, s43, s36
    s_add_u32 s44, s44, 172032
    buffer_load_dwordx4 v[184:187], v2, s[4:7], s44 offen sc1
    s_waitcnt vmcnt(12)
    s_add_u32 s44, s43, s36
    s_add_u32 s44, s44, 176128
    buffer_load_dwordx4 v[188:191], v2, s[4:7], s44 offen sc1
    s_waitcnt vmcnt(12)
    s_add_u32 s44, s43, s36
    s_add_u32 s44, s44, 180224
    buffer_load_dwordx4 v[192:195], v2, s[4:7], s44 offen sc1
    s_waitcnt vmcnt(12)
    s_add_u32 s44, s43, s36
    s_add_u32 s44, s44, 184320
    buffer_load_dwordx4 v[196:199], v2, s[4:7], s44 offen sc1
    s_waitcnt vmcnt(12)
    s_add_u32 s44, s43, s36
    s_add_u32 s44, s44, 188416
    buffer_load_dwordx4 v[200:203], v2, s[4:7], s44 offen sc1
    s_waitcnt vmcnt(12)
    s_add_u32 s44, s43, s36
    s_add_u32 s44, s44, 192512
    buffer_load_dwordx4 v[204:207], v2, s[4:7], s44 offen sc1
    s_waitcnt vmcnt(12)
    s_add_u32 s44, s43, s36
    s_add_u32 s44, s44, 196608
    buffer_load_dwordx4 v[208:211], v2, s[4:7], s44 offen sc1
    s_waitcnt vmcnt(12)
    s_add_u32 s44, s43, s36
    s_add_u32 s44, s44, 200704
    buffer_load_dwordx4 v[212:215], v2, s[4:7], s44 offen sc1
    s_waitcnt vmcnt(12)
    s_add_u32 s44, s43, s36
    s_add_u32 s44, s44, 204800
    buffer_load_dwordx4 v[216:219], v2, s[4:7], s44 offen sc1
    s_waitcnt vmcnt(12)
    s_add_u32 s44, s43, s36
    s_add_u32 s44, s44, 208896
    buffer_load_dwordx4 v[220:223], v2, s[4:7], s44 offen sc1
    s_waitcnt vmcnt(12)
    s_add_u32 s44, s43, s36
    s_add_u32 s44, s44, 212992
    buffer_load_dwordx4 v[224:227], v2, s[4:7], s44 offen sc1
    s_waitcnt vmcnt(12)
    s_add_u32 s44, s43, s36
    s_add_u32 s44, s44, 217088
    buffer_load_dwordx4 v[228:231], v2, s[4:7], s44 offen sc1
    s_waitcnt vmcnt(12)
    s_barrier
    s_andn2_b32 s44, 8388736, s63
    s_cbranch_scc1 Lneed_90
Lneedd_91:
    s_bfe_u32 s44, s99, 0x3001c
    s_lshl_b32 s44, s44, 3
    s_xor_b32 s44, s44, s35
    s_mul_i32 s44, s44, 2688
    s_add_u32 s44, s44, s38
    s_sub_u32 s45, s44, 10752
    s_add_u32 m0, s90, 31488
    s_nop 0
    buffer_load_dwordx4 v2, s[4:7], s45 offen offset:0 sc1 lds
    buffer_load_dwordx4 v2, s[4:7], s45 offen offset:1024 sc1 lds
    s_mov_b32 exec_hi, 15
    buffer_load_dwordx4 v2, s[4:7], s45 offen offset:2048 sc1 lds
    s_mov_b32 exec_hi, -1
    s_add_u32 m0, s90, 41984
    s_nop 0
    buffer_load_dwordx4 v2, s[4:7], s44 offen offset:0 sc1 lds
    buffer_load_dwordx4 v2, s[4:7], s44 offen offset:1024 sc1 lds
    s_mov_b32 exec_hi, 15
    buffer_load_dwordx4 v2, s[4:7], s44 offen offset:2048 sc1 lds
    s_mov_b32 exec_hi, -1
    s_add_u32 s44, s43, s36
    s_add_u32 s44, s44, 221184
    buffer_load_dwordx4 v[232:235], v2, s[4:7], s44 offen sc1
    s_waitcnt vmcnt(12)
    s_add_u32 s44, s43, s36
    s_add_u32 s44, s44, 225280
    buffer_load_dwordx4 v[236:239], v2, s[4:7], s44 offen sc1
    s_waitcnt vmcnt(12)
    s_add_u32 s44, s43, s36
    s_add_u32 s44, s44, 229376
    buffer_load_dwordx4 v[240:243], v2, s[4:7], s44 offen sc1
    s_waitcnt vmcnt(12)
    s_add_u32 s44, s43, s36
    s_add_u32 s44, s44, 233472
    buffer_load_dwordx4 v[244:247], v2, s[4:7], s44 offen sc1
    s_waitcnt vmcnt(12)
    s_add_u32 s44, s43, s36
    s_add_u32 s44, s44, 237568
    buffer_load_dwordx4 v[248:251], v2, s[4:7], s44 offen sc1
    s_waitcnt vmcnt(12)
    s_add_u32 s44, s43, s36
    s_add_u32 s44, s44, 241664
    buffer_load_dwordx4 v[252:255], v2, s[4:7], s44 offen sc1
    s_waitcnt vmcnt(12)
    s_mul_i32 s44, s59, 3328
    s_add_u32 s44, s44, s43
    s_add_u32 s44, s44, 106496
    s_bfm_b64 exec, 26, 0
    buffer_load_dword v17, v16, s[4:7], s44 offen sc1
    s_mov_b64 exec, -1
    s_mul_i32 s44, s60, 6144
    s_add_u32 s44, s44, 3080192
    s_bfm_b64 exec, 12, 0
    buffer_load_dword v17, v16, s[4:7], s44 offen sc1
    s_mov_b64 exec, -1
    s_mul_i32 s44, s60, 6144
    s_add_u32 s44, s44, 3080192
    s_add_u32 s44, s44, 1536
    s_bfm_b64 exec, 12, 0
    buffer_load_dword v17, v16, s[4:7], s44 offen sc1
    s_mov_b64 exec, -1
    s_mul_i32 s44, s60, 6144
    s_add_u32 s44, s44, 3080192
    s_add_u32 s44, s44, 3072
    s_bfm_b64 exec, 12, 0
    buffer_load_dword v17, v16, s[4:7], s44 offen sc1
    s_mov_b64 exec, -1
    s_waitcnt vmcnt(10)
    s_barrier
    s_add_u32 m0, s36, 0
    s_add_u32 s50, s36, s41
    s_add_u32 s50, s50, 98304
    buffer_load_dwordx4 v2, s[4:7], s50 offen sc1  lds
    s_add_u32 m0, s36, 4096
    s_add_u32 s50, s36, s42
    s_add_u32 s50, s50, 0
    buffer_load_dwordx4 v2, s[4:7], s50 offen sc1  lds
    s_add_u32 m0, s36, 8192
    s_add_u32 s50, s36, s42
    s_add_u32 s50, s50, 4096
    buffer_load_dwordx4 v2, s[4:7], s50 offen sc1  lds
    s_waitcnt vmcnt(12)
    s_add_u32 m0, s36, 12288
    s_add_u32 s50, s36, s42
    s_add_u32 s50, s50, 8192
    buffer_load_dwordx4 v2, s[4:7], s50 offen sc1  lds
    s_waitcnt vmcnt(12)
    s_barrier
    s_add_u32 m0, s36, 16384
    s_add_u32 s50, s36, s42
    s_add_u32 s50, s50, 12288
    buffer_load_dwordx4 v2, s[4:7], s50 offen sc1  lds
    s_waitcnt vmcnt(12)
    s_add_u32 m0, s36, 20480
    s_add_u32 s50, s36, s42
    s_add_u32 s50, s50, 16384
    buffer_load_dwordx4 v2, s[4:7], s50 offen sc1  lds
    s_waitcnt vmcnt(12)
    s_add_u32 m0, s36, 24576
    s_add_u32 s50, s36, s42
    s_add_u32 s50, s50, 20480
    buffer_load_dwordx4 v2, s[4:7], s50 offen sc1  lds
    s_waitcnt vmcnt(12)
    s_add_u32 m0, s36, 28672
    s_add_u32 s50, s36, s42
    s_add_u32 s50, s50, 24576
    buffer_load_dwordx4 v2, s[4:7], s50 offen sc1  lds
    s_waitcnt vmcnt(12)
    s_add_u32 m0, s36, 32768
    s_add_u32 s50, s36, s42
    s_add_u32 s50, s50, 28672
    buffer_load_dwordx4 v2, s[4:7], s50 offen sc1  lds
    s_waitcnt vmcnt(12)
    s_add_u32 m0, s36, 36864
    s_add_u32 s50, s36, s42
    s_add_u32 s50, s50, 32768
    buffer_load_dwordx4 v2, s[4:7], s50 offen sc1  lds
    s_waitcnt vmcnt(12)
    s_mul_i32 s44, s60, 6144
    s_add_u32 s44, s44, 3080192
    s_add_u32 s44, s44, 4608
    s_bfm_b64 exec, 12, 0
    buffer_load_dword v17, v16, s[4:7], s44 offen sc1
    s_mov_b64 exec, -1
    s_mul_i32 s44, s60, 2560
    s_add_u32 s44, s44, 458752
    s_bfm_b64 exec, 10, 0
    buffer_load_dword v17, v16, s[4:7], s44 offen sc1
    s_mov_b64 exec, -1
    s_mul_i32 s44, s60, 2560
    s_add_u32 s44, s44, 458752
    s_add_u32 s44, s44, 1280
    s_bfm_b64 exec, 10, 0
    buffer_load_dword v17, v16, s[4:7], s44 offen sc1
    s_mov_b64 exec, -1
    s_mul_i32 s44, s60, 128
    s_add_u32 s44, s44, 196608
    s_bfm_b64 exec, 1, 0
    buffer_load_dword v17, v16, s[4:7], s44 offen sc1
    s_mov_b64 exec, -1
    s_mul_i32 s44, s59, 3328
    s_add_u32 s44, s44, s43
    s_bfm_b64 exec, 26, 0
    buffer_load_dword v17, v16, s[4:7], s44 offen sc1
    s_mov_b64 exec, -1
    s_mul_i32 s44, s59, 3328
    s_add_u32 s44, s44, s43
    s_add_u32 s44, s44, 53248
    s_bfm_b64 exec, 26, 0
    buffer_load_dword v17, v16, s[4:7], s44 offen sc1
    s_mov_b64 exec, -1
    s_waitcnt vmcnt(6)
    s_barrier
    v_add_u32 v20, s36, v2
    v_add_u32 v21, s36, v3
    v_add_u32 v22, s36, v4
    s_setprio 0
    ds_write_b128 v20, v[88:91] offset:40960
    ds_write_b128 v20, v[92:95] offset:45056
    ds_write_b128 v20, v[96:99] offset:49152
    ds_write_b128 v20, v[100:103] offset:53248
    ds_write_b128 v20, v[104:107] offset:57344
    s_waitcnt lgkmcnt(0)
    s_barrier
    ds_write_b128 v20, v[108:111] offset:61440
    ds_write_b128 v21, v[112:115] offset:0
    ds_write_b128 v21, v[116:119] offset:4096
    ds_write_b128 v21, v[120:123] offset:8192
    ds_write_b128 v21, v[124:127] offset:12288
    ds_write_b128 v21, v[128:131] offset:16384
    ds_write_b128 v21, v[132:135] offset:20480
    ds_write_b128 v21, v[136:139] offset:24576
    ds_write_b128 v21, v[140:143] offset:28672
    ds_write_b128 v21, v[144:147] offset:32768
    ds_write_b128 v21, v[148:151] offset:36864
    ds_write_b128 v21, v[152:155] offset:40960
    ds_write_b128 v21, v[156:159] offset:45056
    ds_write_b128 v21, v[160:163] offset:49152
    ds_write_b128 v21, v[164:167] offset:53248
    ds_write_b128 v21, v[168:171] offset:57344
    s_add_u32 m0, s36, 126976
    s_add_u32 s50, s36, s43
    s_add_u32 s50, s50, 0
    buffer_load_dwordx4 v2, s[4:7], s50 offen sc1  lds
    s_waitcnt vmcnt(0)
    s_add_u32 m0, s36, 131072
    s_add_u32 s50, s36, s43
    s_add_u32 s50, s50, 4096
    buffer_load_dwordx4 v2, s[4:7], s50 offen sc1  lds
    s_waitcnt vmcnt(0)
    s_add_u32 m0, s36, 135168
    s_add_u32 s50, s36, s43
    s_add_u32 s50, s50, 8192
    buffer_load_dwordx4 v2, s[4:7], s50 offen sc1  lds
    s_waitcnt vmcnt(0)
    s_add_u32 m0, s36, 139264
    s_add_u32 s50, s36, s43
    s_add_u32 s50, s50, 12288
    buffer_load_dwordx4 v2, s[4:7], s50 offen sc1  lds
    s_waitcnt vmcnt(0)
    s_add_u32 m0, s36, 143360
    s_add_u32 s50, s36, s43
    s_add_u32 s50, s50, 16384
    buffer_load_dwordx4 v2, s[4:7], s50 offen sc1  lds
    s_waitcnt vmcnt(0)
    s_waitcnt lgkmcnt(0)
    s_barrier
    s_add_u32 m0, s36, 147456
    s_add_u32 s50, s36, s43
    s_add_u32 s50, s50, 20480
    buffer_load_dwordx4 v2, s[4:7], s50 offen sc1  lds
    s_add_u32 m0, s36, 151552
    s_add_u32 s50, s36, s43
    s_add_u32 s50, s50, 24576
    buffer_load_dwordx4 v2, s[4:7], s50 offen sc1  lds
    s_waitcnt vmcnt(1)
    s_add_u32 m0, s36, 155648
    s_add_u32 s50, s36, s43
    s_add_u32 s50, s50, 28672
    buffer_load_dwordx4 v2, s[4:7], s50 offen sc1  lds
    s_waitcnt vmcnt(1)
    s_min_u32 s51, s36, 1024
    s_add_u32 m0, s51, 159744
    s_add_u32 s50, s51, s43
    s_add_u32 s50, s50, 32768
    buffer_load_dwordx4 v2, s[4:7], s50 offen sc1  lds
    s_waitcnt vmcnt(1)
    s_add_u32 m0, s36, 0
    s_add_u32 s50, s36, s43
    s_add_u32 s50, s50, 34816
    buffer_load_dwordx4 v2, s[4:7], s50 offen sc1  lds
    s_waitcnt vmcnt(1)
    s_waitcnt vmcnt(0)
    s_barrier
    s_add_u32 m0, s36, 4096
    s_add_u32 s50, s36, s43
    s_add_u32 s50, s50, 38912
    buffer_load_dwordx4 v2, s[4:7], s50 offen sc1  lds
    s_add_u32 m0, s36, 8192
    s_add_u32 s50, s36, s43
    s_add_u32 s50, s50, 43008
    buffer_load_dwordx4 v2, s[4:7], s50 offen sc1  lds
    s_add_u32 m0, s36, 12288
    s_add_u32 s50, s36, s43
    s_add_u32 s50, s50, 47104
    buffer_load_dwordx4 v2, s[4:7], s50 offen sc1  lds
    s_add_u32 m0, s36, 16384
    s_add_u32 s50, s36, s43
    s_add_u32 s50, s50, 51200
    buffer_load_dwordx4 v2, s[4:7], s50 offen sc1  lds
    s_add_u32 m0, s36, 20480
    s_add_u32 s50, s36, s43
    s_add_u32 s50, s50, 55296
    buffer_load_dwordx4 v2, s[4:7], s50 offen sc1  lds
    s_add_u32 m0, s36, 24576
    s_add_u32 s50, s36, s43
    s_add_u32 s50, s50, 59392
    buffer_load_dwordx4 v2, s[4:7], s50 offen sc1  lds
    s_add_u32 m0, s36, 28672
    s_add_u32 s50, s36, s43
    s_add_u32 s50, s50, 63488
    buffer_load_dwordx4 v2, s[4:7], s50 offen sc1  lds
    s_add_u32 m0, s36, 32768
    s_add_u32 s50, s36, s43
    s_add_u32 s50, s50, 67584
    buffer_load_dwordx4 v2, s[4:7], s50 offen sc1  lds
    s_add_u32 m0, s36, 36864
    s_add_u32 s50, s36, s43
    s_add_u32 s50, s50, 71680
    buffer_load_dwordx4 v2, s[4:7], s50 offen sc1  lds
    s_waitcnt vmcnt(8)
    s_add_u32 m0, s36, 40960
    s_add_u32 s50, s36, s43
    s_add_u32 s50, s50, 75776
    buffer_load_dwordx4 v2, s[4:7], s50 offen sc1  lds
    s_waitcnt vmcnt(8)
    s_waitcnt vmcnt(7)
    s_barrier
    s_add_u32 m0, s36, 45056
    s_add_u32 s50, s36, s43
    s_add_u32 s50, s50, 79872
    buffer_load_dwordx4 v2, s[4:7], s50 offen sc1  lds
    s_add_u32 m0, s36, 49152
    s_add_u32 s50, s36, s43
    s_add_u32 s50, s50, 83968
    buffer_load_dwordx4 v2, s[4:7], s50 offen sc1  lds
    s_waitcnt vmcnt(8)
    s_add_u32 m0, s36, 53248
    s_add_u32 s50, s36, s43
    s_add_u32 s50, s50, 88064
    buffer_load_dwordx4 v2, s[4:7], s50 offen sc1  lds
    s_waitcnt vmcnt(8)
    s_add_u32 m0, s36, 57344
    s_add_u32 s50, s36, s43
    s_add_u32 s50, s50, 92160
    buffer_load_dwordx4 v2, s[4:7], s50 offen sc1  lds
    s_waitcnt vmcnt(8)
    s_add_u32 m0, s36, 61440
    s_add_u32 s50, s36, s43
    s_add_u32 s50, s50, 96256
    buffer_load_dwordx4 v2, s[4:7], s50 offen sc1  lds
    s_waitcnt vmcnt(8)
    s_add_u32 m0, s36, 65536
    s_add_u32 s50, s36, s43
    s_add_u32 s50, s50, 100352
    buffer_load_dwordx4 v2, s[4:7], s50 offen sc1  lds
    s_waitcnt vmcnt(8)
    s_add_u32 m0, s36, 69632
    s_add_u32 s50, s36, s43
    s_add_u32 s50, s50, 104448
    buffer_load_dwordx4 v2, s[4:7], s50 offen sc1  lds
    s_waitcnt vmcnt(8)
    s_add_u32 m0, s36, 73728
    s_add_u32 s50, s36, s43
    s_add_u32 s50, s50, 108544
    buffer_load_dwordx4 v2, s[4:7], s50 offen sc1  lds
    s_waitcnt vmcnt(8)
    s_add_u32 m0, s36, 77824
    s_add_u32 s50, s36, s43
    s_add_u32 s50, s50, 112640
    buffer_load_dwordx4 v2, s[4:7], s50 offen sc1  lds
    s_waitcnt vmcnt(8)
    s_add_u32 m0, s36, 81920
    s_add_u32 s50, s36, s43
    s_add_u32 s50, s50, 116736
    buffer_load_dwordx4 v2, s[4:7], s50 offen sc1  lds
    s_waitcnt vmcnt(8)
    s_add_u32 m0, s36, 86016
    s_add_u32 s50, s36, s43
    s_add_u32 s50, s50, 120832
    buffer_load_dwordx4 v2, s[4:7], s50 offen sc1  lds
    s_waitcnt vmcnt(8)
    s_add_u32 m0, s36, 90112
    s_add_u32 s50, s36, s43
    s_add_u32 s50, s50, 124928
    buffer_load_dwordx4 v2, s[4:7], s50 offen sc1  lds
    s_waitcnt vmcnt(8)
    s_add_u32 m0, s36, 94208
    s_add_u32 s50, s36, s43
    s_add_u32 s50, s50, 129024
    buffer_load_dwordx4 v2, s[4:7], s50 offen sc1  lds
    s_waitcnt vmcnt(8)
    s_add_u32 m0, s36, 98304
    s_add_u32 s50, s36, s43
    s_add_u32 s50, s50, 133120
    buffer_load_dwordx4 v2, s[4:7], s50 offen sc1  lds
    s_waitcnt vmcnt(8)
    s_add_u32 m0, s36, 102400
    s_add_u32 s50, s36, s43
    s_add_u32 s50, s50, 137216
    buffer_load_dwordx4 v2, s[4:7], s50 offen sc1  lds
    s_waitcnt vmcnt(8)
    s_add_u32 m0, s36, 106496
    s_add_u32 s50, s36, s43
    s_add_u32 s50, s50, 141312
    buffer_load_dwordx4 v2, s[4:7], s50 offen sc1  lds
    s_waitcnt vmcnt(8)
    s_add_u32 m0, s36, 110592
    s_add_u32 s50, s36, s43
    s_add_u32 s50, s50, 145408
    buffer_load_dwordx4 v2, s[4:7], s50 offen sc1  lds
    s_waitcnt vmcnt(8)
    s_add_u32 m0, s36, 114688
    s_add_u32 s50, s36, s43
    s_add_u32 s50, s50, 149504
    buffer_load_dwordx4 v2, s[4:7], s50 offen sc1  lds
    s_waitcnt vmcnt(8)
    s_add_u32 m0, s36, 118784
    s_add_u32 s50, s36, s43
    s_add_u32 s50, s50, 153600
    buffer_load_dwordx4 v2, s[4:7], s50 offen sc1  lds
    s_waitcnt vmcnt(8)
    s_min_u32 s51, s36, 1024
    s_add_u32 m0, s51, 122880
    s_add_u32 s50, s51, s43
    s_add_u32 s50, s50, 157696
    buffer_load_dwordx4 v2, s[4:7], s50 offen sc1  lds
    s_waitcnt vmcnt(8)
    s_waitcnt lgkmcnt(0)
    s_barrier
    ds_write_b128 v21, v[172:175] offset:59392
    ds_write_b128 v21, v[176:179] offset:63488
    ds_write_b128 v22, v[180:183] offset:2048
    ds_write_b128 v22, v[184:187] offset:6144
    ds_write_b128 v22, v[188:191] offset:10240
    ds_write_b128 v22, v[192:195] offset:14336
    ds_write_b128 v22, v[196:199] offset:18432
    ds_write_b128 v22, v[200:203] offset:22528
    ds_write_b128 v22, v[204:207] offset:26624
    ds_write_b128 v20, v[208:211] offset:0
    s_waitcnt vmcnt(2)
    s_waitcnt lgkmcnt(0)
    s_barrier
    ds_write_b128 v20, v[212:215] offset:4096
    ds_write_b128 v20, v[216:219] offset:8192
    ds_write_b128 v20, v[220:223] offset:12288
    ds_write_b128 v20, v[224:227] offset:16384
    ds_write_b128 v20, v[228:231] offset:20480
    ds_write_b128 v20, v[232:235] offset:24576
    ds_write_b128 v20, v[236:239] offset:28672
    ds_write_b128 v20, v[240:243] offset:32768
    ds_write_b128 v20, v[244:247] offset:36864
    ds_write_b128 v20, v[248:251] offset:40960
    ds_write_b128 v20, v[252:255] offset:45056
    s_waitcnt vmcnt(0)
    s_waitcnt lgkmcnt(0)
    s_barrier
    s_cmp_eq_u32 s27, 0
    s_cbranch_scc1 L_hcont
    s_endpgm
L_hcont:
    s_setprio 0
    s_barrier
    s_barrier
    s_lshl_b32 s44, s37, 1
    s_add_u32 s44, s44, 71680
    v_add_u32 v7, s44, v2
    ds_write_b128 v7, v[48:51] offset:0
    ds_write_b128 v7, v[52:55] offset:1024
    ds_write_b128 v7, v[56:59] offset:16384
    ds_write_b128 v7, v[60:63] offset:17408
    ds_write_b128 v7, v[64:67] offset:32768
    ds_write_b128 v7, v[68:71] offset:33792
    v_add_u32 v7, 49152, v7
    ds_write_b128 v7, v[72:75] offset:0
    ds_write_b128 v7, v[76:79] offset:1024
    ds_write_b128 v7, v[80:83] offset:16384
    ds_write_b128 v7, v[84:87] offset:17408
L_p1b:
    s_waitcnt lgkmcnt(0)
    s_barrier
    s_add_u32 s27, s27, 1
    s_add_u32 s38, s38, 5505024
    ds_read_b128 v[144:147], v3 offset:6144
    ds_read_b128 v[148:151], v3 offset:7168
    ds_read_b128 v[152:155], v3 offset:8192
    ds_read_b128 v[156:159], v3 offset:9216
    s_lshl_b32 s44, s35, 7
    s_add_u32 s98, s44, 8192
    s_mov_b32 s97, 4
    s_mul_i32 s60, s35, 40960
    s_add_u32 s60, s60, 458752
Lpoll_92:
    buffer_load_dword v168, v47, s[4:7], s98 offen sc1
    s_waitcnt vmcnt(0)
    v_cmp_gt_u32 vcc, 3, v168
    s_cbranch_vccz Lpolld_93
    s_sub_u32 s29, s29, 1
    s_cbranch_scc0 Lpoll_92
    s_mov_b32 s29, 0
Lpolld_93:
    buffer_load_dwordx4 v[88:91], v2, s[4:7], s60 offen offset:0 sc1
    buffer_load_dwordx4 v[92:95], v2, s[4:7], s60 offen offset:1024 sc1
    buffer_load_dwordx4 v[96:99], v2, s[4:7], s60 offen offset:2048 sc1
    buffer_load_dwordx4 v[100:103], v2, s[4:7], s60 offen offset:3072 sc1
    s_add_u32 s60, s60, 4096
    buffer_load_dwordx4 v[104:107], v2, s[4:7], s60 offen offset:0 sc1
    s_waitcnt vmcnt(4) lgkmcnt(2)
    v_mfma_f32_32x32x16_bf16 v[224:239], v[144:147], v[88:91], 0
    ds_read_b128 v[160:163], v3 offset:10240
    buffer_load_dwordx4 v[108:111], v2, s[4:7], s60 offen offset:1024 sc1
    v_mfma_f32_32x32x16_bf16 v[240:255], v[148:151], v[88:91], 0
    ds_read_b128 v[164:167], v3 offset:11264
    s_waitcnt vmcnt(4) lgkmcnt(2)
    v_mfma_f32_32x32x16_bf16 v[224:239], v[152:155], v[92:95], v[224:239]
    ds_read_b128 v[144:147], v3 offset:12288
    buffer_load_dwordx4 v[88:91], v2, s[4:7], s60 offen offset:2048 sc1
    v_mfma_f32_32x32x16_bf16 v[240:255], v[156:159], v[92:95], v[240:255]
    ds_read_b128 v[148:151], v3 offset:13312
    s_waitcnt vmcnt(4) lgkmcnt(2)
    v_mfma_f32_32x32x16_bf16 v[224:239], v[160:163], v[96:99], v[224:239]
    ds_read_b128 v[152:155], v3 offset:14336
    buffer_load_dwordx4 v[92:95], v2, s[4:7], s60 offen offset:3072 sc1
    v_mfma_f32_32x32x16_bf16 v[240:255], v[164:167], v[96:99], v[240:255]
    ds_read_b128 v[156:159], v3 offset:15360
    s_waitcnt vmcnt(4) lgkmcnt(2)
    v_mfma_f32_32x32x16_bf16 v[224:239], v[144:147], v[100:103], v[224:239]
    ds_read_b128 v[160:163], v3 offset:16384
    s_add_u32 s60, s60, 4096
    buffer_load_dwordx4 v[96:99], v2, s[4:7], s60 offen offset:0 sc1
    v_mfma_f32_32x32x16_bf16 v[240:255], v[148:151], v[100:103], v[240:255]
    ds_read_b128 v[164:167], v3 offset:17408
    s_waitcnt vmcnt(4) lgkmcnt(2)
    v_mfma_f32_32x32x16_bf16 v[224:239], v[152:155], v[104:107], v[224:239]
    ds_read_b128 v[144:147], v3 offset:18432
    buffer_load_dwordx4 v[100:103], v2, s[4:7], s60 offen offset:1024 sc1
    v_mfma_f32_32x32x16_bf16 v[240:255], v[156:159], v[104:107], v[240:255]
    ds_read_b128 v[148:151], v3 offset:19456
    buffer_load_dword v176, v47, s[4:7], s98 offen sc1
    s_waitcnt vmcnt(5) lgkmcnt(2)
    v_mfma_f32_32x32x16_bf16 v[224:239], v[160:163], v[108:111], v[224:239]
    ds_read_b128 v[152:155], v3 offset:20480
    buffer_load_dwordx4 v[104:107], v2, s[4:7], s60 offen offset:2048 sc1
    v_mfma_f32_32x32x16_bf16 v[240:255], v[164:167], v[108:111], v[240:255]
    ds_read_b128 v[156:159], v3 offset:21504
    s_waitcnt vmcnt(5) lgkmcnt(2)
    v_mfma_f32_32x32x16_bf16 v[224:239], v[144:147], v[88:91], v[224:239]
    ds_read_b128 v[160:163], v3 offset:22528
    buffer_load_dwordx4 v[108:111], v2, s[4:7], s60 offen offset:3072 sc1
    v_mfma_f32_32x32x16_bf16 v[240:255], v[148:151], v[88:91], v[240:255]
    ds_read_b128 v[164:167], v3 offset:23552
    s_waitcnt vmcnt(5) lgkmcnt(2)
    v_mfma_f32_32x32x16_bf16 v[224:239], v[152:155], v[92:95], v[224:239]
    ds_read_b128 v[144:147], v3 offset:24576
    s_add_u32 s60, s60, 4096
    buffer_load_dwordx4 v[88:91], v2, s[4:7], s60 offen offset:0 sc1
    v_mfma_f32_32x32x16_bf16 v[240:255], v[156:159], v[92:95], v[240:255]
    ds_read_b128 v[148:151], v3 offset:25600
    s_waitcnt vmcnt(5) lgkmcnt(2)
    v_mfma_f32_32x32x16_bf16 v[224:239], v[160:163], v[96:99], v[224:239]
    ds_read_b128 v[152:155], v3 offset:26624
    buffer_load_dwordx4 v[92:95], v2, s[4:7], s60 offen offset:1024 sc1
    v_mfma_f32_32x32x16_bf16 v[240:255], v[164:167], v[96:99], v[240:255]
    ds_read_b128 v[156:159], v3 offset:27648
    s_waitcnt vmcnt(5) lgkmcnt(2)
    s_waitcnt vmcnt(4)
    v_cmp_gt_u32 vcc, s97, v176
    s_cbranch_vccnz Lpc_94
Lpcd_95:
    v_mfma_f32_32x32x16_bf16 v[224:239], v[144:147], v[100:103], v[224:239]
    ds_read_b128 v[160:163], v3 offset:28672
    buffer_load_dwordx4 v[96:99], v2, s[4:7], s60 offen offset:2048 sc1
    v_mfma_f32_32x32x16_bf16 v[240:255], v[148:151], v[100:103], v[240:255]
    ds_read_b128 v[164:167], v3 offset:29696
    s_lshl_b32 s49, s35, 11
    s_add_u32 s49, s49, 196608
    buffer_load_dwordx4 v[168:171], v2, s[4:7], s49 offen sc1
    buffer_load_dwordx4 v[172:175], v2, s[4:7], s49 offen offset:1024 sc1
    s_waitcnt vmcnt(6) lgkmcnt(2)
    v_mfma_f32_32x32x16_bf16 v[224:239], v[152:155], v[104:107], v[224:239]
    ds_read_b128 v[144:147], v3 offset:30720
    buffer_load_dwordx4 v[100:103], v2, s[4:7], s60 offen offset:3072 sc1
    v_mfma_f32_32x32x16_bf16 v[240:255], v[156:159], v[104:107], v[240:255]
    ds_read_b128 v[148:151], v3 offset:31744
    s_waitcnt vmcnt(6) lgkmcnt(2)
    v_mfma_f32_32x32x16_bf16 v[224:239], v[160:163], v[108:111], v[224:239]
    ds_read_b128 v[152:155], v3 offset:32768
    s_add_u32 s60, s60, 4096
    buffer_load_dwordx4 v[104:107], v2, s[4:7], s60 offen offset:0 sc1
    v_mfma_f32_32x32x16_bf16 v[240:255], v[164:167], v[108:111], v[240:255]
    ds_read_b128 v[156:159], v3 offset:33792
    s_waitcnt vmcnt(6) lgkmcnt(2)
    v_mfma_f32_32x32x16_bf16 v[224:239], v[144:147], v[88:91], v[224:239]
    ds_read_b128 v[160:163], v3 offset:34816
    buffer_load_dwordx4 v[108:111], v2, s[4:7], s60 offen offset:1024 sc1
    v_mfma_f32_32x32x16_bf16 v[240:255], v[148:151], v[88:91], v[240:255]
    ds_read_b128 v[164:167], v3 offset:35840
    s_waitcnt vmcnt(6) lgkmcnt(2)
    v_mfma_f32_32x32x16_bf16 v[224:239], v[152:155], v[92:95], v[224:239]
    ds_read_b128 v[144:147], v3 offset:36864
    buffer_load_dwordx4 v[88:91], v2, s[4:7], s60 offen offset:2048 sc1
    v_mfma_f32_32x32x16_bf16 v[240:255], v[156:159], v[92:95], v[240:255]
    ds_read_b128 v[148:151], v3 offset:37888
    s_waitcnt vmcnt(6) lgkmcnt(2)
    v_mfma_f32_32x32x16_bf16 v[224:239], v[160:163], v[96:99], v[224:239]
    ds_read_b128 v[152:155], v3 offset:38912
    buffer_load_dwordx4 v[92:95], v2, s[4:7], s60 offen offset:3072 sc1
    v_mfma_f32_32x32x16_bf16 v[240:255], v[164:167], v[96:99], v[240:255]
    ds_read_b128 v[156:159], v3 offset:39936
    s_waitcnt vmcnt(4) lgkmcnt(2)
    v_mfma_f32_32x32x16_bf16 v[224:239], v[144:147], v[100:103], v[224:239]
    ds_read_b128 v[160:163], v3 offset:40960
    s_add_u32 s60, s60, 4096
    buffer_load_dwordx4 v[96:99], v2, s[4:7], s60 offen offset:0 sc1
    v_mfma_f32_32x32x16_bf16 v[240:255], v[148:151], v[100:103], v[240:255]
    ds_read_b128 v[164:167], v3 offset:41984
    s_waitcnt vmcnt(4) lgkmcnt(2)
    v_mfma_f32_32x32x16_bf16 v[224:239], v[152:155], v[104:107], v[224:239]
    ds_read_b128 v[144:147], v3 offset:43008
    buffer_load_dwordx4 v[100:103], v2, s[4:7], s60 offen offset:1024 sc1
    v_mfma_f32_32x32x16_bf16 v[240:255], v[156:159], v[104:107], v[240:255]
    ds_read_b128 v[148:151], v3 offset:44032
    s_waitcnt vmcnt(4) lgkmcnt(2)
    v_mfma_f32_32x32x16_bf16 v[224:239], v[160:163], v[108:111], v[224:239]
    ds_read_b128 v[152:155], v3 offset:45056
    buffer_load_dwordx4 v[104:107], v2, s[4:7], s60 offen offset:2048 sc1
    v_mfma_f32_32x32x16_bf16 v[240:255], v[164:167], v[108:111], v[240:255]
    ds_read_b128 v[156:159], v3 offset:46080
    s_waitcnt vmcnt(4) lgkmcnt(2)
    v_mfma_f32_32x32x16_bf16 v[224:239], v[144:147], v[88:91], v[224:239]
    ds_read_b128 v[160:163], v3 offset:47104
    buffer_load_dwordx4 v[108:111], v2, s[4:7], s60 offen offset:3072 sc1
    v_mfma_f32_32x32x16_bf16 v[240:255], v[148:151], v[88:91], v[240:255]
    ds_read_b128 v[164:167], v3 offset:48128
    v_add_f32 v134, v168, v170
    v_add_f32 v135, v169, v171
    v_add_f32 v172, v172, v174
    v_add_f32 v173, v173, v175
    v_add_f32 v134, v134, v172
    v_add_f32 v135, v135, v173
    v_mov_b32 v168, v134
    v_mov_b32 v169, v135
    s_nop 1
    v_permlane32_swap_b32 v134, v168
    v_permlane32_swap_b32 v135, v169
    v_add_f32 v134, v134, v168
    v_add_f32 v135, v135, v169
    v_mul_f32 v134, 0x3acccccd, v134
    v_mul_f32 v135, 0x3acccccd, v135
    v_fma_f32 v135, -v134, v134, v135
    v_max_f32 v135, 0, v135
    v_add_f32 v135, 0x3727c5ac, v135
    v_rsq_f32 v132, v135
    s_nop 0
    v_mul_f32 v133, -1.0, v132
    v_mul_f32 v133, v134, v133
    s_waitcnt vmcnt(4) lgkmcnt(2)
    v_mfma_f32_32x32x16_bf16 v[224:239], v[152:155], v[92:95], v[224:239]
    ds_read_b128 v[144:147], v3 offset:49152
    s_add_u32 s60, s60, 4096
    buffer_load_dwordx4 v[88:91], v2, s[4:7], s60 offen offset:0 sc1
    v_mfma_f32_32x32x16_bf16 v[240:255], v[156:159], v[92:95], v[240:255]
    ds_read_b128 v[148:151], v3 offset:50176
    s_waitcnt vmcnt(4) lgkmcnt(2)
    v_mfma_f32_32x32x16_bf16 v[224:239], v[160:163], v[96:99], v[224:239]
    ds_read_b128 v[152:155], v3 offset:51200
    buffer_load_dwordx4 v[92:95], v2, s[4:7], s60 offen offset:1024 sc1
    v_lshlrev_b32 v7, 4, v5
    v_add_u32 v7, 161792, v7
    v_mfma_f32_32x32x16_bf16 v[240:255], v[164:167], v[96:99], v[240:255]
    ds_read_b128 v[156:159], v3 offset:52224
    ds_read_b128 v[192:195], v7 offset:0
    ds_read_b128 v[196:199], v7 offset:32
    s_waitcnt vmcnt(4) lgkmcnt(4)
    v_mfma_f32_32x32x16_bf16 v[224:239], v[144:147], v[100:103], v[224:239]
    ds_read_b128 v[160:163], v3 offset:53248
    buffer_load_dwordx4 v[96:99], v2, s[4:7], s60 offen offset:2048 sc1
    ds_read_b128 v[200:203], v7 offset:64
    ds_read_b128 v[204:207], v7 offset:96
    v_mfma_f32_32x32x16_bf16 v[240:255], v[148:151], v[100:103], v[240:255]
    ds_read_b128 v[164:167], v3 offset:54272
    ds_read_b128 v[208:211], v7 offset:128
    ds_read_b128 v[212:215], v7 offset:160
    s_waitcnt vmcnt(4) lgkmcnt(8)
    v_mfma_f32_32x32x16_bf16 v[224:239], v[152:155], v[104:107], v[224:239]
    ds_read_b128 v[144:147], v3 offset:55296
    buffer_load_dwordx4 v[100:103], v2, s[4:7], s60 offen offset:3072 sc1
    ds_read_b128 v[216:219], v7 offset:192
    ds_read_b128 v[220:223], v7 offset:224
    v_mfma_f32_32x32x16_bf16 v[240:255], v[156:159], v[104:107], v[240:255]
    ds_read_b128 v[148:151], v3 offset:56320
    v_mul_f32 v134, 0x3ea52b5c, v132
    v_mul_f32 v135, 0x3ea52b5c, v133
    s_waitcnt vmcnt(4) lgkmcnt(6)
    v_mfma_f32_32x32x16_bf16 v[224:239], v[160:163], v[108:111], v[224:239]
    ds_read_b128 v[152:155], v3 offset:57344
    s_add_u32 s60, s60, 4096
    buffer_load_dwordx4 v[104:107], v2, s[4:7], s60 offen offset:0 sc1
    s_mul_i32 s46, s35, 2688
    s_add_u32 s46, s46, s38
    v_mfma_f32_32x32x16_bf16 v[240:255], v[164:167], v[108:111], v[240:255]
    ds_read_b128 v[156:159], v3 offset:58368
    s_lshl_b32 s47, s24, 9
    s_add_u32 s47, s47, s91
    s_waitcnt vmcnt(4) lgkmcnt(2)
    v_mfma_f32_32x32x16_bf16 v[224:239], v[144:147], v[88:91], v[224:239]
    ds_read_b128 v[160:163], v3 offset:59392
    buffer_load_dwordx4 v[108:111], v2, s[4:7], s60 offen offset:1024 sc1
    s_and_b32 s44, s26, 4
    s_add_u32 s47, s47, s44
    v_mfma_f32_32x32x16_bf16 v[240:255], v[148:151], v[88:91], v[240:255]
    ds_read_b128 v[164:167], v3 offset:60416
    s_add_u32 s45, s27, 1
    v_mov_b32 v126, 0
    s_waitcnt vmcnt(4) lgkmcnt(2)
    v_mfma_f32_32x32x16_bf16 v[224:239], v[152:155], v[92:95], v[224:239]
    ds_read_b128 v[144:147], v3 offset:61440
    buffer_load_dwordx4 v[88:91], v2, s[4:7], s60 offen offset:2048 sc1
    v_mov_b32 v127, s45
    s_mul_i32 s44, s36, 5
    v_mfma_f32_32x32x16_bf16 v[240:255], v[156:159], v[92:95], v[240:255]
    ds_read_b128 v[148:151], v3 offset:62464
    s_lshr_b32 s44, s44, 2
    s_add_u32 s44, s44, 65536
    s_waitcnt vmcnt(4) lgkmcnt(2)
    v_mfma_f32_32x32x16_bf16 v[224:239], v[160:163], v[96:99], v[224:239]
    ds_read_b128 v[152:155], v3 offset:63488
    buffer_load_dwordx4 v[92:95], v2, s[4:7], s60 offen offset:3072 sc1
    v_add_u32 v128, s44, v2
    v_lshl_add_u32 v129, v46, 1, s44
    v_mfma_f32_32x32x16_bf16 v[240:255], v[164:167], v[96:99], v[240:255]
    ds_read_b128 v[156:159], v3 offset:64512
    v_add_u32 v7, s90, v2
    s_waitcnt vmcnt(4) lgkmcnt(2)
    v_mfma_f32_32x32x16_bf16 v[224:239], v[144:147], v[100:103], v[224:239]
    ds_read_b128 v[160:163], v4 offset:0
    s_add_u32 s60, s60, 4096
    buffer_load_dwordx4 v[96:99], v2, s[4:7], s60 offen offset:0 sc1
    v_mul_f32 v192, v133, v192
    v_mul_f32 v193, v133, v193
    v_mfma_f32_32x32x16_bf16 v[240:255], v[148:151], v[100:103], v[240:255]
    ds_read_b128 v[164:167], v4 offset:1024
    v_mul_f32 v194, v133, v194
    v_mul_f32 v195, v133, v195
    s_waitcnt vmcnt(4) lgkmcnt(2)
    v_mfma_f32_32x32x16_bf16 v[224:239], v[152:155], v[104:107], v[224:239]
    ds_read_b128 v[144:147], v4 offset:2048
    buffer_load_dwordx4 v[100:103], v2, s[4:7], s60 offen offset:1024 sc1
    v_mul_f32 v196, v133, v196
    v_mul_f32 v197, v133, v197
    v_mfma_f32_32x32x16_bf16 v[240:255], v[156:159], v[104:107], v[240:255]
    ds_read_b128 v[148:151], v4 offset:3072
    v_mul_f32 v198, v133, v198
    v_mul_f32 v199, v133, v199
    s_waitcnt vmcnt(4) lgkmcnt(2)
    v_mfma_f32_32x32x16_bf16 v[224:239], v[160:163], v[108:111], v[224:239]
    ds_read_b128 v[152:155], v4 offset:4096
    buffer_load_dwordx4 v[104:107], v2, s[4:7], s60 offen offset:2048 sc1
    v_mul_f32 v200, v133, v200
    v_mul_f32 v201, v133, v201
    v_mfma_f32_32x32x16_bf16 v[240:255], v[164:167], v[108:111], v[240:255]
    ds_read_b128 v[156:159], v4 offset:5120
    v_mul_f32 v202, v133, v202
    v_mul_f32 v203, v133, v203
    s_waitcnt vmcnt(4) lgkmcnt(2)
    v_mfma_f32_32x32x16_bf16 v[224:239], v[144:147], v[88:91], v[224:239]
    ds_read_b128 v[160:163], v4 offset:6144
    buffer_load_dwordx4 v[108:111], v2, s[4:7], s60 offen offset:3072 sc1
    v_mul_f32 v204, v133, v204
    v_mul_f32 v205, v133, v205
    v_mfma_f32_32x32x16_bf16 v[240:255], v[148:151], v[88:91], v[240:255]
    ds_read_b128 v[164:167], v4 offset:7168
    v_mul_f32 v206, v133, v206
    v_mul_f32 v207, v133, v207
    s_waitcnt vmcnt(4) lgkmcnt(2)
    v_mfma_f32_32x32x16_bf16 v[224:239], v[152:155], v[92:95], v[224:239]
    ds_read_b128 v[144:147], v4 offset:8192
    s_add_u32 s60, s60, 4096
    buffer_load_dwordx4 v[88:91], v2, s[4:7], s60 offen offset:0 sc1
    v_mul_f32 v208, v133, v208
    v_mul_f32 v209, v133, v209
    v_mfma_f32_32x32x16_bf16 v[240:255], v[156:159], v[92:95], v[240:255]
    ds_read_b128 v[148:151], v4 offset:9216
    v_mul_f32 v210, v133, v210
    v_mul_f32 v211, v133, v211
    s_waitcnt vmcnt(4) lgkmcnt(2)
    v_mfma_f32_32x32x16_bf16 v[224:239], v[160:163], v[96:99], v[224:239]
    ds_read_b128 v[152:155], v4 offset:10240
    buffer_load_dwordx4 v[92:95], v2, s[4:7], s60 offen offset:1024 sc1
    v_mul_f32 v212, v135, v212
    v_mul_f32 v213, v135, v213
    v_mfma_f32_32x32x16_bf16 v[240:255], v[164:167], v[96:99], v[240:255]
    ds_read_b128 v[156:159], v4 offset:11264
    v_mul_f32 v214, v135, v214
    v_mul_f32 v215, v135, v215
    s_waitcnt vmcnt(4) lgkmcnt(2)
    v_mfma_f32_32x32x16_bf16 v[224:239], v[144:147], v[100:103], v[224:239]
    ds_read_b128 v[160:163], v4 offset:12288
    buffer_load_dwordx4 v[96:99], v2, s[4:7], s60 offen offset:2048 sc1
    v_mul_f32 v216, v135, v216
    v_mul_f32 v217, v135, v217
    v_mfma_f32_32x32x16_bf16 v[240:255], v[148:151], v[100:103], v[240:255]
    ds_read_b128 v[164:167], v4 offset:13312
    v_mul_f32 v218, v135, v218
    v_mul_f32 v219, v135, v219
    s_waitcnt vmcnt(4) lgkmcnt(2)
    v_mfma_f32_32x32x16_bf16 v[224:239], v[152:155], v[104:107], v[224:239]
    ds_read_b128 v[144:147], v4 offset:14336
    buffer_load_dwordx4 v[100:103], v2, s[4:7], s60 offen offset:3072 sc1
    v_mul_f32 v220, v135, v220
    v_mul_f32 v221, v135, v221
    v_mfma_f32_32x32x16_bf16 v[240:255], v[156:159], v[104:107], v[240:255]
    ds_read_b128 v[148:151], v4 offset:15360
    v_mul_f32 v222, v135, v222
    v_mul_f32 v223, v135, v223
    s_waitcnt vmcnt(4) lgkmcnt(2)
    v_mfma_f32_32x32x16_bf16 v[224:239], v[160:163], v[108:111], v[224:239]
    ds_read_b128 v[152:155], v4 offset:16384
    v_mfma_f32_32x32x16_bf16 v[240:255], v[164:167], v[108:111], v[240:255]
    ds_read_b128 v[156:159], v4 offset:17408
    s_waitcnt vmcnt(3) lgkmcnt(2)
    v_mfma_f32_32x32x16_bf16 v[224:239], v[144:147], v[88:91], v[224:239]
    ds_read_b128 v[160:163], v4 offset:18432
    v_mfma_f32_32x32x16_bf16 v[240:255], v[148:151], v[88:91], v[240:255]
    ds_read_b128 v[164:167], v4 offset:19456
    s_waitcnt vmcnt(2) lgkmcnt(2)
    v_mfma_f32_32x32x16_bf16 v[224:239], v[152:155], v[92:95], v[224:239]
    ds_read_b128 v[144:147], v4 offset:20480
    v_mfma_f32_32x32x16_bf16 v[240:255], v[156:159], v[92:95], v[240:255]
    ds_read_b128 v[148:151], v4 offset:21504
    s_waitcnt vmcnt(1) lgkmcnt(2)
    v_mfma_f32_32x32x16_bf16 v[224:239], v[160:163], v[96:99], v[224:239]
    v_mfma_f32_32x32x16_bf16 v[240:255], v[164:167], v[96:99], v[240:255]
    s_waitcnt vmcnt(0) lgkmcnt(0)
    v_mfma_f32_32x32x16_bf16 v[224:239], v[144:147], v[100:103], v[224:239]
    v_mfma_f32_32x32x16_bf16 v[240:255], v[148:151], v[100:103], v[240:255]
    s_cmp_lt_u32 s26, 4
    s_cbranch_scc1 Lep_98
    s_bitcmp1_b32 s30, 0
    s_mov_b32 s99, 0x76543210
    s_cmov_b32 s99, 0x76543210
    v_and_b32 v8, 28, v46
    v_bfe_u32 v8, s99, v8, 3
    v_xor_b32 v8, s24, v8
    v_lshlrev_b32 v8, 9, v8
    v_lshl_add_u32 v8, v5, 2, v8
    v_mov_b32 v9, 0
Lep_98:
    s_nop 7
    s_branch L_epi1
L_slow:
    s_waitcnt vmcnt(0) lgkmcnt(0)
    s_mov_b64 s[100:101], 0
    v_mov_b32 v128, 0xff800000
    v_mov_b32 v129, 0xff800000
    v_lshlrev_b32 v130, 1, v46
    s_mov_b32 s44, s38
    s_mov_b32 s45, 64
L_slow0:
    buffer_load_dwordx4 v[144:147], v2, s[4:7], s44 offen sc1
    buffer_load_dwordx2 v[142:143], v130, s[4:7], s44 offen offset:2368 sc1
    s_waitcnt vmcnt(0)
    v_mfma_f32_32x32x16_bf16 v[160:175], v[144:147], v[136:139], 0
    v_mfma_f32_32x32x16_bf16 v[176:191], v[144:147], v[120:123], 0
    s_nop 9
    v_mfma_f32_32x32x4_2b_bf16 v[160:191], v[142:143], v[140:141], v[160:191] cbsz:1 abid:0
    s_nop 15
    s_nop 3
    v_max3_f32 v128, v160, v161, v128
    v_max3_f32 v128, v162, v163, v128
    v_max3_f32 v128, v164, v165, v128
    v_max3_f32 v128, v166, v167, v128
    v_max3_f32 v128, v168, v169, v128
    v_max3_f32 v128, v170, v171, v128
    v_max3_f32 v128, v172, v173, v128
    v_max3_f32 v128, v174, v175, v128
    v_max3_f32 v129, v176, v177, v129
    v_max3_f32 v129, v178, v179, v129
    v_max3_f32 v129, v180, v181, v129
    v_max3_f32 v129, v182, v183, v129
    v_max3_f32 v129, v184, v185, v129
    v_max3_f32 v129, v186, v187, v129
    v_max3_f32 v129, v188, v189, v129
    v_max3_f32 v129, v190, v191, v129
    s_add_u32 s44, s44, 2688
    s_sub_u32 s45, s45, 1
    s_cmp_lg_u32 s45, 0
    s_cbranch_scc1 L_slow0
    v_mov_b32 v131, v128
    s_nop 1
    v_permlane32_swap_b32 v128, v131
    v_max_f32 v128, v128, v131
    v_mov_b32 v131, v129
    s_nop 1
    v_permlane32_swap_b32 v129, v131
    v_max_f32 v129, v129, v131
    s_mov_b32 s44, s38
    s_mov_b32 s45, 64
    v_mov_b32 v88, 0
    v_mov_b32 v89, 0
    v_mov_b32 v90, 0
    v_mov_b32 v91, 0
    v_mov_b32 v92, 0
    v_mov_b32 v93, 0
    v_mov_b32 v94, 0
    v_mov_b32 v95, 0
    v_mov_b32 v96, 0
    v_mov_b32 v97, 0
    v_mov_b32 v98, 0
    v_mov_b32 v99, 0
    v_mov_b32 v100, 0
    v_mov_b32 v101, 0
    v_mov_b32 v102, 0
    v_mov_b32 v103, 0
    v_mov_b32 v104, 0
    v_mov_b32 v105, 0
    v_mov_b32 v106, 0
    v_mov_b32 v107, 0
    v_mov_b32 v108, 0
    v_mov_b32 v109, 0
    v_mov_b32 v110, 0
    v_mov_b32 v111, 0
    v_mov_b32 v112, 0
    v_mov_b32 v113, 0
    v_mov_b32 v114, 0
    v_mov_b32 v115, 0
    v_mov_b32 v116, 0
    v_mov_b32 v117, 0
    v_mov_b32 v118, 0
    v_mov_b32 v119, 0
L_slow1:
    buffer_load_dwordx4 v[144:147], v2, s[4:7], s44 offen sc1
    buffer_load_dwordx2 v[142:143], v130, s[4:7], s44 offen offset:2368 sc1
    buffer_load_dwordx4 v[224:227], v40, s[4:7], s44 offen offset:1024 sc1
    buffer_load_dwordx4 v[232:235], v40, s[4:7], s44 offen offset:1696 sc1
    s_waitcnt vmcnt(0)
    v_mfma_f32_32x32x16_bf16 v[160:175], v[144:147], v[136:139], 0
    v_mfma_f32_32x32x16_bf16 v[176:191], v[144:147], v[120:123], 0
    s_nop 9
    v_mfma_f32_32x32x4_2b_bf16 v[160:191], v[142:143], v[140:141], v[160:191] cbsz:1 abid:0
    s_nop 15
    s_nop 3
    v_sub_f32 v160, v160, v128
    v_sub_f32 v161, v161, v128
    v_sub_f32 v162, v162, v128
    v_sub_f32 v163, v163, v128
    v_sub_f32 v164, v164, v128
    v_sub_f32 v165, v165, v128
    v_sub_f32 v166, v166, v128
    v_sub_f32 v167, v167, v128
    v_sub_f32 v168, v168, v128
    v_sub_f32 v169, v169, v128
    v_sub_f32 v170, v170, v128
    v_sub_f32 v171, v171, v128
    v_sub_f32 v172, v172, v128
    v_sub_f32 v173, v173, v128
    v_sub_f32 v174, v174, v128
    v_sub_f32 v175, v175, v128
    v_sub_f32 v176, v176, v129
    v_sub_f32 v177, v177, v129
    v_sub_f32 v178, v178, v129
    v_sub_f32 v179, v179, v129
    v_sub_f32 v180, v180, v129
    v_sub_f32 v181, v181, v129
    v_sub_f32 v182, v182, v129
    v_sub_f32 v183, v183, v129
    v_sub_f32 v184, v184, v129
    v_sub_f32 v185, v185, v129
    v_sub_f32 v186, v186, v129
    v_sub_f32 v187, v187, v129
    v_sub_f32 v188, v188, v129
    v_sub_f32 v189, v189, v129
    v_sub_f32 v190, v190, v129
    v_sub_f32 v191, v191, v129
    v_exp_f32 v160, v160
    v_exp_f32 v161, v161
    v_exp_f32 v162, v162
    v_exp_f32 v163, v163
    v_exp_f32 v164, v164
    v_exp_f32 v165, v165
    v_exp_f32 v166, v166
    v_exp_f32 v167, v167
    v_exp_f32 v168, v168
    v_exp_f32 v169, v169
    v_exp_f32 v170, v170
    v_exp_f32 v171, v171
    v_exp_f32 v172, v172
    v_exp_f32 v173, v173
    v_exp_f32 v174, v174
    v_exp_f32 v175, v175
    v_exp_f32 v176, v176
    v_exp_f32 v177, v177
    v_exp_f32 v178, v178
    v_exp_f32 v179, v179
    v_exp_f32 v180, v180
    v_exp_f32 v181, v181
    v_exp_f32 v182, v182
    v_exp_f32 v183, v183
    v_exp_f32 v184, v184
    v_exp_f32 v185, v185
    v_exp_f32 v186, v186
    v_exp_f32 v187, v187
    v_exp_f32 v188, v188
    v_exp_f32 v189, v189
    v_exp_f32 v190, v190
    v_exp_f32 v191, v191
    s_nop 1
    v_smfmac_f32_32x32x32_bf16 v[88:103], v[224:227], v[160:167], v35
    v_smfmac_f32_32x32x32_bf16 v[88:103], v[232:235], v[168:175], v35
    v_smfmac_f32_32x32x32_bf16 v[104:119], v[224:227], v[176:183], v35
    v_smfmac_f32_32x32x32_bf16 v[104:119], v[232:235], v[184:191], v35
    s_nop 7
    s_add_u32 s44, s44, 2688
    s_sub_u32 s45, s45, 1
    s_cmp_lg_u32 s45, 0
    s_cbranch_scc1 L_slow1
    s_nop 7
    s_branch L_att_fin
L_ri:
    s_mov_b32 s23, 0x20000
    s_cmp_lt_u32 s40, 384
    s_cbranch_scc1 L_ri_w2
    s_cmp_lt_u32 s40, 704
    s_cbranch_scc1 L_ri_w1
    s_mov_b32 s20, s68
    s_mov_b32 s21, s69
    s_mov_b32 s22, 819200
    s_sub_u32 s49, s40, 704
    s_mul_i32 s94, s49, 5120
    s_add_u32 s94, s94, 9371648
    s_mul_i32 s48, s49, 3277
    s_lshr_b32 s48, s48, 16
    s_mul_i32 s44, s48, 20
    s_sub_u32 s49, s49, s44
    s_mul_i32 s44, s49, 40
    s_mul_i32 s50, s49, 160
    s_sub_u32 s50, s50, 2544
    s_mov_b32 s45, 20
    s_cmp_lt_u32 s49, 16
    s_cselect_b32 s44, s44, s50
    s_cselect_b32 s46, 4, 2
    s_cselect_b32 s47, 15, 3
    s_branch L_ri_a
L_ri_w2:
    s_mov_b32 s20, s76
    s_mov_b32 s21, s77
    s_mov_b32 s22, 1966080
    s_mul_i32 s94, s40, 5120
    s_add_u32 s94, s94, 12156928
    s_mul_i32 s48, s40, 1366
    s_lshr_b32 s48, s48, 16
    s_mul_i32 s44, s48, 48
    s_sub_u32 s44, s40, s44
    s_and_b32 s45, s44, 15
    s_mul_i32 s45, s45, 3
    s_lshr_b32 s44, s44, 4
    s_add_u32 s44, s44, s45
    s_lshl_b32 s44, s44, 5
    s_mov_b32 s45, 0
    s_mov_b32 s46, 5
    s_mov_b32 s47, 31
L_ri_a:
    s_mul_i32 s44, s44, 1280
    s_mul_i32 s48, s48, 160
    s_add_u32 s44, s44, s48
    v_add_u32 v112, 0, v1
    v_mul_u32_u24 v113, 6554, v112
    v_lshrrev_b32 v113, 16, v113
    v_mul_u32_u24 v114, 10, v113
    v_sub_u32 v112, v112, v114
    v_lshrrev_b32 v114, s46, v113
    v_and_b32 v113, s47, v113
    v_mad_u32_u24 v113, v114, s45, v113
    v_mul_u32_u24 v113, 1280, v113
    v_lshl_add_u32 v112, v112, 4, v113
    buffer_load_dwordx4 v[88:91], v112, s[20:23], s44 offen
    v_add_u32 v112, 64, v1
    v_mul_u32_u24 v113, 6554, v112
    v_lshrrev_b32 v113, 16, v113
    v_mul_u32_u24 v114, 10, v113
    v_sub_u32 v112, v112, v114
    v_lshrrev_b32 v114, s46, v113
    v_and_b32 v113, s47, v113
    v_mad_u32_u24 v113, v114, s45, v113
    v_mul_u32_u24 v113, 1280, v113
    v_lshl_add_u32 v112, v112, 4, v113
    buffer_load_dwordx4 v[92:95], v112, s[20:23], s44 offen
    v_add_u32 v112, 128, v1
    v_mul_u32_u24 v113, 6554, v112
    v_lshrrev_b32 v113, 16, v113
    v_mul_u32_u24 v114, 10, v113
    v_sub_u32 v112, v112, v114
    v_lshrrev_b32 v114, s46, v113
    v_and_b32 v113, s47, v113
    v_mad_u32_u24 v113, v114, s45, v113
    v_mul_u32_u24 v113, 1280, v113
    v_lshl_add_u32 v112, v112, 4, v113
    buffer_load_dwordx4 v[96:99], v112, s[20:23], s44 offen
    v_add_u32 v112, 192, v1
    v_mul_u32_u24 v113, 6554, v112
    v_lshrrev_b32 v113, 16, v113
    v_mul_u32_u24 v114, 10, v113
    v_sub_u32 v112, v112, v114
    v_lshrrev_b32 v114, s46, v113
    v_and_b32 v113, s47, v113
    v_mad_u32_u24 v113, v114, s45, v113
    v_mul_u32_u24 v113, 1280, v113
    v_lshl_add_u32 v112, v112, 4, v113
    buffer_load_dwordx4 v[100:103], v112, s[20:23], s44 offen
    v_add_u32 v112, 256, v1
    v_mul_u32_u24 v113, 6554, v112
    v_lshrrev_b32 v113, 16, v113
    v_mul_u32_u24 v114, 10, v113
    v_sub_u32 v112, v112, v114
    v_lshrrev_b32 v114, s46, v113
    v_and_b32 v113, s47, v113
    v_mad_u32_u24 v113, v114, s45, v113
    v_mul_u32_u24 v113, 1280, v113
    v_lshl_add_u32 v112, v112, 4, v113
    buffer_load_dwordx4 v[104:107], v112, s[20:23], s44 offen
    s_branch L_ri_e
L_ri_w1:
    s_mov_b32 s20, s72
    s_mov_b32 s21, s73
    s_mov_b32 s22, 1966080
    s_sub_u32 s49, s40, 384
    s_mul_i32 s94, s49, 6144
    s_add_u32 s94, s94, 10190848
    s_mul_i32 s95, s49, 384
    s_add_u32 s95, s95, 327680
    s_mul_i32 s48, s49, 3277
    s_lshr_b32 s48, s48, 16
    s_mul_i32 s44, s48, 20
    s_sub_u32 s44, s49, s44
    s_mul_i32 s44, s44, 98304
    s_mul_i32 s48, s48, 192
    s_add_u32 s44, s44, s48
    v_add_u32 v112, 0, v1
    v_mul_u32_u24 v113, 5462, v112
    v_lshrrev_b32 v113, 16, v113
    v_mul_u32_u24 v113, 2880, v113
    v_lshl_add_u32 v112, v112, 4, v113
    buffer_load_dwordx4 v[88:91], v112, s[20:23], s44 offen
    v_add_u32 v112, 64, v1
    v_mul_u32_u24 v113, 5462, v112
    v_lshrrev_b32 v113, 16, v113
    v_mul_u32_u24 v113, 2880, v113
    v_lshl_add_u32 v112, v112, 4, v113
    buffer_load_dwordx4 v[92:95], v112, s[20:23], s44 offen
    v_add_u32 v112, 128, v1
    v_mul_u32_u24 v113, 5462, v112
    v_lshrrev_b32 v113, 16, v113
    v_mul_u32_u24 v113, 2880, v113
    v_lshl_add_u32 v112, v112, 4, v113
    buffer_load_dwordx4 v[96:99], v112, s[20:23], s44 offen
    v_add_u32 v112, 192, v1
    v_mul_u32_u24 v113, 5462, v112
    v_lshrrev_b32 v113, 16, v113
    v_mul_u32_u24 v113, 2880, v113
    v_lshl_add_u32 v112, v112, 4, v113
    buffer_load_dwordx4 v[100:103], v112, s[20:23], s44 offen
    v_add_u32 v112, 256, v1
    v_mul_u32_u24 v113, 5462, v112
    v_lshrrev_b32 v113, 16, v113
    v_mul_u32_u24 v113, 2880, v113
    v_lshl_add_u32 v112, v112, 4, v113
    buffer_load_dwordx4 v[104:107], v112, s[20:23], s44 offen
    v_add_u32 v112, 320, v1
    v_mul_u32_u24 v113, 5462, v112
    v_lshrrev_b32 v113, 16, v113
    v_mul_u32_u24 v113, 2880, v113
    v_lshl_add_u32 v112, v112, 4, v113
    buffer_load_dwordx4 v[108:111], v112, s[20:23], s44 offen
L_ri_e:
    s_setpc_b64 s[70:71]
Lc_8:
    v_add_u32 v12, 163328, v47
    ds_read_b32 v13, v12
    v_cmp_ne_u32 vcc, 1, v16
    s_cbranch_vccz Lc_7
Lc_6:
    global_load_dword v16, v17, s[82:83] offset:64 sc1
    s_waitcnt vmcnt(0)
    v_cmp_ne_u32 vcc, 1, v16
    s_cbranch_vccz Lc_7
    s_sub_u32 s29, s29, 1
    s_cbranch_scc0 Lc_6
    s_mov_b32 s29, 0
Lc_7:
    s_lshl_b32 s44, s24, 7
    s_add_u32 s44, s44, s92
    s_waitcnt lgkmcnt(0)
    s_mov_b64 exec, 0xffff
    buffer_store_dword v13, v47, s[4:7], s44 offen offset:64 sc1
    s_mov_b64 exec, -1
    s_branch Lc_9
Lst_12:
    buffer_load_dwordx2 v[132:133], v123, s[4:7], s48 offen sc1
    s_waitcnt vmcnt(0)
    v_cmp_eq_u32 vcc, 0, v132
    s_cbranch_vccz Lst_13
    s_sub_u32 s29, s29, 1
    s_cbranch_scc0 Lst_12
    s_mov_b32 s29, 0
    s_branch Lst_13
Lres_17:
    s_waitcnt vmcnt(3)
    v_lshlrev_b32 v8, 16, v18
    v_and_b32 v9, 0xffff0000, v18
    v_lshlrev_b32 v10, 16, v19
    v_and_b32 v11, 0xffff0000, v19
    v_lshlrev_b32 v12, 16, v20
    v_and_b32 v13, 0xffff0000, v20
    v_lshlrev_b32 v14, 16, v21
    v_and_b32 v15, 0xffff0000, v21
    v_lshlrev_b32 v16, 16, v22
    v_and_b32 v17, 0xffff0000, v22
    v_lshlrev_b32 v18, 16, v23
    v_and_b32 v19, 0xffff0000, v23
    v_lshlrev_b32 v20, 16, v24
    v_and_b32 v21, 0xffff0000, v24
    v_lshlrev_b32 v22, 16, v25
    v_and_b32 v23, 0xffff0000, v25
    v_lshlrev_b32 v24, 16, v26
    v_and_b32 v25, 0xffff0000, v26
    v_lshlrev_b32 v26, 16, v27
    v_and_b32 v27, 0xffff0000, v27
    s_branch Lres_18
Lpc_23:
Lpoll_25:
    buffer_load_dword v128, v47, s[4:7], s98 offen sc1
    s_waitcnt vmcnt(0)
    v_cmp_gt_u32 vcc, s97, v128
    s_cbranch_vccz Lpolld_26
    s_sub_u32 s29, s29, 1
    s_cbranch_scc0 Lpoll_25
    s_mov_b32 s29, 0
Lpolld_26:
    s_branch Lpcd_24
Lpc_27:
Lpoll_29:
    buffer_load_dword v194, v47, s[4:7], s62 offen sc1
    s_waitcnt vmcnt(0)
    v_cmp_gt_u32 vcc, s45, v194
    s_cbranch_vccz Lpolld_30
    s_sub_u32 s29, s29, 1
    s_cbranch_scc0 Lpoll_29
    s_mov_b32 s29, 0
Lpolld_30:
    s_branch Lpcd_28
Lpc_31:
Lpoll_33:
    buffer_load_dword v194, v47, s[4:7], s62 offen sc1
    s_waitcnt vmcnt(0)
    v_cmp_gt_u32 vcc, s45, v194
    s_cbranch_vccz Lpolld_34
    s_sub_u32 s29, s29, 1
    s_cbranch_scc0 Lpoll_33
    s_mov_b32 s29, 0
Lpolld_34:
    s_branch Lpcd_32
Lpc_35:
Lpoll_37:
    buffer_load_dword v194, v47, s[4:7], s62 offen sc1
    s_waitcnt vmcnt(0)
    v_cmp_gt_u32 vcc, s58, v194
    s_cbranch_vccz Lpolld_38
    s_sub_u32 s29, s29, 1
    s_cbranch_scc0 Lpoll_37
    s_mov_b32 s29, 0
Lpolld_38:
    s_branch Lpcd_36
Lpc_43:
Lpoll_45:
    buffer_load_dword v128, v47, s[4:7], s98 offen sc1
    s_waitcnt vmcnt(0)
    v_cmp_gt_u32 vcc, s97, v128
    s_cbranch_vccz Lpolld_46
    s_sub_u32 s29, s29, 1
    s_cbranch_scc0 Lpoll_45
    s_mov_b32 s29, 0
Lpolld_46:
    s_branch Lpcd_44
Lpc_47:
Lpoll_49:
    buffer_load_dword v194, v47, s[4:7], s62 offen sc1
    s_waitcnt vmcnt(0)
    v_cmp_gt_u32 vcc, s45, v194
    s_cbranch_vccz Lpolld_50
    s_sub_u32 s29, s29, 1
    s_cbranch_scc0 Lpoll_49
    s_mov_b32 s29, 0
Lpolld_50:
    s_branch Lpcd_48
Lpc_51:
Lpoll_53:
    buffer_load_dword v194, v47, s[4:7], s62 offen sc1
    s_waitcnt vmcnt(0)
    v_cmp_gt_u32 vcc, s45, v194
    s_cbranch_vccz Lpolld_54
    s_sub_u32 s29, s29, 1
    s_cbranch_scc0 Lpoll_53
    s_mov_b32 s29, 0
Lpolld_54:
    s_branch Lpcd_52
Lpc_55:
Lpoll_57:
    buffer_load_dword v194, v47, s[4:7], s62 offen sc1
    s_waitcnt vmcnt(0)
    v_cmp_gt_u32 vcc, s58, v194
    s_cbranch_vccz Lpolld_58
    s_sub_u32 s29, s29, 1
    s_cbranch_scc0 Lpoll_57
    s_mov_b32 s29, 0
Lpolld_58:
    s_branch Lpcd_56
Lneed_67:
    s_mov_b32 exec_lo, 2
    s_mov_b32 exec_hi, 2
    buffer_load_dword v9, v8, s[4:7], s91 offen sc1
    s_mov_b64 exec, -1
    s_waitcnt vmcnt(0)
    s_add_u32 s45, s27, 1
    v_cmp_le_u32 vcc, s45, v9
    s_pack_ll_b32_b16 s63, vcc_lo, vcc_hi
    s_andn2_b32 s44, 2, s63
    s_cbranch_scc0 Lneedd_68
    s_sub_u32 s29, s29, 1
    s_cbranch_scc0 Lneed_67
    s_mov_b32 s29, 0
    s_branch Lneedd_68
Lneed_69:
    s_mov_b32 exec_lo, 2
    s_mov_b32 exec_hi, 2
    buffer_load_dword v9, v8, s[4:7], s91 offen sc1
    s_mov_b64 exec, -1
    s_waitcnt vmcnt(0)
    s_add_u32 s45, s27, 1
    v_cmp_le_u32 vcc, s45, v9
    s_pack_ll_b32_b16 s63, vcc_lo, vcc_hi
    s_andn2_b32 s44, 131072, s63
    s_cbranch_scc0 Lneedd_70
    s_sub_u32 s29, s29, 1
    s_cbranch_scc0 Lneed_69
    s_mov_b32 s29, 0
    s_branch Lneedd_70
Lneed_71:
    s_mov_b32 exec_lo, 4
    s_mov_b32 exec_hi, 4
    buffer_load_dword v9, v8, s[4:7], s91 offen sc1
    s_mov_b64 exec, -1
    s_waitcnt vmcnt(0)
    s_add_u32 s45, s27, 1
    v_cmp_le_u32 vcc, s45, v9
    s_pack_ll_b32_b16 s63, vcc_lo, vcc_hi
    s_andn2_b32 s44, 262148, s63
    s_cbranch_scc0 Lneedd_72
    s_sub_u32 s29, s29, 1
    s_cbranch_scc0 Lneed_71
    s_mov_b32 s29, 0
    s_branch Lneedd_72
Lneed_73:
    s_mov_b32 exec_lo, 8
    s_mov_b32 exec_hi, 8
    buffer_load_dword v9, v8, s[4:7], s91 offen sc1
    s_mov_b64 exec, -1
    s_waitcnt vmcnt(0)
    s_add_u32 s45, s27, 1
    v_cmp_le_u32 vcc, s45, v9
    s_pack_ll_b32_b16 s63, vcc_lo, vcc_hi
    s_andn2_b32 s44, 524296, s63
    s_cbranch_scc0 Lneedd_74
    s_sub_u32 s29, s29, 1
    s_cbranch_scc0 Lneed_73
    s_mov_b32 s29, 0
    s_branch Lneedd_74
Lneed_84:
    s_mov_b32 exec_lo, 16
    s_mov_b32 exec_hi, 16
    buffer_load_dword v9, v8, s[4:7], s91 offen sc1
    s_mov_b64 exec, -1
    s_waitcnt vmcnt(0)
    s_add_u32 s45, s27, 1
    v_cmp_le_u32 vcc, s45, v9
    s_pack_ll_b32_b16 s63, vcc_lo, vcc_hi
    s_andn2_b32 s44, 1048592, s63
    s_cbranch_scc0 Lneedd_85
    s_sub_u32 s29, s29, 1
    s_cbranch_scc0 Lneed_84
    s_mov_b32 s29, 0
    s_branch Lneedd_85
Lneed_86:
    s_mov_b32 exec_lo, 32
    s_mov_b32 exec_hi, 32
    buffer_load_dword v9, v8, s[4:7], s91 offen sc1
    s_mov_b64 exec, -1
    s_waitcnt vmcnt(0)
    s_add_u32 s45, s27, 1
    v_cmp_le_u32 vcc, s45, v9
    s_pack_ll_b32_b16 s63, vcc_lo, vcc_hi
    s_andn2_b32 s44, 2097184, s63
    s_cbranch_scc0 Lneedd_87
    s_sub_u32 s29, s29, 1
    s_cbranch_scc0 Lneed_86
    s_mov_b32 s29, 0
    s_branch Lneedd_87
Lneed_88:
    s_mov_b32 exec_lo, 64
    s_mov_b32 exec_hi, 64
    buffer_load_dword v9, v8, s[4:7], s91 offen sc1
    s_mov_b64 exec, -1
    s_waitcnt vmcnt(0)
    s_add_u32 s45, s27, 1
    v_cmp_le_u32 vcc, s45, v9
    s_pack_ll_b32_b16 s63, vcc_lo, vcc_hi
    s_andn2_b32 s44, 4194368, s63
    s_cbranch_scc0 Lneedd_89
    s_sub_u32 s29, s29, 1
    s_cbranch_scc0 Lneed_88
    s_mov_b32 s29, 0
    s_branch Lneedd_89
Lneed_90:
    s_mov_b32 exec_lo, 128
    s_mov_b32 exec_hi, 128
    buffer_load_dword v9, v8, s[4:7], s91 offen sc1
    s_mov_b64 exec, -1
    s_waitcnt vmcnt(0)
    s_add_u32 s45, s27, 1
    v_cmp_le_u32 vcc, s45, v9
    s_pack_ll_b32_b16 s63, vcc_lo, vcc_hi
    s_andn2_b32 s44, 8388736, s63
    s_cbranch_scc0 Lneedd_91
    s_sub_u32 s29, s29, 1
    s_cbranch_scc0 Lneed_90
    s_mov_b32 s29, 0
    s_branch Lneedd_91
Lpc_94:
Lpoll_96:
    buffer_load_dword v176, v47, s[4:7], s98 offen sc1
    s_waitcnt vmcnt(0)
    v_cmp_gt_u32 vcc, s97, v176
    s_cbranch_vccz Lpolld_97
    s_sub_u32 s29, s29, 1
    s_cbranch_scc0 Lpoll_96
    s_mov_b32 s29, 0
Lpolld_97:
    s_branch Lpcd_95
L_hotend:
L_chain_safe:
    s_mov_b32 s46, 393216
    s_mov_b32 exec_lo, 0
    v_mov_b32 v100, v96
    s_mov_b32 exec_lo, -1
    v_rcp_f32 v130, v100
    s_nop 0
    v_pk_mul_f32 v[88:89], v[88:89], v[130:131] op_sel_hi:[1,0]
    v_pk_mul_f32 v[90:91], v[90:91], v[130:131] op_sel_hi:[1,0]
    v_pk_mul_f32 v[92:93], v[92:93], v[130:131] op_sel_hi:[1,0]
    v_pk_mul_f32 v[94:95], v[94:95], v[130:131] op_sel_hi:[1,0]
    v_pk_mul_f32 v[96:97], v[96:97], v[130:131] op_sel_hi:[1,0]
    v_pk_mul_f32 v[98:99], v[98:99], v[130:131] op_sel_hi:[1,0]
    v_cvt_pk_bf16_f32 v240, v88, v89
    v_cvt_pk_bf16_f32 v241, v90, v91
    v_cvt_pk_bf16_f32 v242, v92, v93
    v_cvt_pk_bf16_f32 v243, v94, v95
    v_cvt_pk_bf16_f32 v244, v96, v97
    v_cvt_pk_bf16_f32 v245, v98, v99
    buffer_store_dwordx4 v[240:243], v41, s[4:7], 0 offen sc1
    s_mov_b32 exec_hi, 0
    buffer_store_dwordx2 v[244:245], v42, s[4:7], 0 offen sc1
    s_mov_b32 exec_hi, -1
    s_mov_b32 exec_lo, 0
    v_mov_b32 v116, v112
    s_mov_b32 exec_lo, -1
    v_rcp_f32 v130, v116
    s_nop 0
    v_pk_mul_f32 v[104:105], v[104:105], v[130:131] op_sel_hi:[1,0]
    v_pk_mul_f32 v[106:107], v[106:107], v[130:131] op_sel_hi:[1,0]
    v_pk_mul_f32 v[108:109], v[108:109], v[130:131] op_sel_hi:[1,0]
    v_pk_mul_f32 v[110:111], v[110:111], v[130:131] op_sel_hi:[1,0]
    v_pk_mul_f32 v[112:113], v[112:113], v[130:131] op_sel_hi:[1,0]
    v_pk_mul_f32 v[114:115], v[114:115], v[130:131] op_sel_hi:[1,0]
    v_cvt_pk_bf16_f32 v248, v104, v105
    v_cvt_pk_bf16_f32 v249, v106, v107
    v_cvt_pk_bf16_f32 v250, v108, v109
    v_cvt_pk_bf16_f32 v251, v110, v111
    v_cvt_pk_bf16_f32 v252, v112, v113
    v_cvt_pk_bf16_f32 v253, v114, v115
    buffer_store_dwordx4 v[248:251], v41, s[4:7], s46 offen sc1
    s_mov_b32 exec_hi, 0
    buffer_store_dwordx2 v[252:253], v42, s[4:7], s46 offen sc1
    s_mov_b32 exec_hi, -1
    v_pk_mul_f32 v[128:129], v[88:89], 0 op_sel_hi:[1,0]
    v_pk_fma_f32 v[128:129], v[90:91], 0, v[128:129] op_sel_hi:[1,0,1]
    v_pk_fma_f32 v[128:129], v[92:93], 0, v[128:129] op_sel_hi:[1,0,1]
    v_pk_fma_f32 v[128:129], v[94:95], 0, v[128:129] op_sel_hi:[1,0,1]
    v_pk_fma_f32 v[128:129], v[96:97], 0, v[128:129] op_sel_hi:[1,0,1]
    v_pk_fma_f32 v[128:129], v[98:99], 0, v[128:129] op_sel_hi:[1,0,1]
    v_add_f32 v128, v128, v129
    v_add_f32 v128, v128, v100
    v_cmp_nle_f32 vcc, 0x37800000, v128
    s_mov_b64 s[52:53], vcc
    v_cmp_nge_f32 vcc, 0x5f800000, v128
    s_or_b64 s[52:53], vcc, s[52:53]
    v_pk_mul_f32 v[128:129], v[104:105], 0 op_sel_hi:[1,0]
    v_pk_fma_f32 v[128:129], v[106:107], 0, v[128:129] op_sel_hi:[1,0,1]
    v_pk_fma_f32 v[128:129], v[108:109], 0, v[128:129] op_sel_hi:[1,0,1]
    v_pk_fma_f32 v[128:129], v[110:111], 0, v[128:129] op_sel_hi:[1,0,1]
    v_pk_fma_f32 v[128:129], v[112:113], 0, v[128:129] op_sel_hi:[1,0,1]
    v_pk_fma_f32 v[128:129], v[114:115], 0, v[128:129] op_sel_hi:[1,0,1]
    v_add_f32 v128, v128, v129
    v_add_f32 v128, v128, v116
    v_cmp_nle_f32 vcc, 0x37800000, v128
    s_or_b64 s[52:53], vcc, s[52:53]
    v_cmp_nge_f32 vcc, 0x5f800000, v128
    s_or_b64 s[52:53], vcc, s[52:53]
    s_lshl_b32 s44, s35, 7
    s_lshl_b32 s45, s25, 2
    s_add_u32 s44, s44, s45
    s_add_u32 s45, s27, 1
    v_lshlrev_b32 v128, 9, v1
    v_mov_b32 v129, s45
    s_and_b64 s[52:53], s[52:53], s[100:101]
    s_cbranch_scc1 L_slow
    ds_read_b128 v[156:159], v2 offset:63488
    ds_read_b128 v[160:163], v2 offset:64512
    ds_read_b128 v[164:167], v3 offset:0
    ds_read_b128 v[168:171], v3 offset:1024
    ds_read_b128 v[172:175], v3 offset:2048
    ds_read_b128 v[176:179], v3 offset:3072
    ds_read_b128 v[180:183], v3 offset:4096
    ds_read_b128 v[184:187], v3 offset:5120
    ds_read_b128 v[188:191], v3 offset:6144
    ds_read_b128 v[192:195], v3 offset:7168
    s_lshr_b32 s96, s31, 1
    s_lshl_b32 s96, s96, 7
    s_and_b32 s45, s31, 1
    s_lshl_b32 s45, s45, 2
    s_add_u32 s96, s96, s45
    s_lshl_b32 s45, s33, 3
    s_add_u32 s96, s96, s45
    s_add_u32 s96, s96, 8192
    s_lshr_b32 s46, s31, 1
    s_lshl_b32 s46, s46, 7
    s_add_u32 s45, s27, 1
    s_mul_i32 s60, s31, 49152
    s_add_u32 s60, s60, 3080192
    s_mov_b64 exec, 3
    s_waitcnt vmcnt(0)
    buffer_store_dword v129, v128, s[4:7], s44 offen sc1
    s_mov_b64 exec, -1
Lpoll_39:
    buffer_load_dword v136, v46, s[4:7], s46 offen sc1
    s_waitcnt vmcnt(0)
    v_cmp_gt_u32 vcc, s45, v136
    s_cbranch_vccz Lpolld_40
    s_sub_u32 s29, s29, 1
    s_cbranch_scc0 Lpoll_39
    s_mov_b32 s29, 0
Lpolld_40:
    buffer_load_dwordx4 v[216:219], v2, s[4:7], s60 offen offset:0 sc1
    buffer_load_dwordx4 v[220:223], v2, s[4:7], s60 offen offset:1024 sc1
    buffer_load_dwordx4 v[224:227], v2, s[4:7], s60 offen offset:2048 sc1
    buffer_load_dwordx4 v[228:231], v2, s[4:7], s60 offen offset:3072 sc1
    s_add_u32 s60, s60, 4096
    buffer_load_dwordx4 v[232:235], v2, s[4:7], s60 offen offset:0 sc1
    buffer_load_dwordx4 v[236:239], v2, s[4:7], s60 offen offset:1024 sc1
    buffer_load_dwordx4 v[240:243], v2, s[4:7], s60 offen offset:2048 sc1
    s_waitcnt vmcnt(6) lgkmcnt(5)
    v_mfma_f32_16x16x32_bf16 v[8:11], v[156:159], v[216:219], v[8:11]
    ds_read_b128 v[196:199], v3 offset:8192
    buffer_load_dwordx4 v[244:247], v2, s[4:7], s60 offen offset:3072 sc1
    v_mfma_f32_16x16x32_bf16 v[12:15], v[160:163], v[216:219], v[12:15]
    ds_read_b128 v[200:203], v3 offset:9216
    v_mfma_f32_16x16x32_bf16 v[16:19], v[164:167], v[216:219], v[16:19]
    ds_read_b128 v[204:207], v3 offset:10240
    v_mfma_f32_16x16x32_bf16 v[20:23], v[168:171], v[216:219], v[20:23]
    ds_read_b128 v[208:211], v3 offset:11264
    v_mfma_f32_16x16x32_bf16 v[24:27], v[172:175], v[216:219], v[24:27]
    ds_read_b128 v[212:215], v3 offset:12288
    s_waitcnt vmcnt(6) lgkmcnt(5)
    v_mfma_f32_16x16x32_bf16 v[8:11], v[176:179], v[220:223], v[8:11]
    ds_read_b128 v[156:159], v3 offset:13312
    s_add_u32 s60, s60, 4096
    buffer_load_dwordx4 v[216:219], v2, s[4:7], s60 offen offset:0 sc1
    v_mfma_f32_16x16x32_bf16 v[12:15], v[180:183], v[220:223], v[12:15]
    ds_read_b128 v[160:163], v3 offset:14336
    v_mfma_f32_16x16x32_bf16 v[16:19], v[184:187], v[220:223], v[16:19]
    ds_read_b128 v[164:167], v3 offset:15360
    v_mfma_f32_16x16x32_bf16 v[20:23], v[188:191], v[220:223], v[20:23]
    ds_read_b128 v[168:171], v3 offset:16384
    v_mfma_f32_16x16x32_bf16 v[24:27], v[192:195], v[220:223], v[24:27]
    ds_read_b128 v[172:175], v3 offset:17408
    s_waitcnt vmcnt(6) lgkmcnt(5)
    v_mfma_f32_16x16x32_bf16 v[8:11], v[196:199], v[224:227], v[8:11]
    ds_read_b128 v[176:179], v3 offset:18432
    buffer_load_dwordx4 v[220:223], v2, s[4:7], s60 offen offset:1024 sc1
    v_mfma_f32_16x16x32_bf16 v[12:15], v[200:203], v[224:227], v[12:15]
    ds_read_b128 v[180:183], v3 offset:19456
    v_mfma_f32_16x16x32_bf16 v[16:19], v[204:207], v[224:227], v[16:19]
    ds_read_b128 v[184:187], v3 offset:20480
    v_mfma_f32_16x16x32_bf16 v[20:23], v[208:211], v[224:227], v[20:23]
    ds_read_b128 v[188:191], v3 offset:21504
    v_mfma_f32_16x16x32_bf16 v[24:27], v[212:215], v[224:227], v[24:27]
    ds_read_b128 v[192:195], v3 offset:22528
    s_waitcnt vmcnt(6) lgkmcnt(5)
    v_mfma_f32_16x16x32_bf16 v[8:11], v[156:159], v[228:231], v[8:11]
    ds_read_b128 v[196:199], v3 offset:23552
    buffer_load_dwordx4 v[224:227], v2, s[4:7], s60 offen offset:2048 sc1
    v_mfma_f32_16x16x32_bf16 v[12:15], v[160:163], v[228:231], v[12:15]
    ds_read_b128 v[200:203], v3 offset:24576
    v_mfma_f32_16x16x32_bf16 v[16:19], v[164:167], v[228:231], v[16:19]
    ds_read_b128 v[204:207], v3 offset:25600
    v_mfma_f32_16x16x32_bf16 v[20:23], v[168:171], v[228:231], v[20:23]
    ds_read_b128 v[208:211], v3 offset:26624
    v_mfma_f32_16x16x32_bf16 v[24:27], v[172:175], v[228:231], v[24:27]
    ds_read_b128 v[212:215], v3 offset:27648
    s_waitcnt vmcnt(6) lgkmcnt(5)
    v_mfma_f32_16x16x32_bf16 v[8:11], v[176:179], v[232:235], v[8:11]
    ds_read_b128 v[156:159], v3 offset:28672
    buffer_load_dwordx4 v[228:231], v2, s[4:7], s60 offen offset:3072 sc1
    v_mfma_f32_16x16x32_bf16 v[12:15], v[180:183], v[232:235], v[12:15]
    ds_read_b128 v[160:163], v3 offset:29696
    v_mfma_f32_16x16x32_bf16 v[16:19], v[184:187], v[232:235], v[16:19]
    ds_read_b128 v[164:167], v3 offset:30720
    v_mfma_f32_16x16x32_bf16 v[20:23], v[188:191], v[232:235], v[20:23]
    ds_read_b128 v[168:171], v3 offset:31744
    v_mfma_f32_16x16x32_bf16 v[24:27], v[192:195], v[232:235], v[24:27]
    ds_read_b128 v[172:175], v3 offset:32768
    s_waitcnt vmcnt(6) lgkmcnt(5)
    v_mfma_f32_16x16x32_bf16 v[8:11], v[196:199], v[236:239], v[8:11]
    ds_read_b128 v[176:179], v3 offset:33792
    s_add_u32 s60, s60, 4096
    buffer_load_dwordx4 v[232:235], v2, s[4:7], s60 offen offset:0 sc1
    v_mfma_f32_16x16x32_bf16 v[12:15], v[200:203], v[236:239], v[12:15]
    ds_read_b128 v[180:183], v3 offset:34816
    v_mfma_f32_16x16x32_bf16 v[16:19], v[204:207], v[236:239], v[16:19]
    ds_read_b128 v[184:187], v3 offset:35840
    v_mfma_f32_16x16x32_bf16 v[20:23], v[208:211], v[236:239], v[20:23]
    ds_read_b128 v[188:191], v3 offset:36864
    v_mfma_f32_16x16x32_bf16 v[24:27], v[212:215], v[236:239], v[24:27]
    ds_read_b128 v[192:195], v3 offset:37888
    s_waitcnt vmcnt(6) lgkmcnt(5)
    v_mfma_f32_16x16x32_bf16 v[8:11], v[156:159], v[240:243], v[8:11]
    ds_read_b128 v[196:199], v3 offset:38912
    buffer_load_dwordx4 v[236:239], v2, s[4:7], s60 offen offset:1024 sc1
    v_mfma_f32_16x16x32_bf16 v[12:15], v[160:163], v[240:243], v[12:15]
    ds_read_b128 v[200:203], v3 offset:39936
    v_mfma_f32_16x16x32_bf16 v[16:19], v[164:167], v[240:243], v[16:19]
    ds_read_b128 v[204:207], v3 offset:40960
    v_mfma_f32_16x16x32_bf16 v[20:23], v[168:171], v[240:243], v[20:23]
    ds_read_b128 v[208:211], v3 offset:41984
    v_mfma_f32_16x16x32_bf16 v[24:27], v[172:175], v[240:243], v[24:27]
    ds_read_b128 v[212:215], v3 offset:43008
    s_waitcnt vmcnt(6) lgkmcnt(5)
    v_mfma_f32_16x16x32_bf16 v[8:11], v[176:179], v[244:247], v[8:11]
    ds_read_b128 v[156:159], v3 offset:44032
    buffer_load_dwordx4 v[240:243], v2, s[4:7], s60 offen offset:2048 sc1
    v_mfma_f32_16x16x32_bf16 v[12:15], v[180:183], v[244:247], v[12:15]
    ds_read_b128 v[160:163], v3 offset:45056
    v_mfma_f32_16x16x32_bf16 v[16:19], v[184:187], v[244:247], v[16:19]
    ds_read_b128 v[164:167], v3 offset:46080
    v_mfma_f32_16x16x32_bf16 v[20:23], v[188:191], v[244:247], v[20:23]
    ds_read_b128 v[168:171], v3 offset:47104
    v_mfma_f32_16x16x32_bf16 v[24:27], v[192:195], v[244:247], v[24:27]
    ds_read_b128 v[172:175], v3 offset:48128
    s_waitcnt vmcnt(6) lgkmcnt(5)
    v_mfma_f32_16x16x32_bf16 v[8:11], v[196:199], v[216:219], v[8:11]
    ds_read_b128 v[176:179], v3 offset:49152
    buffer_load_dwordx4 v[244:247], v2, s[4:7], s60 offen offset:3072 sc1
    v_mfma_f32_16x16x32_bf16 v[12:15], v[200:203], v[216:219], v[12:15]
    ds_read_b128 v[180:183], v3 offset:50176
    v_mfma_f32_16x16x32_bf16 v[16:19], v[204:207], v[216:219], v[16:19]
    ds_read_b128 v[184:187], v3 offset:51200
    v_mfma_f32_16x16x32_bf16 v[20:23], v[208:211], v[216:219], v[20:23]
    ds_read_b128 v[188:191], v3 offset:52224
    v_mfma_f32_16x16x32_bf16 v[24:27], v[212:215], v[216:219], v[24:27]
    ds_read_b128 v[192:195], v3 offset:53248
    s_waitcnt vmcnt(6) lgkmcnt(5)
    v_mfma_f32_16x16x32_bf16 v[8:11], v[156:159], v[220:223], v[8:11]
    ds_read_b128 v[196:199], v3 offset:54272
    s_add_u32 s60, s60, 4096
    buffer_load_dwordx4 v[216:219], v2, s[4:7], s60 offen offset:0 sc1
    v_mfma_f32_16x16x32_bf16 v[12:15], v[160:163], v[220:223], v[12:15]
    ds_read_b128 v[200:203], v3 offset:55296
    v_mfma_f32_16x16x32_bf16 v[16:19], v[164:167], v[220:223], v[16:19]
    ds_read_b128 v[204:207], v3 offset:56320
    v_mfma_f32_16x16x32_bf16 v[20:23], v[168:171], v[220:223], v[20:23]
    ds_read_b128 v[208:211], v3 offset:57344
    v_mfma_f32_16x16x32_bf16 v[24:27], v[172:175], v[220:223], v[24:27]
    ds_read_b128 v[212:215], v3 offset:58368
    s_waitcnt vmcnt(6) lgkmcnt(5)
    v_mfma_f32_16x16x32_bf16 v[8:11], v[176:179], v[224:227], v[8:11]
    ds_read_b128 v[156:159], v3 offset:59392
    buffer_load_dwordx4 v[220:223], v2, s[4:7], s60 offen offset:1024 sc1
    v_mfma_f32_16x16x32_bf16 v[12:15], v[180:183], v[224:227], v[12:15]
    ds_read_b128 v[160:163], v3 offset:60416
    v_mfma_f32_16x16x32_bf16 v[16:19], v[184:187], v[224:227], v[16:19]
    ds_read_b128 v[164:167], v3 offset:61440
    v_mfma_f32_16x16x32_bf16 v[20:23], v[188:191], v[224:227], v[20:23]
    ds_read_b128 v[168:171], v3 offset:62464
    v_mfma_f32_16x16x32_bf16 v[24:27], v[192:195], v[224:227], v[24:27]
    ds_read_b128 v[172:175], v3 offset:63488
    s_waitcnt vmcnt(6) lgkmcnt(5)
    v_mfma_f32_16x16x32_bf16 v[8:11], v[196:199], v[228:231], v[8:11]
    ds_read_b128 v[176:179], v3 offset:64512
    buffer_load_dwordx4 v[224:227], v2, s[4:7], s60 offen offset:2048 sc1
    v_mfma_f32_16x16x32_bf16 v[12:15], v[200:203], v[228:231], v[12:15]
    ds_read_b128 v[180:183], v4 offset:0
    v_mfma_f32_16x16x32_bf16 v[16:19], v[204:207], v[228:231], v[16:19]
    ds_read_b128 v[184:187], v4 offset:1024
    v_mfma_f32_16x16x32_bf16 v[20:23], v[208:211], v[228:231], v[20:23]
    ds_read_b128 v[188:191], v4 offset:2048
    v_mfma_f32_16x16x32_bf16 v[24:27], v[212:215], v[228:231], v[24:27]
    ds_read_b128 v[192:195], v4 offset:3072
    s_waitcnt vmcnt(6) lgkmcnt(5)
    v_mfma_f32_16x16x32_bf16 v[8:11], v[156:159], v[232:235], v[8:11]
    ds_read_b128 v[196:199], v4 offset:4096
    buffer_load_dwordx4 v[228:231], v2, s[4:7], s60 offen offset:3072 sc1
    v_mfma_f32_16x16x32_bf16 v[12:15], v[160:163], v[232:235], v[12:15]
    ds_read_b128 v[200:203], v4 offset:5120
    v_mfma_f32_16x16x32_bf16 v[16:19], v[164:167], v[232:235], v[16:19]
    ds_read_b128 v[204:207], v4 offset:6144
    v_mfma_f32_16x16x32_bf16 v[20:23], v[168:171], v[232:235], v[20:23]
    ds_read_b128 v[208:211], v4 offset:7168
    v_mfma_f32_16x16x32_bf16 v[24:27], v[172:175], v[232:235], v[24:27]
    ds_read_b128 v[212:215], v4 offset:8192
    s_waitcnt vmcnt(6) lgkmcnt(5)
    v_mfma_f32_16x16x32_bf16 v[8:11], v[176:179], v[236:239], v[8:11]
    ds_read_b128 v[156:159], v4 offset:9216
    v_mfma_f32_16x16x32_bf16 v[12:15], v[180:183], v[236:239], v[12:15]
    ds_read_b128 v[160:163], v4 offset:10240
    v_mfma_f32_16x16x32_bf16 v[16:19], v[184:187], v[236:239], v[16:19]
    ds_read_b128 v[164:167], v4 offset:11264
    v_mfma_f32_16x16x32_bf16 v[20:23], v[188:191], v[236:239], v[20:23]
    ds_read_b128 v[168:171], v4 offset:12288
    v_mfma_f32_16x16x32_bf16 v[24:27], v[192:195], v[236:239], v[24:27]
    ds_read_b128 v[172:175], v4 offset:13312
    s_waitcnt vmcnt(5) lgkmcnt(5)
    v_mfma_f32_16x16x32_bf16 v[8:11], v[196:199], v[240:243], v[8:11]
    ds_read_b128 v[176:179], v4 offset:14336
    v_mfma_f32_16x16x32_bf16 v[12:15], v[200:203], v[240:243], v[12:15]
    ds_read_b128 v[180:183], v4 offset:15360
    v_mfma_f32_16x16x32_bf16 v[16:19], v[204:207], v[240:243], v[16:19]
    ds_read_b128 v[184:187], v4 offset:16384
    v_mfma_f32_16x16x32_bf16 v[20:23], v[208:211], v[240:243], v[20:23]
    ds_read_b128 v[188:191], v4 offset:17408
    v_mfma_f32_16x16x32_bf16 v[24:27], v[212:215], v[240:243], v[24:27]
    ds_read_b128 v[192:195], v4 offset:18432
    s_waitcnt vmcnt(4) lgkmcnt(5)
    v_mfma_f32_16x16x32_bf16 v[8:11], v[156:159], v[244:247], v[8:11]
    ds_read_b128 v[196:199], v4 offset:19456
    v_mfma_f32_16x16x32_bf16 v[12:15], v[160:163], v[244:247], v[12:15]
    ds_read_b128 v[200:203], v4 offset:20480
    v_mfma_f32_16x16x32_bf16 v[16:19], v[164:167], v[244:247], v[16:19]
    ds_read_b128 v[204:207], v4 offset:21504
    v_mfma_f32_16x16x32_bf16 v[20:23], v[168:171], v[244:247], v[20:23]
    ds_read_b128 v[208:211], v4 offset:22528
    v_mfma_f32_16x16x32_bf16 v[24:27], v[172:175], v[244:247], v[24:27]
    ds_read_b128 v[212:215], v4 offset:23552
    s_waitcnt vmcnt(3) lgkmcnt(5)
    v_mfma_f32_16x16x32_bf16 v[8:11], v[176:179], v[216:219], v[8:11]
    ds_read_b128 v[156:159], v4 offset:24576
    v_mfma_f32_16x16x32_bf16 v[12:15], v[180:183], v[216:219], v[12:15]
    ds_read_b128 v[160:163], v4 offset:25600
    v_mfma_f32_16x16x32_bf16 v[16:19], v[184:187], v[216:219], v[16:19]
    ds_read_b128 v[164:167], v4 offset:26624
    v_mfma_f32_16x16x32_bf16 v[20:23], v[188:191], v[216:219], v[20:23]
    ds_read_b128 v[168:171], v4 offset:27648
    v_mfma_f32_16x16x32_bf16 v[24:27], v[192:195], v[216:219], v[24:27]
    ds_read_b128 v[172:175], v4 offset:28672
    s_waitcnt vmcnt(2) lgkmcnt(5)
    v_mfma_f32_16x16x32_bf16 v[8:11], v[196:199], v[220:223], v[8:11]
    ds_read_b128 v[176:179], v4 offset:29696
    v_mfma_f32_16x16x32_bf16 v[12:15], v[200:203], v[220:223], v[12:15]
    ds_read_b128 v[180:183], v2 offset:0
    v_mfma_f32_16x16x32_bf16 v[16:19], v[204:207], v[220:223], v[16:19]
    ds_read_b128 v[184:187], v2 offset:1024
    v_mfma_f32_16x16x32_bf16 v[20:23], v[208:211], v[220:223], v[20:23]
    ds_read_b128 v[188:191], v2 offset:2048
    v_mfma_f32_16x16x32_bf16 v[24:27], v[212:215], v[220:223], v[24:27]
    ds_read_b128 v[192:195], v2 offset:3072
    s_waitcnt vmcnt(1) lgkmcnt(5)
    v_mfma_f32_16x16x32_bf16 v[8:11], v[156:159], v[224:227], v[8:11]
    v_mfma_f32_16x16x32_bf16 v[12:15], v[160:163], v[224:227], v[12:15]
    v_mfma_f32_16x16x32_bf16 v[16:19], v[164:167], v[224:227], v[16:19]
    v_mfma_f32_16x16x32_bf16 v[20:23], v[168:171], v[224:227], v[20:23]
    v_mfma_f32_16x16x32_bf16 v[24:27], v[172:175], v[224:227], v[24:27]
    s_waitcnt vmcnt(0) lgkmcnt(0)
    v_mfma_f32_16x16x32_bf16 v[8:11], v[176:179], v[228:231], v[8:11]
    v_mfma_f32_16x16x32_bf16 v[12:15], v[180:183], v[228:231], v[12:15]
    v_mfma_f32_16x16x32_bf16 v[16:19], v[184:187], v[228:231], v[16:19]
    v_mfma_f32_16x16x32_bf16 v[20:23], v[188:191], v[228:231], v[20:23]
    v_mfma_f32_16x16x32_bf16 v[24:27], v[192:195], v[228:231], v[24:27]
    s_add_u32 s45, s97, 1
    s_add_u32 s97, s97, 2
    s_nop 1
    v_cvt_pk_bf16_f32 v136, v8, v9
    v_cvt_pk_bf16_f32 v137, v10, v11
    v_cvt_pk_bf16_f32 v138, v12, v13
    v_cvt_pk_bf16_f32 v139, v14, v15
    buffer_store_dwordx4 v[136:139], v43, s[4:7], 0 offen sc1
    v_cvt_pk_bf16_f32 v140, v16, v17
    v_cvt_pk_bf16_f32 v141, v18, v19
    v_cvt_pk_bf16_f32 v142, v20, v21
    v_cvt_pk_bf16_f32 v143, v22, v23
    buffer_store_dwordx4 v[140:143], v43, s[4:7], 0 offen offset:2048 sc1
    v_cvt_pk_bf16_f32 v144, v24, v25
    v_cvt_pk_bf16_f32 v145, v26, v27
    buffer_store_dwordx2 v[144:145], v44, s[4:7], 0 offen sc1
    v_pk_add_f32 v[148:149], v[8:9], v[10:11]
    v_pk_mul_f32 v[150:151], v[8:9], v[8:9]
    v_pk_fma_f32 v[150:151], v[10:11], v[10:11], v[150:151]
    v_pk_add_f32 v[148:149], v[148:149], v[12:13]
    v_pk_fma_f32 v[150:151], v[12:13], v[12:13], v[150:151]
    v_pk_add_f32 v[148:149], v[148:149], v[14:15]
    v_pk_fma_f32 v[150:151], v[14:15], v[14:15], v[150:151]
    v_pk_add_f32 v[148:149], v[148:149], v[16:17]
    v_pk_fma_f32 v[150:151], v[16:17], v[16:17], v[150:151]
    v_pk_add_f32 v[148:149], v[148:149], v[18:19]
    v_pk_fma_f32 v[150:151], v[18:19], v[18:19], v[150:151]
    v_pk_add_f32 v[148:149], v[148:149], v[20:21]
    v_pk_fma_f32 v[150:151], v[20:21], v[20:21], v[150:151]
    v_pk_add_f32 v[148:149], v[148:149], v[22:23]
    v_pk_fma_f32 v[150:151], v[22:23], v[22:23], v[150:151]
    v_pk_add_f32 v[148:149], v[148:149], v[24:25]
    v_pk_fma_f32 v[150:151], v[24:25], v[24:25], v[150:151]
    v_pk_add_f32 v[148:149], v[148:149], v[26:27]
    v_pk_fma_f32 v[150:151], v[26:27], v[26:27], v[150:151]
    v_add_f32 v148, v148, v149
    v_add_f32 v150, v150, v151
    v_mov_b32 v152, 0
    v_mov_b32 v153, s45
    v_permlane32_swap_b32 v148, v150
    v_add_f32 v148, v148, v150
    v_mov_b32 v150, v148
    v_mov_b32 v154, s97
    s_nop 0
    v_permlane16_swap_b32 v148, v150
    v_add_f32 v148, v148, v150
    buffer_store_dword v148, v45, s[4:7], 0 offen sc1
    s_barrier
    s_mov_b64 exec, 1
    s_waitcnt vmcnt(1)
    buffer_store_dword v153, v152, s[4:7], s96 offen sc1
    s_mov_b64 exec, -1
    s_lshl_b32 s44, s32, 7
    s_lshl_b32 s45, s34, 2
    s_add_u32 s61, s44, s45
    s_add_u32 s61, s61, 16384
    s_add_u32 s98, s44, 8192
    s_sub_u32 s46, s97, 1
    s_mul_i32 s60, s32, 40960
    s_add_u32 s60, s60, 458752
    s_mul_i32 s59, s32, 98304
    s_lshl_b32 s45, s34, 10
    s_add_u32 s59, s59, s45
    s_add_u32 s59, s59, 3080192
    s_lshr_b32 s62, s31, 1
    s_lshl_b32 s62, s62, 7
    s_add_u32 s62, s62, 16384
    s_mul_i32 s58, s27, 3
    v_mov_b32 v206, s54
    v_mov_b32 v207, s54
    v_add_u32 v204, 49152, v2
    v_lshrrev_b32 v7, 4, v1
    v_lshlrev_b32 v205, 5, v7
    v_add_u32 v205, 162048, v205
    v_lshlrev_b32 v129, 9, v7
    v_lshl_add_u32 v129, v47, 2, v129
    v_mul_u32_u24 v7, 80, v7
    v_add_u32 v7, 162816, v7
    s_mov_b64 exec, 1
    s_waitcnt vmcnt(1)
    buffer_store_dword v154, v152, s[4:7], s96 offen sc1
    s_mov_b64 exec, -1
    ds_read_b128 v[136:139], v2 offset:4096
    ds_read_b128 v[140:143], v2 offset:5120
    ds_read_b128 v[144:147], v2 offset:6144
    ds_read_b128 v[148:151], v2 offset:7168
    ds_read_b128 v[152:155], v2 offset:8192
    ds_read_b128 v[156:159], v2 offset:9216
Lpoll_41:
    buffer_load_dword v172, v47, s[4:7], s98 offen sc1
    s_waitcnt vmcnt(0)
    v_cmp_gt_u32 vcc, s46, v172
    s_cbranch_vccz Lpolld_42
    s_sub_u32 s29, s29, 1
    s_cbranch_scc0 Lpoll_41
    s_mov_b32 s29, 0
Lpolld_42:
    buffer_load_dwordx4 v[172:175], v129, s[4:7], s60 offen offset:0 sc1
    buffer_load_dwordx4 v[176:179], v129, s[4:7], s60 offen offset:256 sc1
    buffer_load_dwordx4 v[180:183], v129, s[4:7], s60 offen offset:2048 sc1
    buffer_load_dwordx4 v[184:187], v129, s[4:7], s60 offen offset:2304 sc1
    s_add_u32 s60, s60, 4096
    buffer_load_dwordx4 v[188:191], v129, s[4:7], s60 offen offset:0 sc1
    buffer_load_dwordx4 v[192:195], v129, s[4:7], s60 offen offset:256 sc1
    s_waitcnt vmcnt(4) lgkmcnt(3)
    v_mfma_f32_16x16x32_bf16 v[208:211], v[136:139], v[172:175], 0
    buffer_load_dwordx4 v[196:199], v129, s[4:7], s60 offen offset:2048 sc1
    v_mfma_f32_16x16x32_bf16 v[216:219], v[136:139], v[176:179], 0
    ds_read_b128 v[160:163], v2 offset:10240
    v_mfma_f32_16x16x32_bf16 v[212:215], v[140:143], v[172:175], 0
    v_mfma_f32_16x16x32_bf16 v[220:223], v[140:143], v[176:179], 0
    ds_read_b128 v[164:167], v2 offset:11264
    v_mfma_f32_16x16x32_bf16 v[224:227], v[144:147], v[172:175], 0
    v_mfma_f32_16x16x32_bf16 v[232:235], v[144:147], v[176:179], 0
    ds_read_b128 v[168:171], v2 offset:12288
    s_waitcnt lgkmcnt(3)
    v_mfma_f32_16x16x32_bf16 v[228:231], v[148:151], v[172:175], 0
    buffer_load_dwordx4 v[200:203], v129, s[4:7], s60 offen offset:2304 sc1
    v_mfma_f32_16x16x32_bf16 v[236:239], v[148:151], v[176:179], 0
    ds_read_b128 v[136:139], v2 offset:13312
    ds_read_b128 v[88:91], v7 offset:0
    v_mfma_f32_16x16x32_bf16 v[240:243], v[152:155], v[172:175], 0
    ds_read_b128 v[92:95], v7 offset:16
    v_mfma_f32_16x16x32_bf16 v[248:251], v[152:155], v[176:179], 0
    ds_read_b128 v[140:143], v2 offset:14336
    ds_read_b128 v[96:99], v7 offset:32
    v_mfma_f32_16x16x32_bf16 v[244:247], v[156:159], v[172:175], 0
    ds_read_b128 v[100:103], v7 offset:48
    v_mfma_f32_16x16x32_bf16 v[252:255], v[156:159], v[176:179], 0
    ds_read_b128 v[144:147], v2 offset:15360
    ds_read_b128 v[104:107], v7 offset:64
    buffer_load_dword v128, v47, s[4:7], s98 offen sc1
    s_waitcnt vmcnt(5) lgkmcnt(8)
    v_mfma_f32_16x16x32_bf16 v[208:211], v[160:163], v[180:183], v[208:211]
    s_add_u32 s60, s60, 4096
    buffer_load_dwordx4 v[172:175], v129, s[4:7], s60 offen offset:0 sc1
    v_mfma_f32_16x16x32_bf16 v[216:219], v[160:163], v[184:187], v[216:219]
    ds_read_b128 v[148:151], v2 offset:16384
    v_mfma_f32_16x16x32_bf16 v[212:215], v[164:167], v[180:183], v[212:215]
    v_mfma_f32_16x16x32_bf16 v[220:223], v[164:167], v[184:187], v[220:223]
    ds_read_b128 v[152:155], v2 offset:17408
    v_mfma_f32_16x16x32_bf16 v[224:227], v[168:171], v[180:183], v[224:227]
    v_mfma_f32_16x16x32_bf16 v[232:235], v[168:171], v[184:187], v[232:235]
    ds_read_b128 v[156:159], v2 offset:18432
    s_waitcnt lgkmcnt(4)
    v_mfma_f32_16x16x32_bf16 v[228:231], v[136:139], v[180:183], v[228:231]
    buffer_load_dwordx4 v[176:179], v129, s[4:7], s60 offen offset:256 sc1
    v_mfma_f32_16x16x32_bf16 v[236:239], v[136:139], v[184:187], v[236:239]
    ds_read_b128 v[160:163], v2 offset:19456
    v_mfma_f32_16x16x32_bf16 v[240:243], v[140:143], v[180:183], v[240:243]
    v_mfma_f32_16x16x32_bf16 v[248:251], v[140:143], v[184:187], v[248:251]
    ds_read_b128 v[164:167], v2 offset:20480
    v_mfma_f32_16x16x32_bf16 v[244:247], v[144:147], v[180:183], v[244:247]
    v_mfma_f32_16x16x32_bf16 v[252:255], v[144:147], v[184:187], v[252:255]
    ds_read_b128 v[168:171], v2 offset:21504
    s_waitcnt vmcnt(5) lgkmcnt(3)
    v_mfma_f32_16x16x32_bf16 v[208:211], v[148:151], v[188:191], v[208:211]
    buffer_load_dwordx4 v[180:183], v129, s[4:7], s60 offen offset:2048 sc1
    v_mfma_f32_16x16x32_bf16 v[216:219], v[148:151], v[192:195], v[216:219]
    ds_read_b128 v[136:139], v2 offset:22528
    v_mfma_f32_16x16x32_bf16 v[212:215], v[152:155], v[188:191], v[212:215]
    v_add_f32 v8, v8, v88
    v_mfma_f32_16x16x32_bf16 v[220:223], v[152:155], v[192:195], v[220:223]
    ds_read_b128 v[140:143], v2 offset:23552
    v_add_f32 v9, v9, v89
    v_mfma_f32_16x16x32_bf16 v[224:227], v[156:159], v[188:191], v[224:227]
    v_add_f32 v10, v10, v90
    v_mfma_f32_16x16x32_bf16 v[232:235], v[156:159], v[192:195], v[232:235]
    ds_read_b128 v[144:147], v2 offset:24576
    s_waitcnt lgkmcnt(3)
    v_mfma_f32_16x16x32_bf16 v[228:231], v[160:163], v[188:191], v[228:231]
    buffer_load_dwordx4 v[184:187], v129, s[4:7], s60 offen offset:2304 sc1
    v_mfma_f32_16x16x32_bf16 v[236:239], v[160:163], v[192:195], v[236:239]
    ds_read_b128 v[148:151], v2 offset:25600
    v_add_f32 v11, v11, v91
    v_mfma_f32_16x16x32_bf16 v[240:243], v[164:167], v[188:191], v[240:243]
    v_add_f32 v12, v12, v92
    v_mfma_f32_16x16x32_bf16 v[248:251], v[164:167], v[192:195], v[248:251]
    ds_read_b128 v[152:155], v2 offset:26624
    v_add_f32 v13, v13, v93
    v_mfma_f32_16x16x32_bf16 v[244:247], v[168:171], v[188:191], v[244:247]
    v_add_f32 v14, v14, v94
    v_mfma_f32_16x16x32_bf16 v[252:255], v[168:171], v[192:195], v[252:255]
    ds_read_b128 v[156:159], v2 offset:27648
    s_waitcnt vmcnt(5) lgkmcnt(3)
    s_waitcnt vmcnt(4)
    v_cmp_gt_u32 vcc, s97, v128
    s_cbranch_vccnz Lpc_43
Lpcd_44:
    v_mfma_f32_16x16x32_bf16 v[208:211], v[136:139], v[196:199], v[208:211]
    s_add_u32 s60, s60, 4096
    buffer_load_dwordx4 v[188:191], v129, s[4:7], s60 offen offset:0 sc1
    v_mfma_f32_16x16x32_bf16 v[216:219], v[136:139], v[200:203], v[216:219]
    ds_read_b128 v[160:163], v2 offset:28672
    v_add_f32 v15, v15, v95
    v_mfma_f32_16x16x32_bf16 v[212:215], v[140:143], v[196:199], v[212:215]
    v_add_f32 v16, v16, v96
    v_mfma_f32_16x16x32_bf16 v[220:223], v[140:143], v[200:203], v[220:223]
    ds_read_b128 v[164:167], v2 offset:29696
    v_add_f32 v17, v17, v97
    v_mfma_f32_16x16x32_bf16 v[224:227], v[144:147], v[196:199], v[224:227]
    v_add_f32 v18, v18, v98
    v_mfma_f32_16x16x32_bf16 v[232:235], v[144:147], v[200:203], v[232:235]
    ds_read_b128 v[168:171], v2 offset:30720
    s_lshl_b32 s49, s32, 11
    s_add_u32 s49, s49, 196608
    buffer_load_dwordx4 v[120:123], v2, s[4:7], s49 offen sc1
    buffer_load_dwordx4 v[124:127], v2, s[4:7], s49 offen offset:1024 sc1
    s_waitcnt lgkmcnt(3)
    v_mfma_f32_16x16x32_bf16 v[228:231], v[148:151], v[196:199], v[228:231]
    buffer_load_dwordx4 v[192:195], v129, s[4:7], s60 offen offset:256 sc1
    v_mfma_f32_16x16x32_bf16 v[236:239], v[148:151], v[200:203], v[236:239]
    ds_read_b128 v[136:139], v2 offset:31744
    v_add_f32 v19, v19, v99
    v_mfma_f32_16x16x32_bf16 v[240:243], v[152:155], v[196:199], v[240:243]
    v_add_f32 v20, v20, v100
    v_mfma_f32_16x16x32_bf16 v[248:251], v[152:155], v[200:203], v[248:251]
    ds_read_b128 v[140:143], v2 offset:32768
    v_add_f32 v21, v21, v101
    v_mfma_f32_16x16x32_bf16 v[244:247], v[156:159], v[196:199], v[244:247]
    v_add_f32 v22, v22, v102
    v_mfma_f32_16x16x32_bf16 v[252:255], v[156:159], v[200:203], v[252:255]
    ds_read_b128 v[144:147], v2 offset:33792
    s_waitcnt vmcnt(6) lgkmcnt(3)
    v_mfma_f32_16x16x32_bf16 v[208:211], v[160:163], v[172:175], v[208:211]
    buffer_load_dwordx4 v[196:199], v129, s[4:7], s60 offen offset:2048 sc1
    v_mfma_f32_16x16x32_bf16 v[216:219], v[160:163], v[176:179], v[216:219]
    ds_read_b128 v[148:151], v2 offset:34816
    v_add_f32 v23, v23, v103
    v_mfma_f32_16x16x32_bf16 v[212:215], v[164:167], v[172:175], v[212:215]
    v_add_f32 v24, v24, v104
    v_mfma_f32_16x16x32_bf16 v[220:223], v[164:167], v[176:179], v[220:223]
    ds_read_b128 v[152:155], v2 offset:35840
    v_add_f32 v25, v25, v105
    v_mfma_f32_16x16x32_bf16 v[224:227], v[168:171], v[172:175], v[224:227]
    v_add_f32 v26, v26, v106
    v_mfma_f32_16x16x32_bf16 v[232:235], v[168:171], v[176:179], v[232:235]
    ds_read_b128 v[156:159], v2 offset:36864
    s_waitcnt lgkmcnt(3)
    v_mfma_f32_16x16x32_bf16 v[228:231], v[136:139], v[172:175], v[228:231]
    buffer_load_dwordx4 v[200:203], v129, s[4:7], s60 offen offset:2304 sc1
    v_mfma_f32_16x16x32_bf16 v[236:239], v[136:139], v[176:179], v[236:239]
    ds_read_b128 v[160:163], v2 offset:37888
    v_add_f32 v27, v27, v107
    v_mfma_f32_16x16x32_bf16 v[240:243], v[140:143], v[172:175], v[240:243]
    v_mfma_f32_16x16x32_bf16 v[248:251], v[140:143], v[176:179], v[248:251]
    ds_read_b128 v[164:167], v2 offset:38912
    v_mfma_f32_16x16x32_bf16 v[244:247], v[144:147], v[172:175], v[244:247]
    v_mfma_f32_16x16x32_bf16 v[252:255], v[144:147], v[176:179], v[252:255]
    ds_read_b128 v[168:171], v2 offset:39936
    s_waitcnt vmcnt(6) lgkmcnt(3)
    v_mfma_f32_16x16x32_bf16 v[208:211], v[148:151], v[180:183], v[208:211]
    s_add_u32 s60, s60, 4096
    buffer_load_dwordx4 v[172:175], v129, s[4:7], s60 offen offset:0 sc1
    v_mfma_f32_16x16x32_bf16 v[216:219], v[148:151], v[184:187], v[216:219]
    ds_read_b128 v[136:139], v2 offset:40960
    v_mfma_f32_16x16x32_bf16 v[212:215], v[152:155], v[180:183], v[212:215]
    v_mfma_f32_16x16x32_bf16 v[220:223], v[152:155], v[184:187], v[220:223]
    ds_read_b128 v[140:143], v2 offset:41984
    v_mfma_f32_16x16x32_bf16 v[224:227], v[156:159], v[180:183], v[224:227]
    v_mfma_f32_16x16x32_bf16 v[232:235], v[156:159], v[184:187], v[232:235]
    ds_read_b128 v[144:147], v2 offset:43008
    s_waitcnt lgkmcnt(3)
    v_mfma_f32_16x16x32_bf16 v[228:231], v[160:163], v[180:183], v[228:231]
    buffer_load_dwordx4 v[176:179], v129, s[4:7], s60 offen offset:256 sc1
    v_mfma_f32_16x16x32_bf16 v[236:239], v[160:163], v[184:187], v[236:239]
    ds_read_b128 v[148:151], v2 offset:44032
    v_mfma_f32_16x16x32_bf16 v[240:243], v[164:167], v[180:183], v[240:243]
    v_mfma_f32_16x16x32_bf16 v[248:251], v[164:167], v[184:187], v[248:251]
    ds_read_b128 v[152:155], v2 offset:45056
    v_mfma_f32_16x16x32_bf16 v[244:247], v[168:171], v[180:183], v[244:247]
    v_mfma_f32_16x16x32_bf16 v[252:255], v[168:171], v[184:187], v[252:255]
    ds_read_b128 v[156:159], v2 offset:46080
    s_waitcnt vmcnt(4) lgkmcnt(3)
    v_mfma_f32_16x16x32_bf16 v[208:211], v[136:139], v[188:191], v[208:211]
    buffer_load_dwordx4 v[180:183], v129, s[4:7], s60 offen offset:2048 sc1
    v_mfma_f32_16x16x32_bf16 v[216:219], v[136:139], v[192:195], v[216:219]
    ds_read_b128 v[160:163], v2 offset:47104
    v_mfma_f32_16x16x32_bf16 v[212:215], v[140:143], v[188:191], v[212:215]
    v_add_f32 v134, v120, v122
    v_mfma_f32_16x16x32_bf16 v[220:223], v[140:143], v[192:195], v[220:223]
    ds_read_b128 v[164:167], v2 offset:48128
    v_add_f32 v135, v121, v123
    v_mfma_f32_16x16x32_bf16 v[224:227], v[144:147], v[188:191], v[224:227]
    v_add_f32 v124, v124, v126
    v_mfma_f32_16x16x32_bf16 v[232:235], v[144:147], v[192:195], v[232:235]
    ds_read_b128 v[168:171], v2 offset:49152
    s_waitcnt lgkmcnt(3)
    v_mfma_f32_16x16x32_bf16 v[228:231], v[148:151], v[188:191], v[228:231]
    buffer_load_dwordx4 v[184:187], v129, s[4:7], s60 offen offset:2304 sc1
    v_mfma_f32_16x16x32_bf16 v[236:239], v[148:151], v[192:195], v[236:239]
    ds_read_b128 v[136:139], v2 offset:50176
    v_add_f32 v125, v125, v127
    v_mfma_f32_16x16x32_bf16 v[240:243], v[152:155], v[188:191], v[240:243]
    v_add_f32 v134, v134, v124
    v_mfma_f32_16x16x32_bf16 v[248:251], v[152:155], v[192:195], v[248:251]
    ds_read_b128 v[140:143], v2 offset:51200
    v_add_f32 v135, v135, v125
    v_mfma_f32_16x16x32_bf16 v[244:247], v[156:159], v[188:191], v[244:247]
    v_mov_b32 v120, v134
    v_mfma_f32_16x16x32_bf16 v[252:255], v[156:159], v[192:195], v[252:255]
    ds_read_b128 v[144:147], v2 offset:52224
    s_waitcnt vmcnt(4) lgkmcnt(3)
    v_mfma_f32_16x16x32_bf16 v[208:211], v[160:163], v[196:199], v[208:211]
    s_add_u32 s60, s60, 4096
    buffer_load_dwordx4 v[188:191], v129, s[4:7], s60 offen offset:0 sc1
    v_mfma_f32_16x16x32_bf16 v[216:219], v[160:163], v[200:203], v[216:219]
    ds_read_b128 v[148:151], v2 offset:53248
    v_mov_b32 v121, v135
    v_mfma_f32_16x16x32_bf16 v[212:215], v[164:167], v[196:199], v[212:215]
    s_nop 1
    v_mfma_f32_16x16x32_bf16 v[220:223], v[164:167], v[200:203], v[220:223]
    ds_read_b128 v[152:155], v2 offset:54272
    v_permlane32_swap_b32 v134, v120
    v_mfma_f32_16x16x32_bf16 v[224:227], v[168:171], v[196:199], v[224:227]
    v_permlane32_swap_b32 v135, v121
    v_mfma_f32_16x16x32_bf16 v[232:235], v[168:171], v[200:203], v[232:235]
    ds_read_b128 v[156:159], v2 offset:55296
    s_waitcnt lgkmcnt(3)
    v_mfma_f32_16x16x32_bf16 v[228:231], v[136:139], v[196:199], v[228:231]
    buffer_load_dwordx4 v[192:195], v129, s[4:7], s60 offen offset:256 sc1
    v_mfma_f32_16x16x32_bf16 v[236:239], v[136:139], v[200:203], v[236:239]
    ds_read_b128 v[160:163], v2 offset:56320
    v_add_f32 v134, v134, v120
    v_mfma_f32_16x16x32_bf16 v[240:243], v[140:143], v[196:199], v[240:243]
    v_add_f32 v135, v135, v121
    v_mfma_f32_16x16x32_bf16 v[248:251], v[140:143], v[200:203], v[248:251]
    ds_read_b128 v[164:167], v2 offset:57344
    v_mul_f32 v134, 0x3acccccd, v134
    v_mfma_f32_16x16x32_bf16 v[244:247], v[144:147], v[196:199], v[244:247]
    v_mul_f32 v135, 0x3acccccd, v135
    v_mfma_f32_16x16x32_bf16 v[252:255], v[144:147], v[200:203], v[252:255]
    ds_read_b128 v[168:171], v2 offset:58368
    s_waitcnt vmcnt(4) lgkmcnt(3)
    s_barrier
    v_mfma_f32_16x16x32_bf16 v[208:211], v[148:151], v[172:175], v[208:211]
    buffer_load_dwordx4 v[196:199], v129, s[4:7], s60 offen offset:2048 sc1
    v_mfma_f32_16x16x32_bf16 v[216:219], v[148:151], v[176:179], v[216:219]
    ds_read_b128 v[136:139], v2 offset:59392
    v_fma_f32 v135, -v134, v134, v135
    v_mfma_f32_16x16x32_bf16 v[212:215], v[152:155], v[172:175], v[212:215]
    v_max_f32 v135, 0, v135
    v_mfma_f32_16x16x32_bf16 v[220:223], v[152:155], v[176:179], v[220:223]
    ds_read_b128 v[140:143], v2 offset:60416
    v_add_f32 v135, 0x3727c5ac, v135
    v_mfma_f32_16x16x32_bf16 v[224:227], v[156:159], v[172:175], v[224:227]
    v_rsq_f32 v132, v135
    v_mfma_f32_16x16x32_bf16 v[232:235], v[156:159], v[176:179], v[232:235]
    ds_read_b128 v[144:147], v2 offset:61440
    s_waitcnt lgkmcnt(3)
    v_mfma_f32_16x16x32_bf16 v[228:231], v[160:163], v[172:175], v[228:231]
    buffer_load_dwordx4 v[200:203], v129, s[4:7], s60 offen offset:2304 sc1
    v_mfma_f32_16x16x32_bf16 v[236:239], v[160:163], v[176:179], v[236:239]
    ds_read_b128 v[148:151], v2 offset:62464
    s_nop 0
    v_mfma_f32_16x16x32_bf16 v[240:243], v[164:167], v[172:175], v[240:243]
    v_mul_f32 v133, -1.0, v132
    v_mfma_f32_16x16x32_bf16 v[248:251], v[164:167], v[176:179], v[248:251]
    ds_read_b128 v[152:155], v2 offset:63488
    v_mul_f32 v133, v134, v133
    v_mfma_f32_16x16x32_bf16 v[244:247], v[168:171], v[172:175], v[244:247]
    v_mov_b32 v130, v132
    v_mfma_f32_16x16x32_bf16 v[252:255], v[168:171], v[176:179], v[252:255]
    ds_read_b128 v[156:159], v2 offset:64512
    s_waitcnt vmcnt(4) lgkmcnt(3)
    v_mfma_f32_16x16x32_bf16 v[208:211], v[136:139], v[180:183], v[208:211]
    s_add_u32 s60, s60, 4096
    buffer_load_dwordx4 v[172:175], v129, s[4:7], s60 offen offset:0 sc1
    v_mfma_f32_16x16x32_bf16 v[216:219], v[136:139], v[184:187], v[216:219]
    ds_read_b128 v[160:163], v3 offset:0
    v_mov_b32 v131, v133
    v_mfma_f32_16x16x32_bf16 v[212:215], v[140:143], v[180:183], v[212:215]
    s_nop 1
    v_mfma_f32_16x16x32_bf16 v[220:223], v[140:143], v[184:187], v[220:223]
    ds_read_b128 v[164:167], v3 offset:1024
    v_permlane16_swap_b32 v132, v130
    v_mfma_f32_16x16x32_bf16 v[224:227], v[144:147], v[180:183], v[224:227]
    v_permlane16_swap_b32 v133, v131
    v_mfma_f32_16x16x32_bf16 v[232:235], v[144:147], v[184:187], v[232:235]
    ds_read_b128 v[168:171], v3 offset:2048
    s_waitcnt lgkmcnt(3)
    v_mfma_f32_16x16x32_bf16 v[228:231], v[148:151], v[180:183], v[228:231]
    buffer_load_dwordx4 v[176:179], v129, s[4:7], s60 offen offset:256 sc1
    v_mfma_f32_16x16x32_bf16 v[236:239], v[148:151], v[184:187], v[236:239]
    ds_read_b128 v[136:139], v3 offset:3072
    ds_read_b128 v[120:123], v205 offset:384
    v_mfma_f32_16x16x32_bf16 v[240:243], v[152:155], v[180:183], v[240:243]
    ds_read_b128 v[124:127], v205 offset:0
    v_mfma_f32_16x16x32_bf16 v[248:251], v[152:155], v[184:187], v[248:251]
    ds_read_b128 v[140:143], v3 offset:4096
    v_mfma_f32_16x16x32_bf16 v[244:247], v[156:159], v[180:183], v[244:247]
    v_mfma_f32_16x16x32_bf16 v[252:255], v[156:159], v[184:187], v[252:255]
    ds_read_b128 v[144:147], v3 offset:5120
    s_waitcnt vmcnt(4) lgkmcnt(5)
    v_mfma_f32_16x16x32_bf16 v[208:211], v[160:163], v[188:191], v[208:211]
    buffer_load_dwordx4 v[180:183], v129, s[4:7], s60 offen offset:2048 sc1
    v_mfma_f32_16x16x32_bf16 v[216:219], v[160:163], v[192:195], v[216:219]
    ds_read_b128 v[148:151], v3 offset:6144
    v_mfma_f32_16x16x32_bf16 v[212:215], v[164:167], v[188:191], v[212:215]
    v_mfma_f32_16x16x32_bf16 v[220:223], v[164:167], v[192:195], v[220:223]
    ds_read_b128 v[152:155], v3 offset:7168
    v_mfma_f32_16x16x32_bf16 v[224:227], v[168:171], v[188:191], v[224:227]
    v_mfma_f32_16x16x32_bf16 v[232:235], v[168:171], v[192:195], v[232:235]
    ds_read_b128 v[156:159], v3 offset:8192
    s_waitcnt lgkmcnt(3)
    v_mfma_f32_16x16x32_bf16 v[228:231], v[136:139], v[188:191], v[228:231]
    buffer_load_dwordx4 v[184:187], v129, s[4:7], s60 offen offset:2304 sc1
    v_mfma_f32_16x16x32_bf16 v[236:239], v[136:139], v[192:195], v[236:239]
    ds_read_b128 v[160:163], v3 offset:9216
    v_mfma_f32_16x16x32_bf16 v[240:243], v[140:143], v[188:191], v[240:243]
    v_mfma_f32_16x16x32_bf16 v[248:251], v[140:143], v[192:195], v[248:251]
    ds_read_b128 v[164:167], v3 offset:10240
    v_mfma_f32_16x16x32_bf16 v[244:247], v[144:147], v[188:191], v[244:247]
    v_mfma_f32_16x16x32_bf16 v[252:255], v[144:147], v[192:195], v[252:255]
    ds_read_b128 v[168:171], v3 offset:11264
    s_waitcnt vmcnt(4) lgkmcnt(3)
    v_mfma_f32_16x16x32_bf16 v[208:211], v[148:151], v[196:199], v[208:211]
    s_add_u32 s60, s60, 4096
    buffer_load_dwordx4 v[188:191], v129, s[4:7], s60 offen offset:0 sc1
    v_mfma_f32_16x16x32_bf16 v[216:219], v[148:151], v[200:203], v[216:219]
    ds_read_b128 v[136:139], v3 offset:12288
    v_mfma_f32_16x16x32_bf16 v[212:215], v[152:155], v[196:199], v[212:215]
    v_fma_f32 v88, v124, v133, v120
    v_mfma_f32_16x16x32_bf16 v[220:223], v[152:155], v[200:203], v[220:223]
    ds_read_b128 v[140:143], v3 offset:13312
    v_fma_f32 v89, v125, v133, v121
    v_mfma_f32_16x16x32_bf16 v[224:227], v[156:159], v[196:199], v[224:227]
    v_fma_f32 v90, v126, v133, v122
    v_mfma_f32_16x16x32_bf16 v[232:235], v[156:159], v[200:203], v[232:235]
    ds_read_b128 v[144:147], v3 offset:14336
    v_fma_f32 v91, v127, v133, v123
    s_waitcnt lgkmcnt(3)
    v_mfma_f32_16x16x32_bf16 v[228:231], v[160:163], v[196:199], v[228:231]
    buffer_load_dwordx4 v[192:195], v129, s[4:7], s60 offen offset:256 sc1
    v_mfma_f32_16x16x32_bf16 v[236:239], v[160:163], v[200:203], v[236:239]
    ds_read_b128 v[148:151], v3 offset:15360
    v_fma_f32 v96, v124, v131, v120
    v_mfma_f32_16x16x32_bf16 v[240:243], v[164:167], v[196:199], v[240:243]
    v_fma_f32 v97, v125, v131, v121
    v_mfma_f32_16x16x32_bf16 v[248:251], v[164:167], v[200:203], v[248:251]
    ds_read_b128 v[152:155], v3 offset:16384
    v_fma_f32 v98, v126, v131, v122
    v_mfma_f32_16x16x32_bf16 v[244:247], v[168:171], v[196:199], v[244:247]
    v_fma_f32 v99, v127, v131, v123
    v_mfma_f32_16x16x32_bf16 v[252:255], v[168:171], v[200:203], v[252:255]
    ds_read_b128 v[156:159], v3 offset:17408
    s_waitcnt vmcnt(4) lgkmcnt(3)
    v_mfma_f32_16x16x32_bf16 v[208:211], v[136:139], v[172:175], v[208:211]
    buffer_load_dwordx4 v[196:199], v129, s[4:7], s60 offen offset:2048 sc1
    v_mfma_f32_16x16x32_bf16 v[216:219], v[136:139], v[176:179], v[216:219]
    ds_read_b128 v[160:163], v3 offset:18432
    ds_read_b128 v[120:123], v205 offset:400
    v_mfma_f32_16x16x32_bf16 v[212:215], v[140:143], v[172:175], v[212:215]
    ds_read_b128 v[124:127], v205 offset:16
    v_mfma_f32_16x16x32_bf16 v[220:223], v[140:143], v[176:179], v[220:223]
    ds_read_b128 v[164:167], v3 offset:19456
    v_mfma_f32_16x16x32_bf16 v[224:227], v[144:147], v[172:175], v[224:227]
    v_mfma_f32_16x16x32_bf16 v[232:235], v[144:147], v[176:179], v[232:235]
    ds_read_b128 v[168:171], v3 offset:20480
    s_waitcnt lgkmcnt(5)
    v_mfma_f32_16x16x32_bf16 v[228:231], v[148:151], v[172:175], v[228:231]
    buffer_load_dwordx4 v[200:203], v129, s[4:7], s60 offen offset:2304 sc1
    v_mfma_f32_16x16x32_bf16 v[236:239], v[148:151], v[176:179], v[236:239]
    ds_read_b128 v[136:139], v3 offset:21504
    v_mfma_f32_16x16x32_bf16 v[240:243], v[152:155], v[172:175], v[240:243]
    v_mfma_f32_16x16x32_bf16 v[248:251], v[152:155], v[176:179], v[248:251]
    ds_read_b128 v[140:143], v3 offset:22528
    v_mfma_f32_16x16x32_bf16 v[244:247], v[156:159], v[172:175], v[244:247]
    v_mfma_f32_16x16x32_bf16 v[252:255], v[156:159], v[176:179], v[252:255]
    ds_read_b128 v[144:147], v3 offset:23552
    s_waitcnt vmcnt(4) lgkmcnt(3)
    v_mfma_f32_16x16x32_bf16 v[208:211], v[160:163], v[180:183], v[208:211]
    s_add_u32 s60, s60, 4096
    buffer_load_dwordx4 v[172:175], v129, s[4:7], s60 offen offset:0 sc1
    v_mfma_f32_16x16x32_bf16 v[216:219], v[160:163], v[184:187], v[216:219]
    ds_read_b128 v[148:151], v3 offset:24576
    v_mfma_f32_16x16x32_bf16 v[212:215], v[164:167], v[180:183], v[212:215]
    v_mfma_f32_16x16x32_bf16 v[220:223], v[164:167], v[184:187], v[220:223]
    ds_read_b128 v[152:155], v3 offset:25600
    v_mfma_f32_16x16x32_bf16 v[224:227], v[168:171], v[180:183], v[224:227]
    v_mfma_f32_16x16x32_bf16 v[232:235], v[168:171], v[184:187], v[232:235]
    ds_read_b128 v[156:159], v3 offset:26624
    s_waitcnt lgkmcnt(3)
    v_mfma_f32_16x16x32_bf16 v[228:231], v[136:139], v[180:183], v[228:231]
    buffer_load_dwordx4 v[176:179], v129, s[4:7], s60 offen offset:256 sc1
    v_mfma_f32_16x16x32_bf16 v[236:239], v[136:139], v[184:187], v[236:239]
    ds_read_b128 v[160:163], v3 offset:27648
    v_mfma_f32_16x16x32_bf16 v[240:243], v[140:143], v[180:183], v[240:243]
    v_fma_f32 v92, v124, v133, v120
    v_mfma_f32_16x16x32_bf16 v[248:251], v[140:143], v[184:187], v[248:251]
    ds_read_b128 v[164:167], v3 offset:28672
    v_fma_f32 v93, v125, v133, v121
    v_mfma_f32_16x16x32_bf16 v[244:247], v[144:147], v[180:183], v[244:247]
    v_fma_f32 v94, v126, v133, v122
    v_mfma_f32_16x16x32_bf16 v[252:255], v[144:147], v[184:187], v[252:255]
    ds_read_b128 v[168:171], v3 offset:29696
    v_fma_f32 v95, v127, v133, v123
    s_waitcnt vmcnt(4) lgkmcnt(3)
    v_mfma_f32_16x16x32_bf16 v[208:211], v[148:151], v[188:191], v[208:211]
    buffer_load_dwordx4 v[180:183], v129, s[4:7], s60 offen offset:2048 sc1
    v_mfma_f32_16x16x32_bf16 v[216:219], v[148:151], v[192:195], v[216:219]
    ds_read_b128 v[136:139], v3 offset:30720
    v_fma_f32 v100, v124, v131, v120
    v_mfma_f32_16x16x32_bf16 v[212:215], v[152:155], v[188:191], v[212:215]
    v_fma_f32 v101, v125, v131, v121
    v_mfma_f32_16x16x32_bf16 v[220:223], v[152:155], v[192:195], v[220:223]
    ds_read_b128 v[140:143], v3 offset:31744
    v_fma_f32 v102, v126, v131, v122
    v_mfma_f32_16x16x32_bf16 v[224:227], v[156:159], v[188:191], v[224:227]
    v_fma_f32 v103, v127, v131, v123
    v_mfma_f32_16x16x32_bf16 v[232:235], v[156:159], v[192:195], v[232:235]
    ds_read_b128 v[144:147], v3 offset:32768
    s_waitcnt lgkmcnt(3)
    v_mfma_f32_16x16x32_bf16 v[228:231], v[160:163], v[188:191], v[228:231]
    buffer_load_dwordx4 v[184:187], v129, s[4:7], s60 offen offset:2304 sc1
    v_mfma_f32_16x16x32_bf16 v[236:239], v[160:163], v[192:195], v[236:239]
    ds_read_b128 v[148:151], v3 offset:33792
    ds_read_b128 v[120:123], v205 offset:512
    v_mfma_f32_16x16x32_bf16 v[240:243], v[164:167], v[188:191], v[240:243]
    ds_read_b128 v[124:127], v205 offset:128
    v_mfma_f32_16x16x32_bf16 v[248:251], v[164:167], v[192:195], v[248:251]
    ds_read_b128 v[152:155], v3 offset:34816
    v_mfma_f32_16x16x32_bf16 v[244:247], v[168:171], v[188:191], v[244:247]
    v_mfma_f32_16x16x32_bf16 v[252:255], v[168:171], v[192:195], v[252:255]
    ds_read_b128 v[156:159], v3 offset:35840
    s_waitcnt vmcnt(4) lgkmcnt(5)
    v_mfma_f32_16x16x32_bf16 v[208:211], v[136:139], v[196:199], v[208:211]
    s_add_u32 s60, s60, 4096
    buffer_load_dwordx4 v[188:191], v129, s[4:7], s60 offen offset:0 sc1
    v_mfma_f32_16x16x32_bf16 v[216:219], v[136:139], v[200:203], v[216:219]
    ds_read_b128 v[160:163], v3 offset:36864
    v_mfma_f32_16x16x32_bf16 v[212:215], v[140:143], v[196:199], v[212:215]
    v_mfma_f32_16x16x32_bf16 v[220:223], v[140:143], v[200:203], v[220:223]
    ds_read_b128 v[164:167], v3 offset:37888
    v_mfma_f32_16x16x32_bf16 v[224:227], v[144:147], v[196:199], v[224:227]
    v_mfma_f32_16x16x32_bf16 v[232:235], v[144:147], v[200:203], v[232:235]
    ds_read_b128 v[168:171], v3 offset:38912
    s_waitcnt lgkmcnt(3)
    s_barrier
    v_mfma_f32_16x16x32_bf16 v[228:231], v[148:151], v[196:199], v[228:231]
    buffer_load_dwordx4 v[192:195], v129, s[4:7], s60 offen offset:256 sc1
    v_mfma_f32_16x16x32_bf16 v[236:239], v[148:151], v[200:203], v[236:239]
    ds_read_b128 v[136:139], v3 offset:39936
    v_mfma_f32_16x16x32_bf16 v[240:243], v[152:155], v[196:199], v[240:243]
    v_mfma_f32_16x16x32_bf16 v[248:251], v[152:155], v[200:203], v[248:251]
    ds_read_b128 v[140:143], v3 offset:40960
    v_mfma_f32_16x16x32_bf16 v[244:247], v[156:159], v[196:199], v[244:247]
    v_mfma_f32_16x16x32_bf16 v[252:255], v[156:159], v[200:203], v[252:255]
    ds_read_b128 v[144:147], v3 offset:41984
    s_waitcnt vmcnt(4) lgkmcnt(3)
    v_mfma_f32_16x16x32_bf16 v[208:211], v[160:163], v[172:175], v[208:211]
    buffer_load_dwordx4 v[196:199], v129, s[4:7], s60 offen offset:2048 sc1
    v_mfma_f32_16x16x32_bf16 v[216:219], v[160:163], v[176:179], v[216:219]
    ds_read_b128 v[148:151], v3 offset:43008
    v_mfma_f32_16x16x32_bf16 v[212:215], v[164:167], v[172:175], v[212:215]
    v_fma_f32 v104, v124, v133, v120
    v_mfma_f32_16x16x32_bf16 v[220:223], v[164:167], v[176:179], v[220:223]
    ds_read_b128 v[152:155], v3 offset:44032
    v_fma_f32 v105, v125, v133, v121
    v_mfma_f32_16x16x32_bf16 v[224:227], v[168:171], v[172:175], v[224:227]
    v_fma_f32 v106, v126, v133, v122
    v_mfma_f32_16x16x32_bf16 v[232:235], v[168:171], v[176:179], v[232:235]
    ds_read_b128 v[156:159], v3 offset:45056
    v_fma_f32 v107, v127, v133, v123
    s_waitcnt lgkmcnt(3)
    v_mfma_f32_16x16x32_bf16 v[228:231], v[136:139], v[172:175], v[228:231]
    buffer_load_dwordx4 v[200:203], v129, s[4:7], s60 offen offset:2304 sc1
    v_mfma_f32_16x16x32_bf16 v[236:239], v[136:139], v[176:179], v[236:239]
    ds_read_b128 v[160:163], v3 offset:46080
    v_fma_f32 v112, v124, v131, v120
    v_mfma_f32_16x16x32_bf16 v[240:243], v[140:143], v[172:175], v[240:243]
    v_fma_f32 v113, v125, v131, v121
    v_mfma_f32_16x16x32_bf16 v[248:251], v[140:143], v[176:179], v[248:251]
    ds_read_b128 v[164:167], v3 offset:47104
    v_fma_f32 v114, v126, v131, v122
    v_mfma_f32_16x16x32_bf16 v[244:247], v[144:147], v[172:175], v[244:247]
    v_fma_f32 v115, v127, v131, v123
    v_mfma_f32_16x16x32_bf16 v[252:255], v[144:147], v[176:179], v[252:255]
    ds_read_b128 v[168:171], v3 offset:48128
    s_waitcnt vmcnt(4) lgkmcnt(3)
    v_mfma_f32_16x16x32_bf16 v[208:211], v[148:151], v[180:183], v[208:211]
    v_mfma_f32_16x16x32_bf16 v[216:219], v[148:151], v[184:187], v[216:219]
    ds_read_b128 v[136:139], v3 offset:49152
    ds_read_b128 v[120:123], v205 offset:528
    v_mfma_f32_16x16x32_bf16 v[212:215], v[152:155], v[180:183], v[212:215]
    ds_read_b128 v[124:127], v205 offset:144
    v_mfma_f32_16x16x32_bf16 v[220:223], v[152:155], v[184:187], v[220:223]
    ds_read_b128 v[140:143], v3 offset:50176
    v_mfma_f32_16x16x32_bf16 v[224:227], v[156:159], v[180:183], v[224:227]
    v_mfma_f32_16x16x32_bf16 v[232:235], v[156:159], v[184:187], v[232:235]
    ds_read_b128 v[144:147], v3 offset:51200
    s_waitcnt lgkmcnt(5)
    v_mfma_f32_16x16x32_bf16 v[228:231], v[160:163], v[180:183], v[228:231]
    v_mfma_f32_16x16x32_bf16 v[236:239], v[160:163], v[184:187], v[236:239]
    ds_read_b128 v[148:151], v3 offset:52224
    v_mfma_f32_16x16x32_bf16 v[240:243], v[164:167], v[180:183], v[240:243]
    v_mfma_f32_16x16x32_bf16 v[248:251], v[164:167], v[184:187], v[248:251]
    ds_read_b128 v[152:155], v3 offset:53248
    v_mfma_f32_16x16x32_bf16 v[244:247], v[168:171], v[180:183], v[244:247]
    v_mfma_f32_16x16x32_bf16 v[252:255], v[168:171], v[184:187], v[252:255]
    ds_read_b128 v[156:159], v3 offset:54272
    s_waitcnt vmcnt(2) lgkmcnt(3)
    v_mfma_f32_16x16x32_bf16 v[208:211], v[136:139], v[188:191], v[208:211]
    v_mfma_f32_16x16x32_bf16 v[216:219], v[136:139], v[192:195], v[216:219]
    ds_read_b128 v[160:163], v3 offset:55296
    v_mfma_f32_16x16x32_bf16 v[212:215], v[140:143], v[188:191], v[212:215]
    v_mfma_f32_16x16x32_bf16 v[220:223], v[140:143], v[192:195], v[220:223]
    ds_read_b128 v[164:167], v3 offset:56320
    v_mfma_f32_16x16x32_bf16 v[224:227], v[144:147], v[188:191], v[224:227]
    v_mfma_f32_16x16x32_bf16 v[232:235], v[144:147], v[192:195], v[232:235]
    ds_read_b128 v[168:171], v3 offset:57344
    s_waitcnt lgkmcnt(3)
    v_mfma_f32_16x16x32_bf16 v[228:231], v[148:151], v[188:191], v[228:231]
    v_mfma_f32_16x16x32_bf16 v[236:239], v[148:151], v[192:195], v[236:239]
    ds_read_b128 v[136:139], v3 offset:58368
    v_mfma_f32_16x16x32_bf16 v[240:243], v[152:155], v[188:191], v[240:243]
    v_fma_f32 v108, v124, v133, v120
    v_mfma_f32_16x16x32_bf16 v[248:251], v[152:155], v[192:195], v[248:251]
    ds_read_b128 v[140:143], v3 offset:59392
    v_fma_f32 v109, v125, v133, v121
    v_mfma_f32_16x16x32_bf16 v[244:247], v[156:159], v[188:191], v[244:247]
    v_fma_f32 v110, v126, v133, v122
    v_mfma_f32_16x16x32_bf16 v[252:255], v[156:159], v[192:195], v[252:255]
    ds_read_b128 v[144:147], v3 offset:60416
    v_fma_f32 v111, v127, v133, v123
    s_waitcnt vmcnt(0) lgkmcnt(3)
    v_mfma_f32_16x16x32_bf16 v[208:211], v[160:163], v[196:199], v[208:211]
    v_mfma_f32_16x16x32_bf16 v[216:219], v[160:163], v[200:203], v[216:219]
    v_fma_f32 v116, v124, v131, v120
    v_mfma_f32_16x16x32_bf16 v[212:215], v[164:167], v[196:199], v[212:215]
    v_fma_f32 v117, v125, v131, v121
    v_mfma_f32_16x16x32_bf16 v[220:223], v[164:167], v[200:203], v[220:223]
    v_fma_f32 v118, v126, v131, v122
    v_mfma_f32_16x16x32_bf16 v[224:227], v[168:171], v[196:199], v[224:227]
    v_fma_f32 v119, v127, v131, v123
    v_mfma_f32_16x16x32_bf16 v[232:235], v[168:171], v[200:203], v[232:235]
    s_waitcnt lgkmcnt(0)
    v_mfma_f32_16x16x32_bf16 v[228:231], v[136:139], v[196:199], v[228:231]
    v_mfma_f32_16x16x32_bf16 v[236:239], v[136:139], v[200:203], v[236:239]
    v_mfma_f32_16x16x32_bf16 v[240:243], v[140:143], v[196:199], v[240:243]
    v_mfma_f32_16x16x32_bf16 v[248:251], v[140:143], v[200:203], v[248:251]
    v_mfma_f32_16x16x32_bf16 v[244:247], v[144:147], v[196:199], v[244:247]
    v_mfma_f32_16x16x32_bf16 v[252:255], v[144:147], v[200:203], v[252:255]
    s_barrier
    ds_read_b128 v[136:139], v205 offset:256
    ds_read_b128 v[144:147], v205 offset:640
    ds_read_b128 v[140:143], v205 offset:272
    ds_read_b128 v[148:151], v205 offset:656
    s_and_b32 s44, s26, 1
    s_mul_i32 s45, s44, 5120
    v_add_u32 v196, s45, v2
    v_add_u32 v197, s45, v3
    v_add_u32 v198, s45, v4
    s_xor_b32 s45, s44, 1
    s_mul_i32 s45, s45, 156672
    v_add_u32 v199, s45, v2
    s_lshl_b32 s44, s44, 10
    s_add_u32 s44, s44, 3080192
    s_mul_i32 s60, s31, 49152
    s_add_u32 s60, s60, s44
    s_xor_b32 s45, s31, 1
    s_mul_i32 s98, s45, 49152
    s_add_u32 s98, s98, s44
    v_pk_fma_f32 v[208:209], v[208:209], v[132:133], v[88:89] op_sel_hi:[1,0,1]
    v_pk_fma_f32 v[210:211], v[210:211], v[132:133], v[90:91] op_sel_hi:[1,0,1]
    v_pk_fma_f32 v[212:213], v[212:213], v[132:133], v[92:93] op_sel_hi:[1,0,1]
    v_pk_fma_f32 v[214:215], v[214:215], v[132:133], v[94:95] op_sel_hi:[1,0,1]
    v_pk_mul_f32 v[168:169], v[208:209], v[208:209]
    v_pk_mul_f32 v[170:171], v[210:211], v[210:211]
    v_pk_mul_f32 v[172:173], v[212:213], v[212:213]
    v_pk_mul_f32 v[174:175], v[214:215], v[214:215]
    v_pk_fma_f32 v[168:169], v[168:169], s[56:57], v[206:207]
    v_pk_fma_f32 v[170:171], v[170:171], s[56:57], v[206:207]
    v_pk_fma_f32 v[172:173], v[172:173], s[56:57], v[206:207]
    v_pk_fma_f32 v[174:175], v[174:175], s[56:57], v[206:207]
    v_pk_mul_f32 v[176:177], v[168:169], v[208:209]
    v_pk_mul_f32 v[178:179], v[170:171], v[210:211]
    v_pk_mul_f32 v[180:181], v[172:173], v[212:213]
    v_pk_mul_f32 v[182:183], v[174:175], v[214:215]
    v_exp_f32 v176, v176
    v_exp_f32 v177, v177
    v_exp_f32 v178, v178
    v_exp_f32 v179, v179
    v_exp_f32 v180, v180
    v_exp_f32 v181, v181
    v_exp_f32 v182, v182
    v_exp_f32 v183, v183
    v_pk_add_f32 v[176:177], v[176:177], 1.0 op_sel_hi:[1,0]
    v_pk_add_f32 v[178:179], v[178:179], 1.0 op_sel_hi:[1,0]
    v_pk_add_f32 v[180:181], v[180:181], 1.0 op_sel_hi:[1,0]
    v_pk_add_f32 v[182:183], v[182:183], 1.0 op_sel_hi:[1,0]
    v_rcp_f32 v176, v176
    v_rcp_f32 v177, v177
    v_rcp_f32 v178, v178
    v_rcp_f32 v179, v179
    v_rcp_f32 v180, v180
    v_rcp_f32 v181, v181
    v_rcp_f32 v182, v182
    v_rcp_f32 v183, v183
    v_pk_mul_f32 v[208:209], v[208:209], v[176:177]
    v_pk_mul_f32 v[210:211], v[210:211], v[178:179]
    v_pk_mul_f32 v[212:213], v[212:213], v[180:181]
    v_pk_mul_f32 v[214:215], v[214:215], v[182:183]
    v_cvt_pk_bf16_f32 v184, v208, v209
    v_cvt_pk_bf16_f32 v185, v210, v211
    v_cvt_pk_bf16_f32 v186, v212, v213
    v_cvt_pk_bf16_f32 v187, v214, v215
    buffer_store_dwordx4 v[184:187], v2, s[4:7], s59 offen sc1
    v_pk_fma_f32 v[216:217], v[216:217], v[130:131], v[96:97] op_sel_hi:[1,0,1]
    v_pk_fma_f32 v[218:219], v[218:219], v[130:131], v[98:99] op_sel_hi:[1,0,1]
    v_pk_fma_f32 v[220:221], v[220:221], v[130:131], v[100:101] op_sel_hi:[1,0,1]
    v_pk_fma_f32 v[222:223], v[222:223], v[130:131], v[102:103] op_sel_hi:[1,0,1]
    v_pk_mul_f32 v[168:169], v[216:217], v[216:217]
    v_pk_mul_f32 v[170:171], v[218:219], v[218:219]
    v_pk_mul_f32 v[172:173], v[220:221], v[220:221]
    v_pk_mul_f32 v[174:175], v[222:223], v[222:223]
    v_pk_fma_f32 v[168:169], v[168:169], s[56:57], v[206:207]
    v_pk_fma_f32 v[170:171], v[170:171], s[56:57], v[206:207]
    v_pk_fma_f32 v[172:173], v[172:173], s[56:57], v[206:207]
    v_pk_fma_f32 v[174:175], v[174:175], s[56:57], v[206:207]
    v_pk_mul_f32 v[176:177], v[168:169], v[216:217]
    v_pk_mul_f32 v[178:179], v[170:171], v[218:219]
    v_pk_mul_f32 v[180:181], v[172:173], v[220:221]
    v_pk_mul_f32 v[182:183], v[174:175], v[222:223]
    v_exp_f32 v176, v176
    v_exp_f32 v177, v177
    v_exp_f32 v178, v178
    v_exp_f32 v179, v179
    v_exp_f32 v180, v180
    v_exp_f32 v181, v181
    v_exp_f32 v182, v182
    v_exp_f32 v183, v183
    v_pk_add_f32 v[176:177], v[176:177], 1.0 op_sel_hi:[1,0]
    v_pk_add_f32 v[178:179], v[178:179], 1.0 op_sel_hi:[1,0]
    v_pk_add_f32 v[180:181], v[180:181], 1.0 op_sel_hi:[1,0]
    v_pk_add_f32 v[182:183], v[182:183], 1.0 op_sel_hi:[1,0]
    v_rcp_f32 v176, v176
    v_rcp_f32 v177, v177
    v_rcp_f32 v178, v178
    v_rcp_f32 v179, v179
    v_rcp_f32 v180, v180
    v_rcp_f32 v181, v181
    v_rcp_f32 v182, v182
    v_rcp_f32 v183, v183
    v_pk_mul_f32 v[216:217], v[216:217], v[176:177]
    v_pk_mul_f32 v[218:219], v[218:219], v[178:179]
    v_pk_mul_f32 v[220:221], v[220:221], v[180:181]
    v_pk_mul_f32 v[222:223], v[222:223], v[182:183]
    v_cvt_pk_bf16_f32 v188, v216, v217
    v_cvt_pk_bf16_f32 v189, v218, v219
    v_cvt_pk_bf16_f32 v190, v220, v221
    v_cvt_pk_bf16_f32 v191, v222, v223
    buffer_store_dwordx4 v[188:191], v204, s[4:7], s59 offen sc1
    s_add_u32 s59, s59, 16384
    v_pk_fma_f32 v[224:225], v[224:225], v[132:133], v[104:105] op_sel_hi:[1,0,1]
    v_pk_fma_f32 v[226:227], v[226:227], v[132:133], v[106:107] op_sel_hi:[1,0,1]
    v_pk_fma_f32 v[228:229], v[228:229], v[132:133], v[108:109] op_sel_hi:[1,0,1]
    v_pk_fma_f32 v[230:231], v[230:231], v[132:133], v[110:111] op_sel_hi:[1,0,1]
    v_pk_mul_f32 v[168:169], v[224:225], v[224:225]
    v_pk_mul_f32 v[170:171], v[226:227], v[226:227]
    v_pk_mul_f32 v[172:173], v[228:229], v[228:229]
    v_pk_mul_f32 v[174:175], v[230:231], v[230:231]
    v_pk_fma_f32 v[168:169], v[168:169], s[56:57], v[206:207]
    v_pk_fma_f32 v[170:171], v[170:171], s[56:57], v[206:207]
    v_pk_fma_f32 v[172:173], v[172:173], s[56:57], v[206:207]
    v_pk_fma_f32 v[174:175], v[174:175], s[56:57], v[206:207]
    v_pk_mul_f32 v[176:177], v[168:169], v[224:225]
    v_pk_mul_f32 v[178:179], v[170:171], v[226:227]
    v_pk_mul_f32 v[180:181], v[172:173], v[228:229]
    v_pk_mul_f32 v[182:183], v[174:175], v[230:231]
    v_exp_f32 v176, v176
    v_exp_f32 v177, v177
    v_exp_f32 v178, v178
    v_exp_f32 v179, v179
    v_exp_f32 v180, v180
    v_exp_f32 v181, v181
    v_exp_f32 v182, v182
    v_exp_f32 v183, v183
    v_pk_add_f32 v[176:177], v[176:177], 1.0 op_sel_hi:[1,0]
    v_pk_add_f32 v[178:179], v[178:179], 1.0 op_sel_hi:[1,0]
    v_pk_add_f32 v[180:181], v[180:181], 1.0 op_sel_hi:[1,0]
    v_pk_add_f32 v[182:183], v[182:183], 1.0 op_sel_hi:[1,0]
    v_rcp_f32 v176, v176
    v_rcp_f32 v177, v177
    v_rcp_f32 v178, v178
    v_rcp_f32 v179, v179
    v_rcp_f32 v180, v180
    v_rcp_f32 v181, v181
    v_rcp_f32 v182, v182
    v_rcp_f32 v183, v183
    v_pk_mul_f32 v[224:225], v[224:225], v[176:177]
    v_pk_mul_f32 v[226:227], v[226:227], v[178:179]
    v_pk_mul_f32 v[228:229], v[228:229], v[180:181]
    v_pk_mul_f32 v[230:231], v[230:231], v[182:183]
    v_cvt_pk_bf16_f32 v184, v224, v225
    v_cvt_pk_bf16_f32 v185, v226, v227
    v_cvt_pk_bf16_f32 v186, v228, v229
    v_cvt_pk_bf16_f32 v187, v230, v231
    buffer_store_dwordx4 v[184:187], v2, s[4:7], s59 offen sc1
    v_pk_fma_f32 v[232:233], v[232:233], v[130:131], v[112:113] op_sel_hi:[1,0,1]
    v_pk_fma_f32 v[234:235], v[234:235], v[130:131], v[114:115] op_sel_hi:[1,0,1]
    v_pk_fma_f32 v[236:237], v[236:237], v[130:131], v[116:117] op_sel_hi:[1,0,1]
    v_pk_fma_f32 v[238:239], v[238:239], v[130:131], v[118:119] op_sel_hi:[1,0,1]
    v_pk_mul_f32 v[168:169], v[232:233], v[232:233]
    v_pk_mul_f32 v[170:171], v[234:235], v[234:235]
    v_pk_mul_f32 v[172:173], v[236:237], v[236:237]
    v_pk_mul_f32 v[174:175], v[238:239], v[238:239]
    v_pk_fma_f32 v[168:169], v[168:169], s[56:57], v[206:207]
    v_pk_fma_f32 v[170:171], v[170:171], s[56:57], v[206:207]
    v_pk_fma_f32 v[172:173], v[172:173], s[56:57], v[206:207]
    v_pk_fma_f32 v[174:175], v[174:175], s[56:57], v[206:207]
    v_pk_mul_f32 v[176:177], v[168:169], v[232:233]
    v_pk_mul_f32 v[178:179], v[170:171], v[234:235]
    v_pk_mul_f32 v[180:181], v[172:173], v[236:237]
    v_pk_mul_f32 v[182:183], v[174:175], v[238:239]
    v_exp_f32 v176, v176
    v_exp_f32 v177, v177
    v_exp_f32 v178, v178
    v_exp_f32 v179, v179
    v_exp_f32 v180, v180
    v_exp_f32 v181, v181
    v_exp_f32 v182, v182
    v_exp_f32 v183, v183
    s_waitcnt vmcnt(1)
    s_add_u32 s58, s58, 1
    v_mov_b32 v192, 0
    v_mov_b32 v193, s58
    s_mov_b64 exec, 1
    buffer_store_dword v193, v192, s[4:7], s61 offen sc1
    s_mov_b64 exec, -1
    v_pk_add_f32 v[176:177], v[176:177], 1.0 op_sel_hi:[1,0]
    v_pk_add_f32 v[178:179], v[178:179], 1.0 op_sel_hi:[1,0]
    v_pk_add_f32 v[180:181], v[180:181], 1.0 op_sel_hi:[1,0]
    v_pk_add_f32 v[182:183], v[182:183], 1.0 op_sel_hi:[1,0]
    v_rcp_f32 v176, v176
    v_rcp_f32 v177, v177
    v_rcp_f32 v178, v178
    v_rcp_f32 v179, v179
    v_rcp_f32 v180, v180
    v_rcp_f32 v181, v181
    v_rcp_f32 v182, v182
    v_rcp_f32 v183, v183
    v_pk_mul_f32 v[232:233], v[232:233], v[176:177]
    v_pk_mul_f32 v[234:235], v[234:235], v[178:179]
    v_pk_mul_f32 v[236:237], v[236:237], v[180:181]
    v_pk_mul_f32 v[238:239], v[238:239], v[182:183]
    v_cvt_pk_bf16_f32 v188, v232, v233
    v_cvt_pk_bf16_f32 v189, v234, v235
    v_cvt_pk_bf16_f32 v190, v236, v237
    v_cvt_pk_bf16_f32 v191, v238, v239
    buffer_store_dwordx4 v[188:191], v204, s[4:7], s59 offen sc1
    s_add_u32 s59, s59, 16384
    s_waitcnt lgkmcnt(0)
    v_pk_fma_f32 v[152:153], v[136:137], v[132:133], v[144:145] op_sel:[0,1,0] op_sel_hi:[1,1,1]
    v_pk_fma_f32 v[154:155], v[138:139], v[132:133], v[146:147] op_sel:[0,1,0] op_sel_hi:[1,1,1]
    v_pk_fma_f32 v[156:157], v[140:141], v[132:133], v[148:149] op_sel:[0,1,0] op_sel_hi:[1,1,1]
    v_pk_fma_f32 v[158:159], v[142:143], v[132:133], v[150:151] op_sel:[0,1,0] op_sel_hi:[1,1,1]
    v_pk_fma_f32 v[240:241], v[240:241], v[132:133], v[152:153] op_sel_hi:[1,0,1]
    v_pk_fma_f32 v[242:243], v[242:243], v[132:133], v[154:155] op_sel_hi:[1,0,1]
    v_pk_fma_f32 v[244:245], v[244:245], v[132:133], v[156:157] op_sel_hi:[1,0,1]
    v_pk_fma_f32 v[246:247], v[246:247], v[132:133], v[158:159] op_sel_hi:[1,0,1]
    v_pk_mul_f32 v[168:169], v[240:241], v[240:241]
    v_pk_mul_f32 v[170:171], v[242:243], v[242:243]
    v_pk_mul_f32 v[172:173], v[244:245], v[244:245]
    v_pk_mul_f32 v[174:175], v[246:247], v[246:247]
    v_pk_fma_f32 v[168:169], v[168:169], s[56:57], v[206:207]
    v_pk_fma_f32 v[170:171], v[170:171], s[56:57], v[206:207]
    v_pk_fma_f32 v[172:173], v[172:173], s[56:57], v[206:207]
    v_pk_fma_f32 v[174:175], v[174:175], s[56:57], v[206:207]
    v_pk_mul_f32 v[176:177], v[168:169], v[240:241]
    v_pk_mul_f32 v[178:179], v[170:171], v[242:243]
    v_pk_mul_f32 v[180:181], v[172:173], v[244:245]
    v_pk_mul_f32 v[182:183], v[174:175], v[246:247]
    v_exp_f32 v176, v176
    v_exp_f32 v177, v177
    v_exp_f32 v178, v178
    v_exp_f32 v179, v179
    v_exp_f32 v180, v180
    v_exp_f32 v181, v181
    v_exp_f32 v182, v182
    v_exp_f32 v183, v183
    v_pk_add_f32 v[176:177], v[176:177], 1.0 op_sel_hi:[1,0]
    v_pk_add_f32 v[178:179], v[178:179], 1.0 op_sel_hi:[1,0]
    v_pk_add_f32 v[180:181], v[180:181], 1.0 op_sel_hi:[1,0]
    v_pk_add_f32 v[182:183], v[182:183], 1.0 op_sel_hi:[1,0]
    v_rcp_f32 v176, v176
    v_rcp_f32 v177, v177
    v_rcp_f32 v178, v178
    v_rcp_f32 v179, v179
    v_rcp_f32 v180, v180
    v_rcp_f32 v181, v181
    v_rcp_f32 v182, v182
    v_rcp_f32 v183, v183
    buffer_load_dword v194, v47, s[4:7], s62 offen sc1
    v_pk_mul_f32 v[240:241], v[240:241], v[176:177]
    v_pk_mul_f32 v[242:243], v[242:243], v[178:179]
    v_pk_mul_f32 v[244:245], v[244:245], v[180:181]
    v_pk_mul_f32 v[246:247], v[246:247], v[182:183]
    v_cvt_pk_bf16_f32 v184, v240, v241
    v_cvt_pk_bf16_f32 v185, v242, v243
    v_cvt_pk_bf16_f32 v186, v244, v245
    v_cvt_pk_bf16_f32 v187, v246, v247
    buffer_store_dwordx4 v[184:187], v2, s[4:7], s59 offen sc1
    v_pk_fma_f32 v[152:153], v[136:137], v[130:131], v[144:145] op_sel:[0,1,0] op_sel_hi:[1,1,1]
    v_pk_fma_f32 v[154:155], v[138:139], v[130:131], v[146:147] op_sel:[0,1,0] op_sel_hi:[1,1,1]
    v_pk_fma_f32 v[156:157], v[140:141], v[130:131], v[148:149] op_sel:[0,1,0] op_sel_hi:[1,1,1]
    v_pk_fma_f32 v[158:159], v[142:143], v[130:131], v[150:151] op_sel:[0,1,0] op_sel_hi:[1,1,1]
    v_pk_fma_f32 v[248:249], v[248:249], v[130:131], v[152:153] op_sel_hi:[1,0,1]
    v_pk_fma_f32 v[250:251], v[250:251], v[130:131], v[154:155] op_sel_hi:[1,0,1]
    v_pk_fma_f32 v[252:253], v[252:253], v[130:131], v[156:157] op_sel_hi:[1,0,1]
    v_pk_fma_f32 v[254:255], v[254:255], v[130:131], v[158:159] op_sel_hi:[1,0,1]
    v_pk_mul_f32 v[168:169], v[248:249], v[248:249]
    v_pk_mul_f32 v[170:171], v[250:251], v[250:251]
    v_pk_mul_f32 v[172:173], v[252:253], v[252:253]
    v_pk_mul_f32 v[174:175], v[254:255], v[254:255]
    v_pk_fma_f32 v[168:169], v[168:169], s[56:57], v[206:207]
    v_pk_fma_f32 v[170:171], v[170:171], s[56:57], v[206:207]
    v_pk_fma_f32 v[172:173], v[172:173], s[56:57], v[206:207]
    v_pk_fma_f32 v[174:175], v[174:175], s[56:57], v[206:207]
    v_pk_mul_f32 v[176:177], v[168:169], v[248:249]
    v_pk_mul_f32 v[178:179], v[170:171], v[250:251]
    v_pk_mul_f32 v[180:181], v[172:173], v[252:253]
    v_pk_mul_f32 v[182:183], v[174:175], v[254:255]
    v_exp_f32 v176, v176
    v_exp_f32 v177, v177
    v_exp_f32 v178, v178
    v_exp_f32 v179, v179
    v_exp_f32 v180, v180
    v_exp_f32 v181, v181
    v_exp_f32 v182, v182
    v_exp_f32 v183, v183
    s_waitcnt vmcnt(2)
    s_add_u32 s58, s58, 1
    v_mov_b32 v192, 0
    v_mov_b32 v193, s58
    s_mov_b64 exec, 1
    buffer_store_dword v193, v192, s[4:7], s61 offen sc1
    s_mov_b64 exec, -1
    s_sub_u32 s45, s58, 1
    s_waitcnt vmcnt(2)
    v_cmp_gt_u32 vcc, s45, v194
    s_cbranch_vccnz Lpc_47
Lpcd_48:
    buffer_load_dwordx4 v[208:211], v2, s[4:7], s60 offen offset:0 sc1
    buffer_load_dwordx4 v[212:215], v2, s[4:7], s98 offen offset:0 sc1
    buffer_load_dwordx4 v[216:219], v2, s[4:7], s60 offen offset:2048 sc1
    buffer_load_dwordx4 v[220:223], v2, s[4:7], s98 offen offset:2048 sc1
    s_add_u32 s60, s60, 4096
    buffer_load_dwordx4 v[224:227], v2, s[4:7], s60 offen offset:0 sc1
    s_add_u32 s98, s98, 4096
    buffer_load_dwordx4 v[228:231], v2, s[4:7], s98 offen offset:0 sc1
    buffer_load_dwordx4 v[232:235], v2, s[4:7], s60 offen offset:2048 sc1
    buffer_load_dwordx4 v[236:239], v2, s[4:7], s98 offen offset:2048 sc1
    ds_read_b128 v[88:91], v197 offset:61440
    ds_read_b128 v[92:95], v197 offset:62464
    ds_read_b128 v[96:99], v197 offset:63488
    ds_read_b128 v[100:103], v197 offset:64512
    ds_read_b128 v[104:107], v198 offset:0
    ds_read_b128 v[108:111], v198 offset:6144
    ds_read_b128 v[112:115], v198 offset:7168
    ds_read_b128 v[116:119], v198 offset:8192
    ds_read_b128 v[120:123], v198 offset:9216
    ds_read_b128 v[124:127], v198 offset:10240
    v_pk_add_f32 v[176:177], v[176:177], 1.0 op_sel_hi:[1,0]
    v_pk_add_f32 v[178:179], v[178:179], 1.0 op_sel_hi:[1,0]
    v_pk_add_f32 v[180:181], v[180:181], 1.0 op_sel_hi:[1,0]
    v_pk_add_f32 v[182:183], v[182:183], 1.0 op_sel_hi:[1,0]
    v_rcp_f32 v176, v176
    v_rcp_f32 v177, v177
    v_rcp_f32 v178, v178
    v_rcp_f32 v179, v179
    v_rcp_f32 v180, v180
    v_rcp_f32 v181, v181
    v_rcp_f32 v182, v182
    v_rcp_f32 v183, v183
    v_pk_mul_f32 v[248:249], v[248:249], v[176:177]
    v_pk_mul_f32 v[250:251], v[250:251], v[178:179]
    v_pk_mul_f32 v[252:253], v[252:253], v[180:181]
    v_pk_mul_f32 v[254:255], v[254:255], v[182:183]
    v_cvt_pk_bf16_f32 v188, v248, v249
    v_cvt_pk_bf16_f32 v189, v250, v251
    v_cvt_pk_bf16_f32 v190, v252, v253
    v_cvt_pk_bf16_f32 v191, v254, v255
    buffer_store_dwordx4 v[188:191], v204, s[4:7], s59 offen sc1
    s_waitcnt vmcnt(7) lgkmcnt(5)
    v_mfma_f32_16x16x32_bf16 v[8:11], v[88:91], v[208:211], v[8:11]
    s_add_u32 s60, s60, 4096
    buffer_load_dwordx4 v[240:243], v2, s[4:7], s60 offen offset:0 sc1
    v_mfma_f32_16x16x32_bf16 v[148:151], v[88:91], v[212:215], 0
    ds_read_b128 v[128:131], v198 offset:16384
    v_mfma_f32_16x16x32_bf16 v[12:15], v[92:95], v[208:211], v[12:15]
    v_mfma_f32_16x16x32_bf16 v[152:155], v[92:95], v[212:215], 0
    ds_read_b128 v[132:135], v198 offset:17408
    v_mfma_f32_16x16x32_bf16 v[16:19], v[96:99], v[208:211], v[16:19]
    s_add_u32 s98, s98, 4096
    buffer_load_dwordx4 v[244:247], v2, s[4:7], s98 offen offset:0 sc1
    v_mfma_f32_16x16x32_bf16 v[156:159], v[96:99], v[212:215], 0
    ds_read_b128 v[136:139], v198 offset:18432
    v_mfma_f32_16x16x32_bf16 v[20:23], v[100:103], v[208:211], v[20:23]
    v_mfma_f32_16x16x32_bf16 v[160:163], v[100:103], v[212:215], 0
    ds_read_b128 v[140:143], v198 offset:19456
    v_mfma_f32_16x16x32_bf16 v[24:27], v[104:107], v[208:211], v[24:27]
    v_mfma_f32_16x16x32_bf16 v[164:167], v[104:107], v[212:215], 0
    ds_read_b128 v[144:147], v198 offset:20480
    s_waitcnt vmcnt(7) lgkmcnt(5)
    v_mfma_f32_16x16x32_bf16 v[8:11], v[108:111], v[216:219], v[8:11]
    buffer_load_dwordx4 v[208:211], v2, s[4:7], s60 offen offset:2048 sc1
    v_mfma_f32_16x16x32_bf16 v[148:151], v[108:111], v[220:223], v[148:151]
    ds_read_b128 v[88:91], v199 offset:1024
    v_mfma_f32_16x16x32_bf16 v[12:15], v[112:115], v[216:219], v[12:15]
    v_mfma_f32_16x16x32_bf16 v[152:155], v[112:115], v[220:223], v[152:155]
    ds_read_b128 v[92:95], v199 offset:2048
    v_mfma_f32_16x16x32_bf16 v[16:19], v[116:119], v[216:219], v[16:19]
    buffer_load_dwordx4 v[212:215], v2, s[4:7], s98 offen offset:2048 sc1
    v_mfma_f32_16x16x32_bf16 v[156:159], v[116:119], v[220:223], v[156:159]
    ds_read_b128 v[96:99], v199 offset:3072
    v_mfma_f32_16x16x32_bf16 v[20:23], v[120:123], v[216:219], v[20:23]
    v_mfma_f32_16x16x32_bf16 v[160:163], v[120:123], v[220:223], v[160:163]
    ds_read_b128 v[100:103], v199 offset:4096
    v_mfma_f32_16x16x32_bf16 v[24:27], v[124:127], v[216:219], v[24:27]
    v_mfma_f32_16x16x32_bf16 v[164:167], v[124:127], v[220:223], v[164:167]
    ds_read_b128 v[104:107], v196 offset:0
    s_waitcnt vmcnt(4)
    s_add_u32 s58, s58, 1
    v_mov_b32 v192, 0
    v_mov_b32 v193, s58
    s_mov_b64 exec, 1
    buffer_store_dword v193, v192, s[4:7], s61 offen sc1
    s_mov_b64 exec, -1
    buffer_load_dword v194, v47, s[4:7], s62 offen sc1
    s_waitcnt lgkmcnt(5)
    v_mfma_f32_16x16x32_bf16 v[8:11], v[128:131], v[224:227], v[8:11]
    s_add_u32 s60, s60, 4096
    buffer_load_dwordx4 v[216:219], v2, s[4:7], s60 offen offset:0 sc1
    v_mfma_f32_16x16x32_bf16 v[148:151], v[128:131], v[228:231], v[148:151]
    ds_read_b128 v[108:111], v196 offset:6144
    v_mfma_f32_16x16x32_bf16 v[12:15], v[132:135], v[224:227], v[12:15]
    v_mfma_f32_16x16x32_bf16 v[152:155], v[132:135], v[228:231], v[152:155]
    ds_read_b128 v[112:115], v196 offset:7168
    v_mfma_f32_16x16x32_bf16 v[16:19], v[136:139], v[224:227], v[16:19]
    s_add_u32 s98, s98, 4096
    buffer_load_dwordx4 v[220:223], v2, s[4:7], s98 offen offset:0 sc1
    v_mfma_f32_16x16x32_bf16 v[156:159], v[136:139], v[228:231], v[156:159]
    ds_read_b128 v[116:119], v196 offset:8192
    v_mfma_f32_16x16x32_bf16 v[20:23], v[140:143], v[224:227], v[20:23]
    v_mfma_f32_16x16x32_bf16 v[160:163], v[140:143], v[228:231], v[160:163]
    ds_read_b128 v[120:123], v196 offset:9216
    v_mfma_f32_16x16x32_bf16 v[24:27], v[144:147], v[224:227], v[24:27]
    v_mfma_f32_16x16x32_bf16 v[164:167], v[144:147], v[228:231], v[164:167]
    ds_read_b128 v[124:127], v196 offset:10240
    s_waitcnt lgkmcnt(5)
    s_barrier
    v_mfma_f32_16x16x32_bf16 v[8:11], v[88:91], v[232:235], v[8:11]
    buffer_load_dwordx4 v[224:227], v2, s[4:7], s60 offen offset:2048 sc1
    v_mfma_f32_16x16x32_bf16 v[148:151], v[88:91], v[236:239], v[148:151]
    ds_read_b128 v[128:131], v196 offset:16384
    v_mfma_f32_16x16x32_bf16 v[12:15], v[92:95], v[232:235], v[12:15]
    v_mfma_f32_16x16x32_bf16 v[152:155], v[92:95], v[236:239], v[152:155]
    ds_read_b128 v[132:135], v196 offset:17408
    v_mfma_f32_16x16x32_bf16 v[16:19], v[96:99], v[232:235], v[16:19]
    buffer_load_dwordx4 v[228:231], v2, s[4:7], s98 offen offset:2048 sc1
    v_mfma_f32_16x16x32_bf16 v[156:159], v[96:99], v[236:239], v[156:159]
    ds_read_b128 v[136:139], v196 offset:18432
    v_mfma_f32_16x16x32_bf16 v[20:23], v[100:103], v[232:235], v[20:23]
    v_mfma_f32_16x16x32_bf16 v[160:163], v[100:103], v[236:239], v[160:163]
    ds_read_b128 v[140:143], v196 offset:19456
    v_mfma_f32_16x16x32_bf16 v[24:27], v[104:107], v[232:235], v[24:27]
    v_mfma_f32_16x16x32_bf16 v[164:167], v[104:107], v[236:239], v[164:167]
    ds_read_b128 v[144:147], v196 offset:20480
    s_waitcnt vmcnt(8) lgkmcnt(5)
    s_waitcnt vmcnt(4)
    s_sub_u32 s45, s58, 1
    v_cmp_gt_u32 vcc, s45, v194
    s_cbranch_vccnz Lpc_51
Lpcd_52:
    v_mfma_f32_16x16x32_bf16 v[8:11], v[108:111], v[240:243], v[8:11]
    s_add_u32 s60, s60, 4096
    buffer_load_dwordx4 v[232:235], v2, s[4:7], s60 offen offset:0 sc1
    v_mfma_f32_16x16x32_bf16 v[148:151], v[108:111], v[244:247], v[148:151]
    ds_read_b128 v[88:91], v196 offset:26624
    v_mfma_f32_16x16x32_bf16 v[12:15], v[112:115], v[240:243], v[12:15]
    v_mfma_f32_16x16x32_bf16 v[152:155], v[112:115], v[244:247], v[152:155]
    ds_read_b128 v[92:95], v196 offset:27648
    v_mfma_f32_16x16x32_bf16 v[16:19], v[116:119], v[240:243], v[16:19]
    s_add_u32 s98, s98, 4096
    buffer_load_dwordx4 v[236:239], v2, s[4:7], s98 offen offset:0 sc1
    v_mfma_f32_16x16x32_bf16 v[156:159], v[116:119], v[244:247], v[156:159]
    ds_read_b128 v[96:99], v196 offset:28672
    v_mfma_f32_16x16x32_bf16 v[20:23], v[120:123], v[240:243], v[20:23]
    v_mfma_f32_16x16x32_bf16 v[160:163], v[120:123], v[244:247], v[160:163]
    ds_read_b128 v[100:103], v196 offset:29696
    v_mfma_f32_16x16x32_bf16 v[24:27], v[124:127], v[240:243], v[24:27]
    v_mfma_f32_16x16x32_bf16 v[164:167], v[124:127], v[244:247], v[164:167]
    ds_read_b128 v[104:107], v196 offset:30720
    s_waitcnt lgkmcnt(5)
    v_mfma_f32_16x16x32_bf16 v[8:11], v[128:131], v[208:211], v[8:11]
    buffer_load_dwordx4 v[240:243], v2, s[4:7], s60 offen offset:2048 sc1
    v_mfma_f32_16x16x32_bf16 v[148:151], v[128:131], v[212:215], v[148:151]
    ds_read_b128 v[108:111], v196 offset:36864
    v_mfma_f32_16x16x32_bf16 v[12:15], v[132:135], v[208:211], v[12:15]
    v_mfma_f32_16x16x32_bf16 v[152:155], v[132:135], v[212:215], v[152:155]
    ds_read_b128 v[112:115], v196 offset:37888
    v_mfma_f32_16x16x32_bf16 v[16:19], v[136:139], v[208:211], v[16:19]
    buffer_load_dwordx4 v[244:247], v2, s[4:7], s98 offen offset:2048 sc1
    v_mfma_f32_16x16x32_bf16 v[156:159], v[136:139], v[212:215], v[156:159]
    ds_read_b128 v[116:119], v196 offset:38912
    v_mfma_f32_16x16x32_bf16 v[20:23], v[140:143], v[208:211], v[20:23]
    v_mfma_f32_16x16x32_bf16 v[160:163], v[140:143], v[212:215], v[160:163]
    ds_read_b128 v[120:123], v196 offset:39936
    v_mfma_f32_16x16x32_bf16 v[24:27], v[144:147], v[208:211], v[24:27]
    v_mfma_f32_16x16x32_bf16 v[164:167], v[144:147], v[212:215], v[164:167]
    ds_read_b128 v[124:127], v196 offset:40960
    s_waitcnt vmcnt(6) lgkmcnt(5)
    v_mfma_f32_16x16x32_bf16 v[8:11], v[88:91], v[216:219], v[8:11]
    s_add_u32 s60, s60, 4096
    buffer_load_dwordx4 v[208:211], v2, s[4:7], s60 offen offset:0 sc1
    v_mfma_f32_16x16x32_bf16 v[148:151], v[88:91], v[220:223], v[148:151]
    ds_read_b128 v[128:131], v196 offset:47104
    v_mfma_f32_16x16x32_bf16 v[12:15], v[92:95], v[216:219], v[12:15]
    v_mfma_f32_16x16x32_bf16 v[152:155], v[92:95], v[220:223], v[152:155]
    ds_read_b128 v[132:135], v196 offset:48128
    v_mfma_f32_16x16x32_bf16 v[16:19], v[96:99], v[216:219], v[16:19]
    s_add_u32 s98, s98, 4096
    buffer_load_dwordx4 v[212:215], v2, s[4:7], s98 offen offset:0 sc1
    v_mfma_f32_16x16x32_bf16 v[156:159], v[96:99], v[220:223], v[156:159]
    ds_read_b128 v[136:139], v196 offset:49152
    v_mfma_f32_16x16x32_bf16 v[20:23], v[100:103], v[216:219], v[20:23]
    v_mfma_f32_16x16x32_bf16 v[160:163], v[100:103], v[220:223], v[160:163]
    ds_read_b128 v[140:143], v196 offset:50176
    v_mfma_f32_16x16x32_bf16 v[24:27], v[104:107], v[216:219], v[24:27]
    v_mfma_f32_16x16x32_bf16 v[164:167], v[104:107], v[220:223], v[164:167]
    ds_read_b128 v[144:147], v196 offset:51200
    s_waitcnt vmcnt(6) lgkmcnt(5)
    v_mfma_f32_16x16x32_bf16 v[8:11], v[108:111], v[224:227], v[8:11]
    buffer_load_dwordx4 v[216:219], v2, s[4:7], s60 offen offset:2048 sc1
    v_mfma_f32_16x16x32_bf16 v[148:151], v[108:111], v[228:231], v[148:151]
    ds_read_b128 v[88:91], v196 offset:57344
    v_mfma_f32_16x16x32_bf16 v[12:15], v[112:115], v[224:227], v[12:15]
    v_mfma_f32_16x16x32_bf16 v[152:155], v[112:115], v[228:231], v[152:155]
    ds_read_b128 v[92:95], v196 offset:58368
    v_mfma_f32_16x16x32_bf16 v[16:19], v[116:119], v[224:227], v[16:19]
    buffer_load_dwordx4 v[220:223], v2, s[4:7], s98 offen offset:2048 sc1
    v_mfma_f32_16x16x32_bf16 v[156:159], v[116:119], v[228:231], v[156:159]
    ds_read_b128 v[96:99], v196 offset:59392
    v_mfma_f32_16x16x32_bf16 v[20:23], v[120:123], v[224:227], v[20:23]
    v_mfma_f32_16x16x32_bf16 v[160:163], v[120:123], v[228:231], v[160:163]
    ds_read_b128 v[100:103], v196 offset:60416
    v_mfma_f32_16x16x32_bf16 v[24:27], v[124:127], v[224:227], v[24:27]
    v_mfma_f32_16x16x32_bf16 v[164:167], v[124:127], v[228:231], v[164:167]
    ds_read_b128 v[104:107], v196 offset:61440
    s_waitcnt vmcnt(6) lgkmcnt(5)
    s_barrier
    v_mfma_f32_16x16x32_bf16 v[8:11], v[128:131], v[232:235], v[8:11]
    s_add_u32 s60, s60, 4096
    buffer_load_dwordx4 v[224:227], v2, s[4:7], s60 offen offset:0 sc1
    v_mfma_f32_16x16x32_bf16 v[148:151], v[128:131], v[236:239], v[148:151]
    ds_read_b128 v[108:111], v197 offset:2048
    v_mfma_f32_16x16x32_bf16 v[12:15], v[132:135], v[232:235], v[12:15]
    v_mfma_f32_16x16x32_bf16 v[152:155], v[132:135], v[236:239], v[152:155]
    ds_read_b128 v[112:115], v197 offset:3072
    v_mfma_f32_16x16x32_bf16 v[16:19], v[136:139], v[232:235], v[16:19]
    s_add_u32 s98, s98, 4096
    buffer_load_dwordx4 v[228:231], v2, s[4:7], s98 offen offset:0 sc1
    v_mfma_f32_16x16x32_bf16 v[156:159], v[136:139], v[236:239], v[156:159]
    ds_read_b128 v[116:119], v197 offset:4096
    v_mfma_f32_16x16x32_bf16 v[20:23], v[140:143], v[232:235], v[20:23]
    v_mfma_f32_16x16x32_bf16 v[160:163], v[140:143], v[236:239], v[160:163]
    ds_read_b128 v[120:123], v197 offset:5120
    v_mfma_f32_16x16x32_bf16 v[24:27], v[144:147], v[232:235], v[24:27]
    v_mfma_f32_16x16x32_bf16 v[164:167], v[144:147], v[236:239], v[164:167]
    ds_read_b128 v[124:127], v197 offset:6144
    s_waitcnt vmcnt(6) lgkmcnt(5)
    v_mfma_f32_16x16x32_bf16 v[8:11], v[88:91], v[240:243], v[8:11]
    buffer_load_dwordx4 v[232:235], v2, s[4:7], s60 offen offset:2048 sc1
    v_mfma_f32_16x16x32_bf16 v[148:151], v[88:91], v[244:247], v[148:151]
    ds_read_b128 v[128:131], v197 offset:12288
    v_mfma_f32_16x16x32_bf16 v[12:15], v[92:95], v[240:243], v[12:15]
    v_mfma_f32_16x16x32_bf16 v[152:155], v[92:95], v[244:247], v[152:155]
    ds_read_b128 v[132:135], v197 offset:13312
    v_mfma_f32_16x16x32_bf16 v[16:19], v[96:99], v[240:243], v[16:19]
    buffer_load_dwordx4 v[236:239], v2, s[4:7], s98 offen offset:2048 sc1
    v_mfma_f32_16x16x32_bf16 v[156:159], v[96:99], v[244:247], v[156:159]
    ds_read_b128 v[136:139], v197 offset:14336
    v_mfma_f32_16x16x32_bf16 v[20:23], v[100:103], v[240:243], v[20:23]
    v_mfma_f32_16x16x32_bf16 v[160:163], v[100:103], v[244:247], v[160:163]
    ds_read_b128 v[140:143], v197 offset:15360
    v_mfma_f32_16x16x32_bf16 v[24:27], v[104:107], v[240:243], v[24:27]
    v_mfma_f32_16x16x32_bf16 v[164:167], v[104:107], v[244:247], v[164:167]
    ds_read_b128 v[144:147], v197 offset:16384
    buffer_load_dword v194, v47, s[4:7], s62 offen sc1
    s_waitcnt vmcnt(7) lgkmcnt(5)
    v_mfma_f32_16x16x32_bf16 v[8:11], v[108:111], v[208:211], v[8:11]
    s_add_u32 s60, s60, 4096
    buffer_load_dwordx4 v[240:243], v2, s[4:7], s60 offen offset:0 sc1
    v_mfma_f32_16x16x32_bf16 v[148:151], v[108:111], v[212:215], v[148:151]
    ds_read_b128 v[88:91], v197 offset:22528
    v_mfma_f32_16x16x32_bf16 v[12:15], v[112:115], v[208:211], v[12:15]
    v_mfma_f32_16x16x32_bf16 v[152:155], v[112:115], v[212:215], v[152:155]
    ds_read_b128 v[92:95], v197 offset:23552
    v_mfma_f32_16x16x32_bf16 v[16:19], v[116:119], v[208:211], v[16:19]
    s_add_u32 s98, s98, 4096
    buffer_load_dwordx4 v[244:247], v2, s[4:7], s98 offen offset:0 sc1
    v_mfma_f32_16x16x32_bf16 v[156:159], v[116:119], v[212:215], v[156:159]
    ds_read_b128 v[96:99], v197 offset:24576
    v_mfma_f32_16x16x32_bf16 v[20:23], v[120:123], v[208:211], v[20:23]
    v_mfma_f32_16x16x32_bf16 v[160:163], v[120:123], v[212:215], v[160:163]
    ds_read_b128 v[100:103], v197 offset:25600
    v_mfma_f32_16x16x32_bf16 v[24:27], v[124:127], v[208:211], v[24:27]
    v_mfma_f32_16x16x32_bf16 v[164:167], v[124:127], v[212:215], v[164:167]
    ds_read_b128 v[104:107], v197 offset:26624
    s_waitcnt vmcnt(7) lgkmcnt(5)
    v_mfma_f32_16x16x32_bf16 v[8:11], v[128:131], v[216:219], v[8:11]
    buffer_load_dwordx4 v[208:211], v2, s[4:7], s60 offen offset:2048 sc1
    v_mfma_f32_16x16x32_bf16 v[148:151], v[128:131], v[220:223], v[148:151]
    ds_read_b128 v[108:111], v197 offset:32768
    v_mfma_f32_16x16x32_bf16 v[12:15], v[132:135], v[216:219], v[12:15]
    v_mfma_f32_16x16x32_bf16 v[152:155], v[132:135], v[220:223], v[152:155]
    ds_read_b128 v[112:115], v197 offset:33792
    v_mfma_f32_16x16x32_bf16 v[16:19], v[136:139], v[216:219], v[16:19]
    buffer_load_dwordx4 v[212:215], v2, s[4:7], s98 offen offset:2048 sc1
    v_mfma_f32_16x16x32_bf16 v[156:159], v[136:139], v[220:223], v[156:159]
    ds_read_b128 v[116:119], v197 offset:34816
    v_mfma_f32_16x16x32_bf16 v[20:23], v[140:143], v[216:219], v[20:23]
    v_mfma_f32_16x16x32_bf16 v[160:163], v[140:143], v[220:223], v[160:163]
    ds_read_b128 v[120:123], v197 offset:35840
    v_mfma_f32_16x16x32_bf16 v[24:27], v[144:147], v[216:219], v[24:27]
    v_mfma_f32_16x16x32_bf16 v[164:167], v[144:147], v[220:223], v[164:167]
    ds_read_b128 v[124:127], v197 offset:36864
    s_waitcnt vmcnt(7) lgkmcnt(5)
    s_waitcnt vmcnt(4)
    v_cmp_gt_u32 vcc, s58, v194
    s_cbranch_vccnz Lpc_55
Lpcd_56:
    v_mfma_f32_16x16x32_bf16 v[8:11], v[88:91], v[224:227], v[8:11]
    s_add_u32 s60, s60, 4096
    buffer_load_dwordx4 v[216:219], v2, s[4:7], s60 offen offset:0 sc1
    v_mfma_f32_16x16x32_bf16 v[148:151], v[88:91], v[228:231], v[148:151]
    ds_read_b128 v[128:131], v197 offset:43008
    v_mfma_f32_16x16x32_bf16 v[12:15], v[92:95], v[224:227], v[12:15]
    v_mfma_f32_16x16x32_bf16 v[152:155], v[92:95], v[228:231], v[152:155]
    ds_read_b128 v[132:135], v197 offset:44032
    v_mfma_f32_16x16x32_bf16 v[16:19], v[96:99], v[224:227], v[16:19]
    s_add_u32 s98, s98, 4096
    buffer_load_dwordx4 v[220:223], v2, s[4:7], s98 offen offset:0 sc1
    v_mfma_f32_16x16x32_bf16 v[156:159], v[96:99], v[228:231], v[156:159]
    ds_read_b128 v[136:139], v197 offset:45056
    v_mfma_f32_16x16x32_bf16 v[20:23], v[100:103], v[224:227], v[20:23]
    v_mfma_f32_16x16x32_bf16 v[160:163], v[100:103], v[228:231], v[160:163]
    ds_read_b128 v[140:143], v197 offset:46080
    v_mfma_f32_16x16x32_bf16 v[24:27], v[104:107], v[224:227], v[24:27]
    v_mfma_f32_16x16x32_bf16 v[164:167], v[104:107], v[228:231], v[164:167]
    ds_read_b128 v[144:147], v197 offset:47104
    s_waitcnt lgkmcnt(5)
    s_barrier
    v_mfma_f32_16x16x32_bf16 v[8:11], v[108:111], v[232:235], v[8:11]
    buffer_load_dwordx4 v[224:227], v2, s[4:7], s60 offen offset:2048 sc1
    v_mfma_f32_16x16x32_bf16 v[148:151], v[108:111], v[236:239], v[148:151]
    ds_read_b128 v[88:91], v197 offset:53248
    v_mfma_f32_16x16x32_bf16 v[12:15], v[112:115], v[232:235], v[12:15]
    v_mfma_f32_16x16x32_bf16 v[152:155], v[112:115], v[236:239], v[152:155]
    ds_read_b128 v[92:95], v197 offset:54272
    v_mfma_f32_16x16x32_bf16 v[16:19], v[116:119], v[232:235], v[16:19]
    buffer_load_dwordx4 v[228:231], v2, s[4:7], s98 offen offset:2048 sc1
    v_mfma_f32_16x16x32_bf16 v[156:159], v[116:119], v[236:239], v[156:159]
    ds_read_b128 v[96:99], v197 offset:55296
    v_mfma_f32_16x16x32_bf16 v[20:23], v[120:123], v[232:235], v[20:23]
    v_mfma_f32_16x16x32_bf16 v[160:163], v[120:123], v[236:239], v[160:163]
    ds_read_b128 v[100:103], v197 offset:56320
    v_mfma_f32_16x16x32_bf16 v[24:27], v[124:127], v[232:235], v[24:27]
    v_mfma_f32_16x16x32_bf16 v[164:167], v[124:127], v[236:239], v[164:167]
    ds_read_b128 v[104:107], v197 offset:57344
    s_waitcnt vmcnt(6) lgkmcnt(5)
    v_mfma_f32_16x16x32_bf16 v[8:11], v[128:131], v[240:243], v[8:11]
    s_add_u32 s60, s60, 4096
    buffer_load_dwordx4 v[232:235], v2, s[4:7], s60 offen offset:0 sc1
    v_mfma_f32_16x16x32_bf16 v[148:151], v[128:131], v[244:247], v[148:151]
    ds_read_b128 v[108:111], v197 offset:63488
    v_mfma_f32_16x16x32_bf16 v[12:15], v[132:135], v[240:243], v[12:15]
    v_mfma_f32_16x16x32_bf16 v[152:155], v[132:135], v[244:247], v[152:155]
    ds_read_b128 v[112:115], v197 offset:64512
    v_mfma_f32_16x16x32_bf16 v[16:19], v[136:139], v[240:243], v[16:19]
    s_add_u32 s98, s98, 4096
    buffer_load_dwordx4 v[236:239], v2, s[4:7], s98 offen offset:0 sc1
    v_mfma_f32_16x16x32_bf16 v[156:159], v[136:139], v[244:247], v[156:159]
    ds_read_b128 v[116:119], v198 offset:0
    v_mfma_f32_16x16x32_bf16 v[20:23], v[140:143], v[240:243], v[20:23]
    v_mfma_f32_16x16x32_bf16 v[160:163], v[140:143], v[244:247], v[160:163]
    ds_read_b128 v[120:123], v198 offset:1024
    v_mfma_f32_16x16x32_bf16 v[24:27], v[144:147], v[240:243], v[24:27]
    v_mfma_f32_16x16x32_bf16 v[164:167], v[144:147], v[244:247], v[164:167]
    ds_read_b128 v[124:127], v198 offset:2048
    s_waitcnt vmcnt(6) lgkmcnt(5)
    v_mfma_f32_16x16x32_bf16 v[8:11], v[88:91], v[208:211], v[8:11]
    buffer_load_dwordx4 v[240:243], v2, s[4:7], s60 offen offset:2048 sc1
    v_mfma_f32_16x16x32_bf16 v[148:151], v[88:91], v[212:215], v[148:151]
    ds_read_b128 v[128:131], v198 offset:8192
    v_mfma_f32_16x16x32_bf16 v[12:15], v[92:95], v[208:211], v[12:15]
    v_mfma_f32_16x16x32_bf16 v[152:155], v[92:95], v[212:215], v[152:155]
    ds_read_b128 v[132:135], v198 offset:9216
    v_mfma_f32_16x16x32_bf16 v[16:19], v[96:99], v[208:211], v[16:19]
    buffer_load_dwordx4 v[244:247], v2, s[4:7], s98 offen offset:2048 sc1
    v_mfma_f32_16x16x32_bf16 v[156:159], v[96:99], v[212:215], v[156:159]
    ds_read_b128 v[136:139], v198 offset:10240
    v_mfma_f32_16x16x32_bf16 v[20:23], v[100:103], v[208:211], v[20:23]
    v_mfma_f32_16x16x32_bf16 v[160:163], v[100:103], v[212:215], v[160:163]
    ds_read_b128 v[140:143], v198 offset:11264
    v_mfma_f32_16x16x32_bf16 v[24:27], v[104:107], v[208:211], v[24:27]
    v_mfma_f32_16x16x32_bf16 v[164:167], v[104:107], v[212:215], v[164:167]
    ds_read_b128 v[144:147], v198 offset:12288
    s_waitcnt vmcnt(6) lgkmcnt(5)
    v_mfma_f32_16x16x32_bf16 v[8:11], v[108:111], v[216:219], v[8:11]
    s_add_u32 s60, s60, 4096
    buffer_load_dwordx4 v[208:211], v2, s[4:7], s60 offen offset:0 sc1
    v_mfma_f32_16x16x32_bf16 v[148:151], v[108:111], v[220:223], v[148:151]
    ds_read_b128 v[88:91], v198 offset:18432
    v_mfma_f32_16x16x32_bf16 v[12:15], v[112:115], v[216:219], v[12:15]
    v_mfma_f32_16x16x32_bf16 v[152:155], v[112:115], v[220:223], v[152:155]
    ds_read_b128 v[92:95], v198 offset:19456
    v_mfma_f32_16x16x32_bf16 v[16:19], v[116:119], v[216:219], v[16:19]
    s_add_u32 s98, s98, 4096
    buffer_load_dwordx4 v[212:215], v2, s[4:7], s98 offen offset:0 sc1
    v_mfma_f32_16x16x32_bf16 v[156:159], v[116:119], v[220:223], v[156:159]
    ds_read_b128 v[96:99], v198 offset:20480
    v_mfma_f32_16x16x32_bf16 v[20:23], v[120:123], v[216:219], v[20:23]
    v_mfma_f32_16x16x32_bf16 v[160:163], v[120:123], v[220:223], v[160:163]
    ds_read_b128 v[100:103], v198 offset:21504
    v_mfma_f32_16x16x32_bf16 v[24:27], v[124:127], v[216:219], v[24:27]
    v_mfma_f32_16x16x32_bf16 v[164:167], v[124:127], v[220:223], v[164:167]
    ds_read_b128 v[104:107], v198 offset:22528
    s_mul_i32 s44, s26, 5120
    s_add_u32 s44, s44, 67584
    v_add_u32 v200, s44, v2
    s_xor_b32 s44, s26, 1
    s_mul_i32 s44, s44, 5120
    s_add_u32 s44, s44, 67584
    v_add_u32 v201, s44, v2
    s_waitcnt vmcnt(6) lgkmcnt(5)
    v_mfma_f32_16x16x32_bf16 v[8:11], v[128:131], v[224:227], v[8:11]
    buffer_load_dwordx4 v[216:219], v2, s[4:7], s60 offen offset:2048 sc1
    v_mfma_f32_16x16x32_bf16 v[148:151], v[128:131], v[228:231], v[148:151]
    ds_read_b128 v[108:111], v199 offset:3072
    v_mfma_f32_16x16x32_bf16 v[12:15], v[132:135], v[224:227], v[12:15]
    v_mfma_f32_16x16x32_bf16 v[152:155], v[132:135], v[228:231], v[152:155]
    ds_read_b128 v[112:115], v199 offset:4096
    v_mfma_f32_16x16x32_bf16 v[16:19], v[136:139], v[224:227], v[16:19]
    buffer_load_dwordx4 v[220:223], v2, s[4:7], s98 offen offset:2048 sc1
    v_mfma_f32_16x16x32_bf16 v[156:159], v[136:139], v[228:231], v[156:159]
    ds_read_b128 v[116:119], v196 offset:0
    v_mfma_f32_16x16x32_bf16 v[20:23], v[140:143], v[224:227], v[20:23]
    v_mfma_f32_16x16x32_bf16 v[160:163], v[140:143], v[228:231], v[160:163]
    ds_read_b128 v[120:123], v196 offset:1024
    v_mfma_f32_16x16x32_bf16 v[24:27], v[144:147], v[224:227], v[24:27]
    v_mfma_f32_16x16x32_bf16 v[164:167], v[144:147], v[228:231], v[164:167]
    ds_read_b128 v[124:127], v196 offset:2048
    s_waitcnt vmcnt(6) lgkmcnt(5)
    v_mfma_f32_16x16x32_bf16 v[8:11], v[88:91], v[232:235], v[8:11]
    s_add_u32 s60, s60, 4096
    buffer_load_dwordx4 v[224:227], v2, s[4:7], s60 offen offset:0 sc1
    v_mfma_f32_16x16x32_bf16 v[148:151], v[88:91], v[236:239], v[148:151]
    ds_read_b128 v[128:131], v196 offset:8192
    v_mfma_f32_16x16x32_bf16 v[12:15], v[92:95], v[232:235], v[12:15]
    v_mfma_f32_16x16x32_bf16 v[152:155], v[92:95], v[236:239], v[152:155]
    ds_read_b128 v[132:135], v196 offset:9216
    v_mfma_f32_16x16x32_bf16 v[16:19], v[96:99], v[232:235], v[16:19]
    s_add_u32 s98, s98, 4096
    buffer_load_dwordx4 v[228:231], v2, s[4:7], s98 offen offset:0 sc1
    v_mfma_f32_16x16x32_bf16 v[156:159], v[96:99], v[236:239], v[156:159]
    ds_read_b128 v[136:139], v196 offset:10240
    v_mfma_f32_16x16x32_bf16 v[20:23], v[100:103], v[232:235], v[20:23]
    v_mfma_f32_16x16x32_bf16 v[160:163], v[100:103], v[236:239], v[160:163]
    ds_read_b128 v[140:143], v196 offset:11264
    v_mfma_f32_16x16x32_bf16 v[24:27], v[104:107], v[232:235], v[24:27]
    v_mfma_f32_16x16x32_bf16 v[164:167], v[104:107], v[236:239], v[164:167]
    ds_read_b128 v[144:147], v196 offset:12288
    s_waitcnt vmcnt(6) lgkmcnt(5)
    v_mfma_f32_16x16x32_bf16 v[8:11], v[108:111], v[240:243], v[8:11]
    buffer_load_dwordx4 v[232:235], v2, s[4:7], s60 offen offset:2048 sc1
    v_mfma_f32_16x16x32_bf16 v[148:151], v[108:111], v[244:247], v[148:151]
    ds_read_b128 v[88:91], v196 offset:18432
    v_mfma_f32_16x16x32_bf16 v[12:15], v[112:115], v[240:243], v[12:15]
    v_mfma_f32_16x16x32_bf16 v[152:155], v[112:115], v[244:247], v[152:155]
    ds_read_b128 v[92:95], v196 offset:19456
    v_mfma_f32_16x16x32_bf16 v[16:19], v[116:119], v[240:243], v[16:19]
    buffer_load_dwordx4 v[236:239], v2, s[4:7], s98 offen offset:2048 sc1
    v_mfma_f32_16x16x32_bf16 v[156:159], v[116:119], v[244:247], v[156:159]
    ds_read_b128 v[96:99], v196 offset:20480
    v_mfma_f32_16x16x32_bf16 v[20:23], v[120:123], v[240:243], v[20:23]
    v_mfma_f32_16x16x32_bf16 v[160:163], v[120:123], v[244:247], v[160:163]
    ds_read_b128 v[100:103], v196 offset:21504
    v_mfma_f32_16x16x32_bf16 v[24:27], v[124:127], v[240:243], v[24:27]
    v_mfma_f32_16x16x32_bf16 v[164:167], v[124:127], v[244:247], v[164:167]
    ds_read_b128 v[104:107], v196 offset:22528
    s_waitcnt vmcnt(6) lgkmcnt(5)
    v_mfma_f32_16x16x32_bf16 v[8:11], v[128:131], v[208:211], v[8:11]
    s_mul_i32 s46, s26, 3072
    v_mfma_f32_16x16x32_bf16 v[148:151], v[128:131], v[212:215], v[148:151]
    ds_read_b128 v[108:111], v196 offset:28672
    s_add_u32 s46, s46, 88064
    v_mfma_f32_16x16x32_bf16 v[12:15], v[132:135], v[208:211], v[12:15]
    v_mul_u32_u24 v168, 40, v47
    v_mfma_f32_16x16x32_bf16 v[152:155], v[132:135], v[212:215], v[152:155]
    ds_read_b128 v[112:115], v196 offset:29696
    v_add_u32 v168, s46, v168
    v_mfma_f32_16x16x32_bf16 v[16:19], v[136:139], v[208:211], v[16:19]
    v_lshrrev_b32 v170, 4, v1
    v_mfma_f32_16x16x32_bf16 v[156:159], v[136:139], v[212:215], v[156:159]
    ds_read_b128 v[116:119], v196 offset:30720
    v_lshl_add_u32 v169, v170, 3, v168
    v_mfma_f32_16x16x32_bf16 v[20:23], v[140:143], v[208:211], v[20:23]
    v_lshl_add_u32 v168, v170, 4, v168
    v_mfma_f32_16x16x32_bf16 v[160:163], v[140:143], v[212:215], v[160:163]
    ds_read_b128 v[120:123], v196 offset:31744
    v_add_u32 v170, s46, v2
    v_mfma_f32_16x16x32_bf16 v[24:27], v[144:147], v[208:211], v[24:27]
    s_mul_i32 s46, s31, 20480
    v_mfma_f32_16x16x32_bf16 v[164:167], v[144:147], v[212:215], v[164:167]
    ds_read_b128 v[124:127], v196 offset:32768
    s_mul_i32 s47, s33, 160
    s_waitcnt vmcnt(4) lgkmcnt(5)
    v_mfma_f32_16x16x32_bf16 v[8:11], v[88:91], v[216:219], v[8:11]
    s_add_u32 s46, s46, s47
    v_mfma_f32_16x16x32_bf16 v[148:151], v[88:91], v[220:223], v[148:151]
    ds_read_b128 v[128:131], v196 offset:38912
    v_add_u32 v171, 0, v1
    v_mfma_f32_16x16x32_bf16 v[12:15], v[92:95], v[216:219], v[12:15]
    v_mul_u32_u24 v174, 6554, v171
    v_mfma_f32_16x16x32_bf16 v[152:155], v[92:95], v[220:223], v[152:155]
    ds_read_b128 v[132:135], v196 offset:39936
    v_lshrrev_b32 v174, 16, v174
    v_mfma_f32_16x16x32_bf16 v[16:19], v[96:99], v[216:219], v[16:19]
    v_mul_u32_u24 v174, 1120, v174
    v_mfma_f32_16x16x32_bf16 v[156:159], v[96:99], v[220:223], v[156:159]
    ds_read_b128 v[136:139], v196 offset:40960
    v_lshl_add_u32 v171, v171, 4, v174
    v_mfma_f32_16x16x32_bf16 v[20:23], v[100:103], v[216:219], v[20:23]
    v_add_u32 v172, 64, v1
    v_mfma_f32_16x16x32_bf16 v[160:163], v[100:103], v[220:223], v[160:163]
    ds_read_b128 v[140:143], v196 offset:41984
    v_mul_u32_u24 v174, 6554, v172
    v_mfma_f32_16x16x32_bf16 v[24:27], v[104:107], v[216:219], v[24:27]
    v_lshrrev_b32 v174, 16, v174
    v_mfma_f32_16x16x32_bf16 v[164:167], v[104:107], v[220:223], v[164:167]
    ds_read_b128 v[144:147], v196 offset:43008
    v_mul_u32_u24 v174, 1120, v174
    s_waitcnt vmcnt(2) lgkmcnt(5)
    v_mfma_f32_16x16x32_bf16 v[8:11], v[108:111], v[224:227], v[8:11]
    v_lshl_add_u32 v172, v172, 4, v174
    v_mfma_f32_16x16x32_bf16 v[148:151], v[108:111], v[228:231], v[148:151]
    v_add_u32 v173, 128, v1
    v_mfma_f32_16x16x32_bf16 v[12:15], v[112:115], v[224:227], v[12:15]
    v_mul_u32_u24 v174, 6554, v173
    v_mfma_f32_16x16x32_bf16 v[152:155], v[112:115], v[228:231], v[152:155]
    v_lshrrev_b32 v174, 16, v174
    v_mfma_f32_16x16x32_bf16 v[16:19], v[116:119], v[224:227], v[16:19]
    v_mul_u32_u24 v174, 1120, v174
    v_mfma_f32_16x16x32_bf16 v[156:159], v[116:119], v[228:231], v[156:159]
    v_lshl_add_u32 v173, v173, 4, v174
    v_mfma_f32_16x16x32_bf16 v[20:23], v[120:123], v[224:227], v[20:23]
    v_mfma_f32_16x16x32_bf16 v[160:163], v[120:123], v[228:231], v[160:163]
    v_mfma_f32_16x16x32_bf16 v[24:27], v[124:127], v[224:227], v[24:27]
    v_mfma_f32_16x16x32_bf16 v[164:167], v[124:127], v[228:231], v[164:167]
    s_waitcnt vmcnt(0) lgkmcnt(0)
    v_mfma_f32_16x16x32_bf16 v[148:151], v[128:131], v[236:239], v[148:151]
    v_mfma_f32_16x16x32_bf16 v[152:155], v[132:135], v[236:239], v[152:155]
    v_mfma_f32_16x16x32_bf16 v[156:159], v[136:139], v[236:239], v[156:159]
    v_mfma_f32_16x16x32_bf16 v[160:163], v[140:143], v[236:239], v[160:163]
    v_mfma_f32_16x16x32_bf16 v[164:167], v[144:147], v[236:239], v[164:167]
    v_mfma_f32_16x16x32_bf16 v[8:11], v[128:131], v[232:235], v[8:11]
    v_mfma_f32_16x16x32_bf16 v[12:15], v[132:135], v[232:235], v[12:15]
    v_mfma_f32_16x16x32_bf16 v[16:19], v[136:139], v[232:235], v[16:19]
    v_mfma_f32_16x16x32_bf16 v[20:23], v[140:143], v[232:235], v[20:23]
    v_mfma_f32_16x16x32_bf16 v[24:27], v[144:147], v[232:235], v[24:27]
    ds_write_b128 v200, v[148:151] offset:0
    ds_write_b128 v200, v[152:155] offset:1024
    ds_write_b128 v200, v[156:159] offset:2048
    ds_write_b128 v200, v[160:163] offset:3072
    ds_write_b128 v200, v[164:167] offset:4096
    s_waitcnt lgkmcnt(0)
    s_barrier
    ds_read_b128 v[148:151], v201 offset:0
    ds_read_b128 v[152:155], v201 offset:1024
    ds_read_b128 v[156:159], v201 offset:2048
    ds_read_b128 v[160:163], v201 offset:3072
    ds_read_b128 v[164:167], v201 offset:4096
    s_waitcnt lgkmcnt(4)
    v_pk_add_f32 v[8:9], v[8:9], v[148:149]
    v_pk_add_f32 v[10:11], v[10:11], v[150:151]
    s_waitcnt lgkmcnt(3)
    v_pk_add_f32 v[12:13], v[12:13], v[152:153]
    v_pk_add_f32 v[14:15], v[14:15], v[154:155]
    s_waitcnt lgkmcnt(2)
    v_pk_add_f32 v[16:17], v[16:17], v[156:157]
    v_pk_add_f32 v[18:19], v[18:19], v[158:159]
    s_waitcnt lgkmcnt(1)
    v_pk_add_f32 v[20:21], v[20:21], v[160:161]
    v_pk_add_f32 v[22:23], v[22:23], v[162:163]
    s_waitcnt lgkmcnt(0)
    v_pk_add_f32 v[24:25], v[24:25], v[164:165]
    v_pk_add_f32 v[26:27], v[26:27], v[166:167]
    s_cmp_lg_u32 s27, 0
    s_cbranch_scc1 L_final
    s_add_u32 s45, s97, 1
    s_add_u32 s97, s97, 2
    s_nop 1
    v_cvt_pk_bf16_f32 v136, v8, v9
    v_cvt_pk_bf16_f32 v137, v10, v11
    v_cvt_pk_bf16_f32 v138, v12, v13
    v_cvt_pk_bf16_f32 v139, v14, v15
    buffer_store_dwordx4 v[136:139], v43, s[4:7], 0 offen sc1
    v_cvt_pk_bf16_f32 v140, v16, v17
    v_cvt_pk_bf16_f32 v141, v18, v19
    v_cvt_pk_bf16_f32 v142, v20, v21
    v_cvt_pk_bf16_f32 v143, v22, v23
    buffer_store_dwordx4 v[140:143], v43, s[4:7], 0 offen offset:2048 sc1
    v_cvt_pk_bf16_f32 v144, v24, v25
    v_cvt_pk_bf16_f32 v145, v26, v27
    buffer_store_dwordx2 v[144:145], v44, s[4:7], 0 offen sc1
    v_pk_add_f32 v[148:149], v[8:9], v[10:11]
    v_pk_mul_f32 v[150:151], v[8:9], v[8:9]
    v_pk_fma_f32 v[150:151], v[10:11], v[10:11], v[150:151]
    v_pk_add_f32 v[148:149], v[148:149], v[12:13]
    v_pk_fma_f32 v[150:151], v[12:13], v[12:13], v[150:151]
    v_pk_add_f32 v[148:149], v[148:149], v[14:15]
    v_pk_fma_f32 v[150:151], v[14:15], v[14:15], v[150:151]
    v_pk_add_f32 v[148:149], v[148:149], v[16:17]
    v_pk_fma_f32 v[150:151], v[16:17], v[16:17], v[150:151]
    v_pk_add_f32 v[148:149], v[148:149], v[18:19]
    v_pk_fma_f32 v[150:151], v[18:19], v[18:19], v[150:151]
    v_pk_add_f32 v[148:149], v[148:149], v[20:21]
    v_pk_fma_f32 v[150:151], v[20:21], v[20:21], v[150:151]
    v_pk_add_f32 v[148:149], v[148:149], v[22:23]
    v_pk_fma_f32 v[150:151], v[22:23], v[22:23], v[150:151]
    v_pk_add_f32 v[148:149], v[148:149], v[24:25]
    v_pk_fma_f32 v[150:151], v[24:25], v[24:25], v[150:151]
    v_pk_add_f32 v[148:149], v[148:149], v[26:27]
    v_pk_fma_f32 v[150:151], v[26:27], v[26:27], v[150:151]
    v_add_f32 v148, v148, v149
    v_add_f32 v150, v150, v151
    v_mov_b32 v152, 0
    v_mov_b32 v153, s45
    v_permlane32_swap_b32 v148, v150
    v_add_f32 v148, v148, v150
    v_mov_b32 v150, v148
    v_mov_b32 v154, s97
    s_nop 0
    v_permlane16_swap_b32 v148, v150
    v_add_f32 v148, v148, v150
    buffer_store_dword v148, v45, s[4:7], 0 offen sc1
    s_barrier
    s_mov_b64 exec, 1
    s_waitcnt vmcnt(1)
    buffer_store_dword v153, v152, s[4:7], s96 offen sc1
    s_mov_b64 exec, -1
    s_lshl_b32 s44, s37, 1
    s_add_u32 s44, s44, 71680
    v_add_u32 v7, s44, v2
    ds_write_b128 v7, v[48:51] offset:0
    ds_write_b128 v7, v[52:55] offset:1024
    ds_write_b128 v7, v[56:59] offset:16384
    ds_write_b128 v7, v[60:63] offset:17408
    ds_write_b128 v7, v[64:67] offset:32768
    ds_write_b128 v7, v[68:71] offset:33792
    v_add_u32 v7, 49152, v7
    ds_write_b128 v7, v[72:75] offset:0
    ds_write_b128 v7, v[76:79] offset:1024
    ds_write_b128 v7, v[80:83] offset:16384
    ds_write_b128 v7, v[84:87] offset:17408
    s_mov_b64 exec, 1
    s_waitcnt vmcnt(1)
    buffer_store_dword v154, v152, s[4:7], s96 offen sc1
    s_mov_b64 exec, -1
    s_setprio 0
    s_branch L_p1b
L_done:
L_exit:
    s_endpgm
L_codeend:
.section .rodata,"a"
.p2align 6
.amdhsa_kernel interleave_layers__softmax_full_mha__dense_activation_gelu__prompt_kernel
  .amdhsa_next_free_vgpr 256
  .amdhsa_next_free_sgpr 102
  .amdhsa_accum_offset 256
  .amdhsa_group_segment_fixed_size 0
  .amdhsa_kernarg_size 88
  .amdhsa_user_sgpr_count 2
  .amdhsa_user_sgpr_kernarg_segment_ptr 1
  .amdhsa_system_sgpr_workgroup_id_x 1
  .amdhsa_float_denorm_mode_32 3
.end_amdhsa_kernel
```
